```python
import torch

def _softmax(x, axis=-1):
    return torch.softmax(x, dim=axis)
def _gelu(x):
    return torch.nn.functional.gelu(x, approximate="tanh")
def _silu(x):
    return torch.nn.functional.silu(x)
def _sigmoid(x):
    return torch.sigmoid(x)
def _layernorm(x, axis=-1, eps=1e-5):
    m = x.mean(dim=axis, keepdim=True)
    v = x.var(dim=axis, keepdim=True, unbiased=False)
    return (x - m) / torch.sqrt(v + eps)
def _scatter_add(tgt, idx, src, axis=0):
    return tgt.clone().index_add_(axis, idx, src)
def _segment_sum(src, seg, n):
    out = torch.zeros((n,) + src.shape[1:], dtype=src.dtype)
    return out.index_add_(0, seg, src)
def _pad(x, pw):
    flat = tuple(v for pair in reversed(pw) for v in pair)
    return torch.nn.functional.pad(x, flat)

kernel_name = 'parallel_sum__linear_attn_block__geglu_ffn__prompt'

def setup_inputs():

    _w = (lambda a: (lambda t: t.to(torch.bfloat16) if t.is_floating_point() else t)(torch.as_tensor(a)))
    def _A_setup():
        B, S, D = 1, 2048, 576
        return {
            "x": _w((lambda *s: torch.randn(*s, dtype=torch.bfloat16) * 0.05)(B, S, D)),
            "wqkv": _w((lambda *s: torch.randn(*s, dtype=torch.bfloat16) * 0.4)(D, 3 * D)),
            "wo": _w((lambda *s: torch.randn(*s, dtype=torch.bfloat16) * 0.2)(D, D)),
        }
    _A_in = _A_setup()

    def _B_setup():
        B, S, D, F = 1, 2048, 576, 4608
        return {
            "x": _w((lambda *s: torch.randn(*s, dtype=torch.bfloat16) * 0.05)(B, S, D)),
            "w_gate": _w((lambda *s: torch.randn(*s, dtype=torch.bfloat16) * 0.05)(D, F)),
            "w_up": _w((lambda *s: torch.randn(*s, dtype=torch.bfloat16) * 0.05)(D, F)),
            "w_down": _w((lambda *s: torch.randn(*s, dtype=torch.bfloat16) * 0.05)(F, D)),
        }
    _B_in = _B_setup()

    return {
        "A_x": _A_in["x"],
        "A_wqkv": _A_in["wqkv"],
        "A_wo": _A_in["wo"],
        "B_x": _B_in["x"],
        "B_w_gate": _B_in["w_gate"],
        "B_w_up": _B_in["w_up"],
        "B_w_down": _B_in["w_down"],
    }

def reference(A_x, A_wqkv, A_wo, B_x, B_w_gate, B_w_up, B_w_down):
    def _A_ref(x, wqkv, wo):
        B, S, D = x.shape
        H = 32; Dh = D // H
        qkv = (lambda x, *d: x.permute(*d))((x @ wqkv).reshape(B, S, 3, H, Dh), 2, 0, 3, 1, 4)
        q, k, v = qkv[0], qkv[1], qkv[2]
        phi = lambda t: torch.where(t > 0, t + 1, torch.exp(t)) + 1e-6
        pq, pk = phi(q), phi(k)
        kv = torch.einsum("bhsd,bhse->bhde", pk, v)
        z = torch.einsum("bhsd->bhd", pk)
        num = torch.einsum("bhqd,bhde->bhqe", pq, kv)
        den = torch.einsum("bhqd,bhd->bhq", pq, z)[..., None] + 1e-6
        o = num / den
        return (lambda x, *d: x.permute(*d))(o, 0, 2, 1, 3).reshape(B, S, D) @ wo

    def _B_ref(x, w_gate, w_up, w_down):
        return (_gelu(x @ w_gate) * (x @ w_up)) @ w_down

    x = A_x
    xn = _layernorm(x, axis=-1)
    return x + _A_ref(xn, A_wqkv, A_wo) + _B_ref(xn, B_w_gate, B_w_up, B_w_down)
```

```asm
; @launch grid=(256,1,1) block=(256,1,1) lds=163840
.amdgcn_target "amdgcn-amd-amdhsa--gfx950"
.text
.globl parallel_sum__linear_attn_block__geglu_ffn__prompt_kernel
.p2align 8
.type parallel_sum__linear_attn_block__geglu_ffn__prompt_kernel,@function
parallel_sum__linear_attn_block__geglu_ffn__prompt_kernel:
    s_cmp_ge_u32 s2, 256
    s_cbranch_scc1 L_endA
    s_load_dwordx16 s[4:19], s[0:1], 0
    s_load_dwordx4 s[20:23], s[0:1], 64
    s_getpc_b64 s[80:81]
L_pc:
    s_lshr_b32 s3, s2, 3
    s_lshl_b32 s3, s3, 12
    v_lshl_add_u32 v2, v0, 4, s3
    v_min_u32 v2, L_codeend-L_pc-4, v2
    global_load_dword v11, v2, s[80:81]
    v_lshrrev_b32 v1, 6, v0
    s_nop 0
    v_readfirstlane_b32 s52, v1
    v_and_b32 v0, 63, v0
    s_bfe_u32 s53, s2, 196608
    s_lshl_b32 s53, s53, 1
    s_bfe_u32 s82, s2, 65539
    s_add_u32 s53, s53, s82
    s_and_b32 s82, s82, 1
    s_lshr_b32 s54, s2, 4
    v_lshrrev_b32 v1, 3, v0
    v_mul_u32_u24 v1, 1152, v1
    v_and_b32 v3, 7, v0
    v_lshl_add_u32 v1, v3, 4, v1
    s_lshl_b32 s83, s54, 2
    s_add_u32 s83, s83, s52
    s_mul_i32 s83, s83, 36864
    s_lshr_b32 s65, s2, 0
    s_and_b32 s65, s65, 3
    s_mul_i32 s87, s65, 9216
    s_add_u32 s87, s87, s83
    s_waitcnt lgkmcnt(0)
    s_mov_b32 s24, s4
    s_mov_b32 s25, s5
    s_mov_b32 s26, 2359296
    s_mov_b32 s27, 0x20000
    buffer_load_dwordx4 v[140:143], v1, s[24:27], s87 offen offset:0
    buffer_load_dwordx4 v[144:147], v1, s[24:27], s87 offen offset:128
    buffer_load_dwordx4 v[148:151], v1, s[24:27], s87 offen offset:256
    buffer_load_dwordx4 v[152:155], v1, s[24:27], s87 offen offset:384
    buffer_load_dwordx4 v[156:159], v1, s[24:27], s87 offen offset:512
    buffer_load_dwordx4 v[44:47], v1, s[24:27], s87 offen offset:640
    buffer_load_dwordx4 v[60:63], v1, s[24:27], s87 offen offset:768
    buffer_load_dwordx4 v[76:79], v1, s[24:27], s87 offen offset:896
    buffer_load_dwordx4 v[92:95], v1, s[24:27], s87 offen offset:1024
    s_sub_u32 s28, s6, 4096
    s_subb_u32 s29, s7, 0
    s_mov_b32 s30, 1994752
    s_mov_b32 s31, 0x20000
    s_sub_u32 s32, s8, 4096
    s_subb_u32 s33, s9, 0
    s_mov_b32 s34, 667648
    s_mov_b32 s35, 0x20000
    s_sub_u32 s36, s12, 4096
    s_subb_u32 s37, s13, 0
    s_mov_b32 s38, 5312512
    s_mov_b32 s39, 0x20000
    s_sub_u32 s40, s14, 4096
    s_subb_u32 s41, s15, 0
    s_mov_b32 s42, 5312512
    s_mov_b32 s43, 0x20000
    s_sub_u32 s44, s16, 4096
    s_subb_u32 s45, s17, 0
    s_mov_b32 s46, 5312512
    s_mov_b32 s47, 0x20000
    s_mov_b32 s48, s22
    s_mov_b32 s49, s23
    s_mov_b32 s50, 100663296
    s_mov_b32 s51, 0x20000
    s_lshl_b32 s55, s52, 12
    s_mul_i32 s56, s53, 72
    s_and_b32 s56, s56, -16
    s_add_u32 s56, s56, 4096
    s_mul_i32 s57, s53, 576
    s_add_u32 s57, s57, 4096
    s_mul_i32 s59, s53, 331776
    s_add_u32 s59, s59, 4096
    s_cmp_eq_u32 s82, 0
    s_cselect_b32 s84, 512, 0
    s_cselect_b32 s85, 0, 64
    s_cselect_b32 s86, 294912, 0
    s_cselect_b32 s87, 0, 36864
    s_add_u32 s58, s57, s84
    s_add_u32 s57, s57, s85
    s_add_u32 s60, s59, s86
    s_add_u32 s59, s59, s87
    s_mul_i32 s61, s53, 41472
    s_add_u32 s61, s61, 4096
    s_lshr_b32 s84, s2, 4
    s_lshl_b32 s84, s84, 2
    s_add_u32 s84, s84, s52
    s_mul_i32 s84, s84, 82944
    s_add_u32 s0, s57, s84
    s_add_u32 s1, s58, s84
    s_lshr_b32 s84, s2, 3
    s_lshl_b32 s84, s84, 2
    s_add_u32 s84, s84, s52
    s_lshr_b32 s85, s53, 1
    s_mul_i32 s3, s85, 663552
    s_lshl_b32 s86, s84, 11
    s_add_u32 s3, s3, s86
    s_add_u32 s3, s3, 4096
    s_mul_i32 s10, s85, 82944
    s_add_u32 s10, s10, s86
    s_add_u32 s10, s10, 4096
    s_cmp_lt_u32 s84, 41
    s_cselect_b32 s10, s10, 0x7ff00000
    s_mul_i32 s85, s85, 144
    s_and_b32 s85, s85, -128
    s_mul_i32 s84, s84, 16128
    s_add_u32 s11, s84, s85
    s_add_u32 s11, s11, 4096
    v_lshrrev_b32 v2, 1, v0
    v_min_u32 v2, 13, v2
    v_mul_u32_u24 v2, 1152, v2
    v_and_b32 v6, 1, v0
    v_lshl_add_u32 v5, v6, 7, v2
    v_min_u32 v6, 8, v0
    v_mul_u32_u24 v6, 9216, v6
    v_lshlrev_b32 v7, 5, v0
    s_mul_i32 s84, s52, 73728
    s_add_u32 s57, s57, s84
    s_lshl_b32 s84, s84, 1
    s_add_u32 s58, s58, s84
    s_mul_i32 s84, s52, 9216
    s_add_u32 s59, s59, s84
    s_add_u32 s60, s60, s84
    s_add_u32 s61, s61, s84
    s_mul_i32 s62, s53, 2428928
    s_mul_i32 s84, s54, 151808
    s_add_u32 s62, s62, s84
    s_add_u32 s62, s62, 983040
    s_mul_i32 s63, s53, 49152
    s_add_u32 s63, s63, 50331648
    v_lshrrev_b32 v3, 4, v0
    s_and_b32 s84, s52, 1
    s_lshl_b32 s84, s84, 3
    v_lshlrev_b32 v253, 1, v3
    v_or_b32 v253, s84, v253
    v_and_b32 v254, 15, v0
    v_xor_b32 v253, v253, v254
    v_min_u32 v253, 14, v253
    v_mul_u32_u24 v254, 52, v253
    v_lshrrev_b32 v254, 8, v254
    v_min_u32 v2, 1, v254
    v_mul_u32_u24 v254, 1072, v254
    v_lshl_add_u32 v253, v253, 4, v254
    s_lshl_b32 s84, s52, 3
    v_add_u32 v2, s84, v3
    v_mul_u32_u24 v2, 3456, v2
    v_add_u32 v4, v2, v253
    s_mul_i32 s84, s52, 20480
    s_add_u32 s84, s84, 65536
    s_xor_b32 s85, s52, 1
    s_mul_i32 s85, s85, 20480
    s_add_u32 s85, s85, 65536
    v_lshlrev_b32 v253, 1, v3
    v_xor_b32 v253, v253, v0
    v_lshlrev_b32 v253, 4, v253
    v_xor_b32 v254, 16, v253
    v_add_u32 v28, s84, v253
    v_add_u32 v29, s84, v254
    v_add_u32 v30, s85, v253
    v_add_u32 v31, s85, v254
    v_bfe_u32 v253, v0, 2, 1
    v_and_b32 v254, 3, v0
    v_lshl_add_u32 v2, v254, 1, v253
    v_lshrrev_b32 v3, 3, v0
    v_xor_b32 v2, v2, v3
    v_lshl_add_u32 v2, v254, 4, v2
    v_lshlrev_b32 v2, 4, v2
    v_lshl_add_u32 v2, v253, 10, v2
    v_add_u32 v42, s84, v2
    s_and_b32 s84, s65, 1
    s_lshl_b32 s84, s84, 7
    v_add_u32 v42, s84, v42
    v_xor_b32 v43, 128, v42
    s_add_u32 s80, s80, L_tbl-L_pc
    s_addc_u32 s81, s81, 0
    s_and_b32 s86, s52, 1
    v_lshrrev_b32 v236, 4, v0
    v_bfe_u32 v237, v0, 2, 2
    v_and_b32 v238, 3, v0
    v_lshrrev_b32 v2, 3, v0
    v_and_b32 v3, 7, v0
    v_and_b32 v239, 2, v2
    v_xor_b32 v239, v239, v3
    s_lshl_b32 s84, s86, 2
    v_xor_b32 v239, s84, v239
    v_mul_u32_u24 v240, 9216, v2
    v_lshl_add_u32 v8, v239, 4, v240
    v_lshlrev_b32 v239, 1, v236
    v_xor_b32 v239, v239, v3
    v_mul_u32_u24 v240, 1152, v2
    v_lshl_add_u32 v10, v239, 4, v240
    v_and_b32 v239, 2, v236
    v_xor_b32 v239, v239, v238
    v_lshrrev_b32 v240, 2, v0
    v_mul_u32_u24 v240, 9216, v240
    v_lshl_add_u32 v9, v239, 4, v240
    v_and_b32 v2, 1, v236
    v_lshrrev_b32 v3, 1, v236
    v_lshlrev_b32 v3, 12, v3
    v_lshl_add_u32 v3, v2, 9, v3
    v_lshrrev_b32 v239, 1, v237
    v_lshl_add_u32 v239, v2, 1, v239
    s_lshl_b32 s84, s86, 1
    v_xor_b32 v239, s84, v239
    v_lshlrev_b32 v239, 5, v239
    v_lshl_add_u32 v239, v237, 7, v239
    v_lshl_add_u32 v239, v238, 3, v239
    v_lshl_add_u32 v12, v236, 12, v239
    v_xor_b32 v13, 32, v12
    v_add_u32 v16, v3, v239
    v_xor_b32 v17, 32, v16
    v_xor_b32 v239, s86, v2
    v_lshl_add_u32 v239, v239, 5, v3
    v_lshl_add_u32 v239, v237, 6, v239
    v_lshl_add_u32 v14, v238, 3, v239
    s_mul_i32 s84, s52, 768
    v_lshl_add_u32 v239, v0, 4, s84
    v_mov_b32 v240, 0x7ff00000
    v_cmp_gt_u32 vcc, 48, v0
    s_nop 1
    v_cndmask_b32 v15, v240, v239, vcc
    s_lshl_b32 s84, s86, 13
    s_lshl_b32 s85, s52, 11
    s_add_u32 s84, s84, s85
    s_add_u32 s84, s84, 65536
    v_lshl_add_u32 v18, v0, 4, s84
    v_xor_b32 v19, 2048, v18
    v_lshlrev_b32 v3, 12, v236
    v_lshl_add_u32 v3, v237, 8, v3
    v_lshl_add_u32 v2, v2, 2, v237
    v_lshlrev_b32 v2, 5, v2
    v_add_u32 v239, s82, v238
    v_lshlrev_b32 v239, 3, v239
    v_add_u32 v240, 0, v239
    v_xad_u32 v20, v240, v2, v3
    v_add_u32 v240, 32, v239
    v_xad_u32 v21, v240, v2, v3
    v_add_u32 v240, 80, v239
    v_xad_u32 v23, v240, v2, v3
    v_add_u32 v240, 112, v239
    v_xad_u32 v24, v240, v2, v3
    v_add_u32 v240, 160, v239
    v_xad_u32 v25, v240, v2, v3
    v_add_u32 v240, 192, v239
    v_xad_u32 v26, v240, v2, v3
    s_cmp_eq_u32 s82, 0
    s_mov_b32 s84, 0x4898e898
    s_cselect_b32 s84, 0x4090e090, s84
    v_lshlrev_b32 v240, 3, v238
    v_bfe_u32 v240, s84, v240, 8
    v_xad_u32 v27, v240, v2, v3
    v_lshlrev_b32 v3, 4, v0
    s_mov_b32 s64, 0x409d30fc
    s_mov_b32 s69, 0xbeeff558
    s_mov_b32 s66, 0xc0450298
    s_mov_b32 s67, 0xc0088e99
    s_mov_b32 s68, 0x358637bd
    s_mov_b32 s74, 0xf00ff00f
    s_mov_b32 s75, 0xf00ff00f
    s_mov_b32 s76, 0x0f000f00
    s_mov_b32 s77, 0x0f000f00
    s_mov_b32 s78, 0xffff
    s_mov_b32 s79, 0
    s_mov_b32 s84, 0x3f803f80
    s_lshl_b32 s17, s54, 4
    s_add_u32 s17, s17, s53
    s_lshl_b32 s17, s17, 2
    s_add_u32 s17, s17, s52
    s_lshl_b32 s17, s17, 7
    s_add_u32 s17, s17, 58720256
    s_mov_b32 s86, s11
    s_lshl_b32 s12, s54, 4
    s_add_u32 s12, s12, s53
    s_xor_b32 s14, s12, 1
    s_mul_i32 s12, s12, 90368
    s_add_u32 s12, s12, 67043328
    s_mul_i32 s14, s14, 90368
    s_add_u32 s14, s14, 67043328
    s_xor_b32 s15, s17, 512
    s_and_b32 s15, s15, 4294967167
    s_lshr_b32 s85, s53, 1
    s_mul_i32 s85, s85, 82944
    s_lshl_b32 s13, s82, 9
    s_add_u32 s85, s85, s13
    s_add_u32 s85, s85, 36864
    s_lshl_b32 s13, s52, 6
    v_add_u32 v253, s13, v0
    v_mul_u32_u24 v236, 1639, v253
    v_lshrrev_b32 v236, 16, v236
    v_lshlrev_b32 v253, 4, v253
    v_mul_u32_u24 v237, 640, v236
    v_sub_u32 v253, v253, v237
    v_lshrrev_b32 v237, 2, v236
    v_xor_b32 v237, s82, v237
    v_mul_u32_u24 v237, 36, v237
    v_and_b32 v236, 3, v236
    v_add_u32 v236, v236, v237
    v_mul_u32_u24 v236, 1152, v236
    v_add3_u32 v253, v253, v236, s85
    s_mov_b32 s13, 256
    v_add_u32 v254, s13, v0
    v_mul_u32_u24 v236, 1639, v254
    v_lshrrev_b32 v236, 16, v236
    v_lshlrev_b32 v254, 4, v254
    v_mul_u32_u24 v237, 640, v236
    v_sub_u32 v254, v254, v237
    v_lshrrev_b32 v237, 2, v236
    v_xor_b32 v237, s82, v237
    v_mul_u32_u24 v237, 36, v237
    v_and_b32 v236, 3, v236
    v_add_u32 v236, v236, v237
    v_mul_u32_u24 v236, 1152, v236
    v_add3_u32 v254, v254, v236, s85
    s_lshr_b32 s13, s54, 1
    v_mov_b32 v32, 0
    v_mov_b32 v33, 0
    v_mov_b32 v34, 0
    v_mov_b32 v35, 0
    v_mov_b32 v36, 158704
    ds_write_b128 v36, v[32:35]
    s_mov_b64 exec, 0
    s_cmp_eq_u32 s52, 2
    s_cbranch_scc1 L_chain2
    s_cmp_eq_u32 s52, 3
    s_cbranch_scc1 L_chain3
L_padretA:
    s_mov_b64 exec, -1
    v_mov_b32 v36, 0
    v_mov_b32 v37, 0
    s_waitcnt vmcnt(8)
    v_dot2c_f32_bf16 v36, s84, v140
    v_dot2c_f32_bf16 v37, v140, v140
    s_xor_b32 s87, s65, 1
    s_mul_i32 s87, s87, 9216
    s_add_u32 s87, s87, s83
    buffer_load_dwordx4 v[160:163], v1, s[24:27], s87 offen offset:0
    v_dot2c_f32_bf16 v36, s84, v141
    v_dot2c_f32_bf16 v37, v141, v141
    v_dot2c_f32_bf16 v36, s84, v142
    v_dot2c_f32_bf16 v37, v142, v142
    v_dot2c_f32_bf16 v36, s84, v143
    v_dot2c_f32_bf16 v37, v143, v143
    s_waitcnt vmcnt(8)
    v_dot2c_f32_bf16 v36, s84, v144
    v_dot2c_f32_bf16 v37, v144, v144
    buffer_load_dwordx4 v[164:167], v1, s[24:27], s87 offen offset:128
    v_dot2c_f32_bf16 v36, s84, v145
    v_dot2c_f32_bf16 v37, v145, v145
    v_dot2c_f32_bf16 v36, s84, v146
    v_dot2c_f32_bf16 v37, v146, v146
    v_dot2c_f32_bf16 v36, s84, v147
    v_dot2c_f32_bf16 v37, v147, v147
    s_waitcnt vmcnt(8)
    v_dot2c_f32_bf16 v36, s84, v148
    v_dot2c_f32_bf16 v37, v148, v148
    buffer_load_dwordx4 v[168:171], v1, s[24:27], s87 offen offset:256
    v_dot2c_f32_bf16 v36, s84, v149
    v_dot2c_f32_bf16 v37, v149, v149
    v_dot2c_f32_bf16 v36, s84, v150
    v_dot2c_f32_bf16 v37, v150, v150
    v_dot2c_f32_bf16 v36, s84, v151
    v_dot2c_f32_bf16 v37, v151, v151
    s_waitcnt vmcnt(8)
    v_dot2c_f32_bf16 v36, s84, v152
    v_dot2c_f32_bf16 v37, v152, v152
    buffer_load_dwordx4 v[172:175], v1, s[24:27], s87 offen offset:384
    v_dot2c_f32_bf16 v36, s84, v153
    v_dot2c_f32_bf16 v37, v153, v153
    v_dot2c_f32_bf16 v36, s84, v154
    v_dot2c_f32_bf16 v37, v154, v154
    v_dot2c_f32_bf16 v36, s84, v155
    v_dot2c_f32_bf16 v37, v155, v155
    s_waitcnt vmcnt(8)
    v_dot2c_f32_bf16 v36, s84, v156
    v_dot2c_f32_bf16 v37, v156, v156
    buffer_load_dwordx4 v[176:179], v1, s[24:27], s87 offen offset:512
    v_dot2c_f32_bf16 v36, s84, v157
    v_dot2c_f32_bf16 v37, v157, v157
    v_dot2c_f32_bf16 v36, s84, v158
    v_dot2c_f32_bf16 v37, v158, v158
    v_dot2c_f32_bf16 v36, s84, v159
    v_dot2c_f32_bf16 v37, v159, v159
    s_waitcnt vmcnt(8)
    v_dot2c_f32_bf16 v36, s84, v44
    v_dot2c_f32_bf16 v37, v44, v44
    buffer_load_dwordx4 v[48:51], v1, s[24:27], s87 offen offset:640
    v_dot2c_f32_bf16 v36, s84, v45
    v_dot2c_f32_bf16 v37, v45, v45
    v_dot2c_f32_bf16 v36, s84, v46
    v_dot2c_f32_bf16 v37, v46, v46
    v_dot2c_f32_bf16 v36, s84, v47
    v_dot2c_f32_bf16 v37, v47, v47
    s_waitcnt vmcnt(8)
    v_dot2c_f32_bf16 v36, s84, v60
    v_dot2c_f32_bf16 v37, v60, v60
    buffer_load_dwordx4 v[64:67], v1, s[24:27], s87 offen offset:768
    v_dot2c_f32_bf16 v36, s84, v61
    v_dot2c_f32_bf16 v37, v61, v61
    v_dot2c_f32_bf16 v36, s84, v62
    v_dot2c_f32_bf16 v37, v62, v62
    v_dot2c_f32_bf16 v36, s84, v63
    v_dot2c_f32_bf16 v37, v63, v63
    s_waitcnt vmcnt(8)
    v_dot2c_f32_bf16 v36, s84, v76
    v_dot2c_f32_bf16 v37, v76, v76
    buffer_load_dwordx4 v[80:83], v1, s[24:27], s87 offen offset:896
    v_dot2c_f32_bf16 v36, s84, v77
    v_dot2c_f32_bf16 v37, v77, v77
    v_dot2c_f32_bf16 v36, s84, v78
    v_dot2c_f32_bf16 v37, v78, v78
    v_dot2c_f32_bf16 v36, s84, v79
    v_dot2c_f32_bf16 v37, v79, v79
    s_waitcnt vmcnt(8)
    v_dot2c_f32_bf16 v36, s84, v92
    v_dot2c_f32_bf16 v37, v92, v92
    buffer_load_dwordx4 v[96:99], v1, s[24:27], s87 offen offset:1024
    v_dot2c_f32_bf16 v36, s84, v93
    v_dot2c_f32_bf16 v37, v93, v93
    v_dot2c_f32_bf16 v36, s84, v94
    v_dot2c_f32_bf16 v37, v94, v94
    v_dot2c_f32_bf16 v36, s84, v95
    v_dot2c_f32_bf16 v37, v95, v95
    s_nop 1
    v_add_f32_dpp v36, v36, v36 quad_perm:[1,0,3,2] row_mask:0xf bank_mask:0xf
    v_add_f32_dpp v37, v37, v37 quad_perm:[1,0,3,2] row_mask:0xf bank_mask:0xf
    s_nop 0
    v_add_f32_dpp v36, v36, v36 quad_perm:[2,3,0,1] row_mask:0xf bank_mask:0xf
    v_add_f32_dpp v37, v37, v37 quad_perm:[2,3,0,1] row_mask:0xf bank_mask:0xf
    s_nop 0
    v_add_f32_dpp v36, v36, v36 row_half_mirror row_mask:0xf bank_mask:0xf
    v_add_f32_dpp v37, v37, v37 row_half_mirror row_mask:0xf bank_mask:0xf
    v_mul_f32 v36, 0x3ae38e39, v36
    v_mul_f32 v37, 0x3ae38e39, v37
    v_fma_f32 v37, -v36, v36, v37
    v_max_f32 v37, 0, v37
    v_cvt_pk_bf16_f32 v36, v36, v37
    v_lshlrev_b32 v38, 16, v36
    v_and_b32 v37, 0xffff0000, v36
    v_add_f32 v37, 0x3727c5ac, v37
    v_cvt_pk_bf16_f32 v37, v37, v37
    v_and_b32 v37, 0xffff0000, v37
    v_sqrt_f32 v37, v37
    s_nop 0
    v_cvt_pk_bf16_f32 v37, v37, v37
    v_and_b32 v37, 0xffff0000, v37
    v_rcp_f32 v40, v37
    s_nop 0
    v_mul_f32 v40, 0xbeeff558, v40
    v_mul_f32 v38, v38, v40
    v_sub_f32 v38, 0, v38
    v_lshlrev_b32 v236, 16, v140
    v_and_b32 v237, 0xffff0000, v140
    v_lshlrev_b32 v238, 16, v141
    v_and_b32 v239, 0xffff0000, v141
    v_lshlrev_b32 v240, 16, v142
    v_and_b32 v241, 0xffff0000, v142
    v_lshlrev_b32 v242, 16, v143
    v_and_b32 v243, 0xffff0000, v143
    v_pk_fma_f32 v[236:237], v[236:237], v[40:41], v[38:39] op_sel_hi:[1,0,0]
    v_pk_fma_f32 v[238:239], v[238:239], v[40:41], v[38:39] op_sel_hi:[1,0,0]
    v_pk_fma_f32 v[240:241], v[240:241], v[40:41], v[38:39] op_sel_hi:[1,0,0]
    v_pk_fma_f32 v[242:243], v[242:243], v[40:41], v[38:39] op_sel_hi:[1,0,0]
    v_cvt_pk_bf16_f32 v140, v236, v237
    v_cvt_pk_bf16_f32 v141, v238, v239
    v_cvt_pk_bf16_f32 v142, v240, v241
    v_cvt_pk_bf16_f32 v143, v242, v243
    ds_write_b128 v42, v[140:143] offset:0
    s_add_u32 m0, s55, 0
    s_add_u32 s70, s57, 0
    buffer_load_dwordx4 v8, s[36:39], s70 offen offset:0 lds
    v_lshlrev_b32 v244, 16, v144
    v_and_b32 v245, 0xffff0000, v144
    v_lshlrev_b32 v246, 16, v145
    v_and_b32 v247, 0xffff0000, v145
    v_lshlrev_b32 v248, 16, v146
    v_and_b32 v249, 0xffff0000, v146
    v_lshlrev_b32 v250, 16, v147
    v_and_b32 v251, 0xffff0000, v147
    v_pk_fma_f32 v[244:245], v[244:245], v[40:41], v[38:39] op_sel_hi:[1,0,0]
    v_pk_fma_f32 v[246:247], v[246:247], v[40:41], v[38:39] op_sel_hi:[1,0,0]
    v_pk_fma_f32 v[248:249], v[248:249], v[40:41], v[38:39] op_sel_hi:[1,0,0]
    v_pk_fma_f32 v[250:251], v[250:251], v[40:41], v[38:39] op_sel_hi:[1,0,0]
    v_cvt_pk_bf16_f32 v144, v244, v245
    v_cvt_pk_bf16_f32 v145, v246, v247
    v_cvt_pk_bf16_f32 v146, v248, v249
    v_cvt_pk_bf16_f32 v147, v250, v251
    ds_write_b128 v42, v[144:147] offset:4096
    v_lshlrev_b32 v236, 16, v148
    v_and_b32 v237, 0xffff0000, v148
    v_lshlrev_b32 v238, 16, v149
    v_and_b32 v239, 0xffff0000, v149
    v_lshlrev_b32 v240, 16, v150
    v_and_b32 v241, 0xffff0000, v150
    v_lshlrev_b32 v242, 16, v151
    v_and_b32 v243, 0xffff0000, v151
    v_pk_fma_f32 v[236:237], v[236:237], v[40:41], v[38:39] op_sel_hi:[1,0,0]
    v_pk_fma_f32 v[238:239], v[238:239], v[40:41], v[38:39] op_sel_hi:[1,0,0]
    v_pk_fma_f32 v[240:241], v[240:241], v[40:41], v[38:39] op_sel_hi:[1,0,0]
    v_pk_fma_f32 v[242:243], v[242:243], v[40:41], v[38:39] op_sel_hi:[1,0,0]
    v_cvt_pk_bf16_f32 v148, v236, v237
    v_cvt_pk_bf16_f32 v149, v238, v239
    v_cvt_pk_bf16_f32 v150, v240, v241
    v_cvt_pk_bf16_f32 v151, v242, v243
    ds_write_b128 v42, v[148:151] offset:8192
    s_sub_u32 s71, s57, 1024
    buffer_load_dwordx4 v8, s[40:43], s71 offen offset:1024 lds
    v_lshlrev_b32 v244, 16, v152
    v_and_b32 v245, 0xffff0000, v152
    v_lshlrev_b32 v246, 16, v153
    v_and_b32 v247, 0xffff0000, v153
    v_lshlrev_b32 v248, 16, v154
    v_and_b32 v249, 0xffff0000, v154
    v_lshlrev_b32 v250, 16, v155
    v_and_b32 v251, 0xffff0000, v155
    v_pk_fma_f32 v[244:245], v[244:245], v[40:41], v[38:39] op_sel_hi:[1,0,0]
    v_pk_fma_f32 v[246:247], v[246:247], v[40:41], v[38:39] op_sel_hi:[1,0,0]
    v_pk_fma_f32 v[248:249], v[248:249], v[40:41], v[38:39] op_sel_hi:[1,0,0]
    v_pk_fma_f32 v[250:251], v[250:251], v[40:41], v[38:39] op_sel_hi:[1,0,0]
    v_cvt_pk_bf16_f32 v152, v244, v245
    v_cvt_pk_bf16_f32 v153, v246, v247
    v_cvt_pk_bf16_f32 v154, v248, v249
    v_cvt_pk_bf16_f32 v155, v250, v251
    ds_write_b128 v42, v[152:155] offset:12288
    v_lshlrev_b32 v236, 16, v156
    v_and_b32 v237, 0xffff0000, v156
    v_lshlrev_b32 v238, 16, v157
    v_and_b32 v239, 0xffff0000, v157
    v_lshlrev_b32 v240, 16, v158
    v_and_b32 v241, 0xffff0000, v158
    v_lshlrev_b32 v242, 16, v159
    v_and_b32 v243, 0xffff0000, v159
    v_pk_fma_f32 v[236:237], v[236:237], v[40:41], v[38:39] op_sel_hi:[1,0,0]
    v_pk_fma_f32 v[238:239], v[238:239], v[40:41], v[38:39] op_sel_hi:[1,0,0]
    v_pk_fma_f32 v[240:241], v[240:241], v[40:41], v[38:39] op_sel_hi:[1,0,0]
    v_pk_fma_f32 v[242:243], v[242:243], v[40:41], v[38:39] op_sel_hi:[1,0,0]
    v_cvt_pk_bf16_f32 v156, v236, v237
    v_cvt_pk_bf16_f32 v157, v238, v239
    v_cvt_pk_bf16_f32 v158, v240, v241
    v_cvt_pk_bf16_f32 v159, v242, v243
    ds_write_b128 v42, v[156:159] offset:16384
    s_add_u32 s72, s57, 292864
    buffer_load_dwordx4 v8, s[36:39], s72 offen offset:2048 lds
    v_lshlrev_b32 v244, 16, v44
    v_and_b32 v245, 0xffff0000, v44
    v_lshlrev_b32 v246, 16, v45
    v_and_b32 v247, 0xffff0000, v45
    v_lshlrev_b32 v248, 16, v46
    v_and_b32 v249, 0xffff0000, v46
    v_lshlrev_b32 v250, 16, v47
    v_and_b32 v251, 0xffff0000, v47
    v_pk_fma_f32 v[244:245], v[244:245], v[40:41], v[38:39] op_sel_hi:[1,0,0]
    v_pk_fma_f32 v[246:247], v[246:247], v[40:41], v[38:39] op_sel_hi:[1,0,0]
    v_pk_fma_f32 v[248:249], v[248:249], v[40:41], v[38:39] op_sel_hi:[1,0,0]
    v_pk_fma_f32 v[250:251], v[250:251], v[40:41], v[38:39] op_sel_hi:[1,0,0]
    v_cvt_pk_bf16_f32 v44, v244, v245
    v_cvt_pk_bf16_f32 v45, v246, v247
    v_cvt_pk_bf16_f32 v46, v248, v249
    v_cvt_pk_bf16_f32 v47, v250, v251
    v_lshlrev_b32 v236, 16, v60
    v_and_b32 v237, 0xffff0000, v60
    v_lshlrev_b32 v238, 16, v61
    v_and_b32 v239, 0xffff0000, v61
    v_lshlrev_b32 v240, 16, v62
    v_and_b32 v241, 0xffff0000, v62
    v_lshlrev_b32 v242, 16, v63
    v_and_b32 v243, 0xffff0000, v63
    v_pk_fma_f32 v[236:237], v[236:237], v[40:41], v[38:39] op_sel_hi:[1,0,0]
    v_pk_fma_f32 v[238:239], v[238:239], v[40:41], v[38:39] op_sel_hi:[1,0,0]
    v_pk_fma_f32 v[240:241], v[240:241], v[40:41], v[38:39] op_sel_hi:[1,0,0]
    v_pk_fma_f32 v[242:243], v[242:243], v[40:41], v[38:39] op_sel_hi:[1,0,0]
    v_cvt_pk_bf16_f32 v60, v236, v237
    v_cvt_pk_bf16_f32 v61, v238, v239
    v_cvt_pk_bf16_f32 v62, v240, v241
    v_cvt_pk_bf16_f32 v63, v242, v243
    s_add_u32 s73, s57, 291840
    buffer_load_dwordx4 v8, s[40:43], s73 offen offset:3072 lds
    v_lshlrev_b32 v244, 16, v76
    v_and_b32 v245, 0xffff0000, v76
    v_lshlrev_b32 v246, 16, v77
    v_and_b32 v247, 0xffff0000, v77
    v_lshlrev_b32 v248, 16, v78
    v_and_b32 v249, 0xffff0000, v78
    v_lshlrev_b32 v250, 16, v79
    v_and_b32 v251, 0xffff0000, v79
    v_pk_fma_f32 v[244:245], v[244:245], v[40:41], v[38:39] op_sel_hi:[1,0,0]
    v_pk_fma_f32 v[246:247], v[246:247], v[40:41], v[38:39] op_sel_hi:[1,0,0]
    v_pk_fma_f32 v[248:249], v[248:249], v[40:41], v[38:39] op_sel_hi:[1,0,0]
    v_pk_fma_f32 v[250:251], v[250:251], v[40:41], v[38:39] op_sel_hi:[1,0,0]
    v_cvt_pk_bf16_f32 v76, v244, v245
    v_cvt_pk_bf16_f32 v77, v246, v247
    v_cvt_pk_bf16_f32 v78, v248, v249
    v_cvt_pk_bf16_f32 v79, v250, v251
    v_lshlrev_b32 v236, 16, v92
    v_and_b32 v237, 0xffff0000, v92
    v_lshlrev_b32 v238, 16, v93
    v_and_b32 v239, 0xffff0000, v93
    v_lshlrev_b32 v240, 16, v94
    v_and_b32 v241, 0xffff0000, v94
    v_lshlrev_b32 v242, 16, v95
    v_and_b32 v243, 0xffff0000, v95
    v_pk_fma_f32 v[236:237], v[236:237], v[40:41], v[38:39] op_sel_hi:[1,0,0]
    v_pk_fma_f32 v[238:239], v[238:239], v[40:41], v[38:39] op_sel_hi:[1,0,0]
    v_pk_fma_f32 v[240:241], v[240:241], v[40:41], v[38:39] op_sel_hi:[1,0,0]
    v_pk_fma_f32 v[242:243], v[242:243], v[40:41], v[38:39] op_sel_hi:[1,0,0]
    v_cvt_pk_bf16_f32 v92, v236, v237
    v_cvt_pk_bf16_f32 v93, v238, v239
    v_cvt_pk_bf16_f32 v94, v240, v241
    v_cvt_pk_bf16_f32 v95, v242, v243
    s_add_u32 m0, s55, 16384
    s_add_u32 s70, s57, 589824
    buffer_load_dwordx4 v8, s[36:39], s70 offen offset:0 lds
    v_mov_b32 v36, 0
    v_mov_b32 v37, 0
    s_waitcnt vmcnt(13)
    v_dot2c_f32_bf16 v36, s84, v160
    v_dot2c_f32_bf16 v37, v160, v160
    s_xor_b32 s87, s65, 2
    s_mul_i32 s87, s87, 9216
    s_add_u32 s87, s87, s83
    buffer_load_dwordx4 v[180:183], v1, s[24:27], s87 offen offset:0
    v_dot2c_f32_bf16 v36, s84, v161
    v_dot2c_f32_bf16 v37, v161, v161
    v_dot2c_f32_bf16 v36, s84, v162
    v_dot2c_f32_bf16 v37, v162, v162
    v_dot2c_f32_bf16 v36, s84, v163
    v_dot2c_f32_bf16 v37, v163, v163
    s_waitcnt vmcnt(13)
    v_dot2c_f32_bf16 v36, s84, v164
    v_dot2c_f32_bf16 v37, v164, v164
    buffer_load_dwordx4 v[184:187], v1, s[24:27], s87 offen offset:128
    v_dot2c_f32_bf16 v36, s84, v165
    v_dot2c_f32_bf16 v37, v165, v165
    v_dot2c_f32_bf16 v36, s84, v166
    v_dot2c_f32_bf16 v37, v166, v166
    v_dot2c_f32_bf16 v36, s84, v167
    v_dot2c_f32_bf16 v37, v167, v167
    s_waitcnt vmcnt(13)
    v_dot2c_f32_bf16 v36, s84, v168
    v_dot2c_f32_bf16 v37, v168, v168
    buffer_load_dwordx4 v[188:191], v1, s[24:27], s87 offen offset:256
    v_dot2c_f32_bf16 v36, s84, v169
    v_dot2c_f32_bf16 v37, v169, v169
    v_dot2c_f32_bf16 v36, s84, v170
    v_dot2c_f32_bf16 v37, v170, v170
    v_dot2c_f32_bf16 v36, s84, v171
    v_dot2c_f32_bf16 v37, v171, v171
    s_waitcnt vmcnt(13)
    v_dot2c_f32_bf16 v36, s84, v172
    v_dot2c_f32_bf16 v37, v172, v172
    buffer_load_dwordx4 v[192:195], v1, s[24:27], s87 offen offset:384
    v_dot2c_f32_bf16 v36, s84, v173
    v_dot2c_f32_bf16 v37, v173, v173
    v_dot2c_f32_bf16 v36, s84, v174
    v_dot2c_f32_bf16 v37, v174, v174
    v_dot2c_f32_bf16 v36, s84, v175
    v_dot2c_f32_bf16 v37, v175, v175
    s_waitcnt vmcnt(13)
    v_dot2c_f32_bf16 v36, s84, v176
    v_dot2c_f32_bf16 v37, v176, v176
    buffer_load_dwordx4 v[196:199], v1, s[24:27], s87 offen offset:512
    v_dot2c_f32_bf16 v36, s84, v177
    v_dot2c_f32_bf16 v37, v177, v177
    v_dot2c_f32_bf16 v36, s84, v178
    v_dot2c_f32_bf16 v37, v178, v178
    v_dot2c_f32_bf16 v36, s84, v179
    v_dot2c_f32_bf16 v37, v179, v179
    s_waitcnt vmcnt(13)
    v_dot2c_f32_bf16 v36, s84, v48
    v_dot2c_f32_bf16 v37, v48, v48
    buffer_load_dwordx4 v[52:55], v1, s[24:27], s87 offen offset:640
    v_dot2c_f32_bf16 v36, s84, v49
    v_dot2c_f32_bf16 v37, v49, v49
    v_dot2c_f32_bf16 v36, s84, v50
    v_dot2c_f32_bf16 v37, v50, v50
    v_dot2c_f32_bf16 v36, s84, v51
    v_dot2c_f32_bf16 v37, v51, v51
    s_waitcnt vmcnt(13)
    v_dot2c_f32_bf16 v36, s84, v64
    v_dot2c_f32_bf16 v37, v64, v64
    buffer_load_dwordx4 v[68:71], v1, s[24:27], s87 offen offset:768
    v_dot2c_f32_bf16 v36, s84, v65
    v_dot2c_f32_bf16 v37, v65, v65
    v_dot2c_f32_bf16 v36, s84, v66
    v_dot2c_f32_bf16 v37, v66, v66
    v_dot2c_f32_bf16 v36, s84, v67
    v_dot2c_f32_bf16 v37, v67, v67
    s_waitcnt vmcnt(13)
    v_dot2c_f32_bf16 v36, s84, v80
    v_dot2c_f32_bf16 v37, v80, v80
    buffer_load_dwordx4 v[84:87], v1, s[24:27], s87 offen offset:896
    v_dot2c_f32_bf16 v36, s84, v81
    v_dot2c_f32_bf16 v37, v81, v81
    v_dot2c_f32_bf16 v36, s84, v82
    v_dot2c_f32_bf16 v37, v82, v82
    v_dot2c_f32_bf16 v36, s84, v83
    v_dot2c_f32_bf16 v37, v83, v83
    s_waitcnt vmcnt(13)
    v_dot2c_f32_bf16 v36, s84, v96
    v_dot2c_f32_bf16 v37, v96, v96
    buffer_load_dwordx4 v[100:103], v1, s[24:27], s87 offen offset:1024
    v_dot2c_f32_bf16 v36, s84, v97
    v_dot2c_f32_bf16 v37, v97, v97
    v_dot2c_f32_bf16 v36, s84, v98
    v_dot2c_f32_bf16 v37, v98, v98
    v_dot2c_f32_bf16 v36, s84, v99
    v_dot2c_f32_bf16 v37, v99, v99
    s_nop 1
    v_add_f32_dpp v36, v36, v36 quad_perm:[1,0,3,2] row_mask:0xf bank_mask:0xf
    v_add_f32_dpp v37, v37, v37 quad_perm:[1,0,3,2] row_mask:0xf bank_mask:0xf
    s_nop 0
    v_add_f32_dpp v36, v36, v36 quad_perm:[2,3,0,1] row_mask:0xf bank_mask:0xf
    v_add_f32_dpp v37, v37, v37 quad_perm:[2,3,0,1] row_mask:0xf bank_mask:0xf
    s_nop 0
    v_add_f32_dpp v36, v36, v36 row_half_mirror row_mask:0xf bank_mask:0xf
    v_add_f32_dpp v37, v37, v37 row_half_mirror row_mask:0xf bank_mask:0xf
    v_mul_f32 v36, 0x3ae38e39, v36
    v_mul_f32 v37, 0x3ae38e39, v37
    v_fma_f32 v37, -v36, v36, v37
    v_max_f32 v37, 0, v37
    v_cvt_pk_bf16_f32 v36, v36, v37
    v_lshlrev_b32 v38, 16, v36
    v_and_b32 v37, 0xffff0000, v36
    v_add_f32 v37, 0x3727c5ac, v37
    v_cvt_pk_bf16_f32 v37, v37, v37
    v_and_b32 v37, 0xffff0000, v37
    v_sqrt_f32 v37, v37
    s_nop 0
    v_cvt_pk_bf16_f32 v37, v37, v37
    v_and_b32 v37, 0xffff0000, v37
    v_rcp_f32 v40, v37
    s_nop 0
    v_mul_f32 v40, 0xbeeff558, v40
    v_mul_f32 v38, v38, v40
    v_sub_f32 v38, 0, v38
    v_lshlrev_b32 v236, 16, v160
    v_and_b32 v237, 0xffff0000, v160
    v_lshlrev_b32 v238, 16, v161
    v_and_b32 v239, 0xffff0000, v161
    v_lshlrev_b32 v240, 16, v162
    v_and_b32 v241, 0xffff0000, v162
    v_lshlrev_b32 v242, 16, v163
    v_and_b32 v243, 0xffff0000, v163
    v_pk_fma_f32 v[236:237], v[236:237], v[40:41], v[38:39] op_sel_hi:[1,0,0]
    v_pk_fma_f32 v[238:239], v[238:239], v[40:41], v[38:39] op_sel_hi:[1,0,0]
    v_pk_fma_f32 v[240:241], v[240:241], v[40:41], v[38:39] op_sel_hi:[1,0,0]
    v_pk_fma_f32 v[242:243], v[242:243], v[40:41], v[38:39] op_sel_hi:[1,0,0]
    v_cvt_pk_bf16_f32 v160, v236, v237
    v_cvt_pk_bf16_f32 v161, v238, v239
    v_cvt_pk_bf16_f32 v162, v240, v241
    v_cvt_pk_bf16_f32 v163, v242, v243
    ds_write_b128 v43, v[160:163] offset:0
    s_add_u32 s71, s57, 588800
    buffer_load_dwordx4 v8, s[40:43], s71 offen offset:1024 lds
    v_lshlrev_b32 v244, 16, v164
    v_and_b32 v245, 0xffff0000, v164
    v_lshlrev_b32 v246, 16, v165
    v_and_b32 v247, 0xffff0000, v165
    v_lshlrev_b32 v248, 16, v166
    v_and_b32 v249, 0xffff0000, v166
    v_lshlrev_b32 v250, 16, v167
    v_and_b32 v251, 0xffff0000, v167
    v_pk_fma_f32 v[244:245], v[244:245], v[40:41], v[38:39] op_sel_hi:[1,0,0]
    v_pk_fma_f32 v[246:247], v[246:247], v[40:41], v[38:39] op_sel_hi:[1,0,0]
    v_pk_fma_f32 v[248:249], v[248:249], v[40:41], v[38:39] op_sel_hi:[1,0,0]
    v_pk_fma_f32 v[250:251], v[250:251], v[40:41], v[38:39] op_sel_hi:[1,0,0]
    v_cvt_pk_bf16_f32 v164, v244, v245
    v_cvt_pk_bf16_f32 v165, v246, v247
    v_cvt_pk_bf16_f32 v166, v248, v249
    v_cvt_pk_bf16_f32 v167, v250, v251
    ds_write_b128 v43, v[164:167] offset:4096
    v_lshlrev_b32 v236, 16, v168
    v_and_b32 v237, 0xffff0000, v168
    v_lshlrev_b32 v238, 16, v169
    v_and_b32 v239, 0xffff0000, v169
    v_lshlrev_b32 v240, 16, v170
    v_and_b32 v241, 0xffff0000, v170
    v_lshlrev_b32 v242, 16, v171
    v_and_b32 v243, 0xffff0000, v171
    v_pk_fma_f32 v[236:237], v[236:237], v[40:41], v[38:39] op_sel_hi:[1,0,0]
    v_pk_fma_f32 v[238:239], v[238:239], v[40:41], v[38:39] op_sel_hi:[1,0,0]
    v_pk_fma_f32 v[240:241], v[240:241], v[40:41], v[38:39] op_sel_hi:[1,0,0]
    v_pk_fma_f32 v[242:243], v[242:243], v[40:41], v[38:39] op_sel_hi:[1,0,0]
    v_cvt_pk_bf16_f32 v168, v236, v237
    v_cvt_pk_bf16_f32 v169, v238, v239
    v_cvt_pk_bf16_f32 v170, v240, v241
    v_cvt_pk_bf16_f32 v171, v242, v243
    ds_write_b128 v43, v[168:171] offset:8192
    s_add_u32 s72, s57, 882688
    buffer_load_dwordx4 v8, s[36:39], s72 offen offset:2048 lds
    v_lshlrev_b32 v244, 16, v172
    v_and_b32 v245, 0xffff0000, v172
    v_lshlrev_b32 v246, 16, v173
    v_and_b32 v247, 0xffff0000, v173
    v_lshlrev_b32 v248, 16, v174
    v_and_b32 v249, 0xffff0000, v174
    v_lshlrev_b32 v250, 16, v175
    v_and_b32 v251, 0xffff0000, v175
    v_pk_fma_f32 v[244:245], v[244:245], v[40:41], v[38:39] op_sel_hi:[1,0,0]
    v_pk_fma_f32 v[246:247], v[246:247], v[40:41], v[38:39] op_sel_hi:[1,0,0]
    v_pk_fma_f32 v[248:249], v[248:249], v[40:41], v[38:39] op_sel_hi:[1,0,0]
    v_pk_fma_f32 v[250:251], v[250:251], v[40:41], v[38:39] op_sel_hi:[1,0,0]
    v_cvt_pk_bf16_f32 v172, v244, v245
    v_cvt_pk_bf16_f32 v173, v246, v247
    v_cvt_pk_bf16_f32 v174, v248, v249
    v_cvt_pk_bf16_f32 v175, v250, v251
    ds_write_b128 v43, v[172:175] offset:12288
    v_lshlrev_b32 v236, 16, v176
    v_and_b32 v237, 0xffff0000, v176
    v_lshlrev_b32 v238, 16, v177
    v_and_b32 v239, 0xffff0000, v177
    v_lshlrev_b32 v240, 16, v178
    v_and_b32 v241, 0xffff0000, v178
    v_lshlrev_b32 v242, 16, v179
    v_and_b32 v243, 0xffff0000, v179
    v_pk_fma_f32 v[236:237], v[236:237], v[40:41], v[38:39] op_sel_hi:[1,0,0]
    v_pk_fma_f32 v[238:239], v[238:239], v[40:41], v[38:39] op_sel_hi:[1,0,0]
    v_pk_fma_f32 v[240:241], v[240:241], v[40:41], v[38:39] op_sel_hi:[1,0,0]
    v_pk_fma_f32 v[242:243], v[242:243], v[40:41], v[38:39] op_sel_hi:[1,0,0]
    v_cvt_pk_bf16_f32 v176, v236, v237
    v_cvt_pk_bf16_f32 v177, v238, v239
    v_cvt_pk_bf16_f32 v178, v240, v241
    v_cvt_pk_bf16_f32 v179, v242, v243
    ds_write_b128 v43, v[176:179] offset:16384
    s_add_u32 s73, s57, 881664
    buffer_load_dwordx4 v8, s[40:43], s73 offen offset:3072 lds
    v_lshlrev_b32 v244, 16, v48
    v_and_b32 v245, 0xffff0000, v48
    v_lshlrev_b32 v246, 16, v49
    v_and_b32 v247, 0xffff0000, v49
    v_lshlrev_b32 v248, 16, v50
    v_and_b32 v249, 0xffff0000, v50
    v_lshlrev_b32 v250, 16, v51
    v_and_b32 v251, 0xffff0000, v51
    v_pk_fma_f32 v[244:245], v[244:245], v[40:41], v[38:39] op_sel_hi:[1,0,0]
    v_pk_fma_f32 v[246:247], v[246:247], v[40:41], v[38:39] op_sel_hi:[1,0,0]
    v_pk_fma_f32 v[248:249], v[248:249], v[40:41], v[38:39] op_sel_hi:[1,0,0]
    v_pk_fma_f32 v[250:251], v[250:251], v[40:41], v[38:39] op_sel_hi:[1,0,0]
    v_cvt_pk_bf16_f32 v48, v244, v245
    v_cvt_pk_bf16_f32 v49, v246, v247
    v_cvt_pk_bf16_f32 v50, v248, v249
    v_cvt_pk_bf16_f32 v51, v250, v251
    v_lshlrev_b32 v236, 16, v64
    v_and_b32 v237, 0xffff0000, v64
    v_lshlrev_b32 v238, 16, v65
    v_and_b32 v239, 0xffff0000, v65
    v_lshlrev_b32 v240, 16, v66
    v_and_b32 v241, 0xffff0000, v66
    v_lshlrev_b32 v242, 16, v67
    v_and_b32 v243, 0xffff0000, v67
    v_pk_fma_f32 v[236:237], v[236:237], v[40:41], v[38:39] op_sel_hi:[1,0,0]
    v_pk_fma_f32 v[238:239], v[238:239], v[40:41], v[38:39] op_sel_hi:[1,0,0]
    v_pk_fma_f32 v[240:241], v[240:241], v[40:41], v[38:39] op_sel_hi:[1,0,0]
    v_pk_fma_f32 v[242:243], v[242:243], v[40:41], v[38:39] op_sel_hi:[1,0,0]
    v_cvt_pk_bf16_f32 v64, v236, v237
    v_cvt_pk_bf16_f32 v65, v238, v239
    v_cvt_pk_bf16_f32 v66, v240, v241
    v_cvt_pk_bf16_f32 v67, v242, v243
    s_add_u32 m0, s55, 32768
    s_add_u32 s70, s57, 1179648
    buffer_load_dwordx4 v8, s[36:39], s70 offen offset:0 lds
    v_lshlrev_b32 v244, 16, v80
    v_and_b32 v245, 0xffff0000, v80
    v_lshlrev_b32 v246, 16, v81
    v_and_b32 v247, 0xffff0000, v81
    v_lshlrev_b32 v248, 16, v82
    v_and_b32 v249, 0xffff0000, v82
    v_lshlrev_b32 v250, 16, v83
    v_and_b32 v251, 0xffff0000, v83
    v_pk_fma_f32 v[244:245], v[244:245], v[40:41], v[38:39] op_sel_hi:[1,0,0]
    v_pk_fma_f32 v[246:247], v[246:247], v[40:41], v[38:39] op_sel_hi:[1,0,0]
    v_pk_fma_f32 v[248:249], v[248:249], v[40:41], v[38:39] op_sel_hi:[1,0,0]
    v_pk_fma_f32 v[250:251], v[250:251], v[40:41], v[38:39] op_sel_hi:[1,0,0]
    v_cvt_pk_bf16_f32 v80, v244, v245
    v_cvt_pk_bf16_f32 v81, v246, v247
    v_cvt_pk_bf16_f32 v82, v248, v249
    v_cvt_pk_bf16_f32 v83, v250, v251
    v_lshlrev_b32 v236, 16, v96
    v_and_b32 v237, 0xffff0000, v96
    v_lshlrev_b32 v238, 16, v97
    v_and_b32 v239, 0xffff0000, v97
    v_lshlrev_b32 v240, 16, v98
    v_and_b32 v241, 0xffff0000, v98
    v_lshlrev_b32 v242, 16, v99
    v_and_b32 v243, 0xffff0000, v99
    v_pk_fma_f32 v[236:237], v[236:237], v[40:41], v[38:39] op_sel_hi:[1,0,0]
    v_pk_fma_f32 v[238:239], v[238:239], v[40:41], v[38:39] op_sel_hi:[1,0,0]
    v_pk_fma_f32 v[240:241], v[240:241], v[40:41], v[38:39] op_sel_hi:[1,0,0]
    v_pk_fma_f32 v[242:243], v[242:243], v[40:41], v[38:39] op_sel_hi:[1,0,0]
    v_cvt_pk_bf16_f32 v96, v236, v237
    v_cvt_pk_bf16_f32 v97, v238, v239
    v_cvt_pk_bf16_f32 v98, v240, v241
    v_cvt_pk_bf16_f32 v99, v242, v243
    s_add_u32 s71, s57, 1178624
    buffer_load_dwordx4 v8, s[40:43], s71 offen offset:1024 lds
    v_mov_b32 v36, 0
    v_mov_b32 v37, 0
    s_waitcnt vmcnt(13)
    v_dot2c_f32_bf16 v36, s84, v180
    v_dot2c_f32_bf16 v37, v180, v180
    s_xor_b32 s87, s65, 3
    s_mul_i32 s87, s87, 9216
    s_add_u32 s87, s87, s83
    buffer_load_dwordx4 v[200:203], v1, s[24:27], s87 offen offset:0
    v_dot2c_f32_bf16 v36, s84, v181
    v_dot2c_f32_bf16 v37, v181, v181
    v_dot2c_f32_bf16 v36, s84, v182
    v_dot2c_f32_bf16 v37, v182, v182
    v_dot2c_f32_bf16 v36, s84, v183
    v_dot2c_f32_bf16 v37, v183, v183
    s_waitcnt vmcnt(13)
    v_dot2c_f32_bf16 v36, s84, v184
    v_dot2c_f32_bf16 v37, v184, v184
    buffer_load_dwordx4 v[108:111], v1, s[24:27], s87 offen offset:128
    v_dot2c_f32_bf16 v36, s84, v185
    v_dot2c_f32_bf16 v37, v185, v185
    v_dot2c_f32_bf16 v36, s84, v186
    v_dot2c_f32_bf16 v37, v186, v186
    v_dot2c_f32_bf16 v36, s84, v187
    v_dot2c_f32_bf16 v37, v187, v187
    s_waitcnt vmcnt(13)
    v_dot2c_f32_bf16 v36, s84, v188
    v_dot2c_f32_bf16 v37, v188, v188
    buffer_load_dwordx4 v[112:115], v1, s[24:27], s87 offen offset:256
    v_dot2c_f32_bf16 v36, s84, v189
    v_dot2c_f32_bf16 v37, v189, v189
    v_dot2c_f32_bf16 v36, s84, v190
    v_dot2c_f32_bf16 v37, v190, v190
    v_dot2c_f32_bf16 v36, s84, v191
    v_dot2c_f32_bf16 v37, v191, v191
    s_waitcnt vmcnt(13)
    v_dot2c_f32_bf16 v36, s84, v192
    v_dot2c_f32_bf16 v37, v192, v192
    buffer_load_dwordx4 v[116:119], v1, s[24:27], s87 offen offset:384
    v_dot2c_f32_bf16 v36, s84, v193
    v_dot2c_f32_bf16 v37, v193, v193
    v_dot2c_f32_bf16 v36, s84, v194
    v_dot2c_f32_bf16 v37, v194, v194
    v_dot2c_f32_bf16 v36, s84, v195
    v_dot2c_f32_bf16 v37, v195, v195
    s_waitcnt vmcnt(13)
    v_dot2c_f32_bf16 v36, s84, v196
    v_dot2c_f32_bf16 v37, v196, v196
    buffer_load_dwordx4 v[120:123], v1, s[24:27], s87 offen offset:512
    v_dot2c_f32_bf16 v36, s84, v197
    v_dot2c_f32_bf16 v37, v197, v197
    v_dot2c_f32_bf16 v36, s84, v198
    v_dot2c_f32_bf16 v37, v198, v198
    v_dot2c_f32_bf16 v36, s84, v199
    v_dot2c_f32_bf16 v37, v199, v199
    s_waitcnt vmcnt(13)
    v_dot2c_f32_bf16 v36, s84, v52
    v_dot2c_f32_bf16 v37, v52, v52
    buffer_load_dwordx4 v[56:59], v1, s[24:27], s87 offen offset:640
    v_dot2c_f32_bf16 v36, s84, v53
    v_dot2c_f32_bf16 v37, v53, v53
    v_dot2c_f32_bf16 v36, s84, v54
    v_dot2c_f32_bf16 v37, v54, v54
    v_dot2c_f32_bf16 v36, s84, v55
    v_dot2c_f32_bf16 v37, v55, v55
    s_waitcnt vmcnt(13)
    v_dot2c_f32_bf16 v36, s84, v68
    v_dot2c_f32_bf16 v37, v68, v68
    buffer_load_dwordx4 v[72:75], v1, s[24:27], s87 offen offset:768
    v_dot2c_f32_bf16 v36, s84, v69
    v_dot2c_f32_bf16 v37, v69, v69
    v_dot2c_f32_bf16 v36, s84, v70
    v_dot2c_f32_bf16 v37, v70, v70
    v_dot2c_f32_bf16 v36, s84, v71
    v_dot2c_f32_bf16 v37, v71, v71
    s_waitcnt vmcnt(13)
    v_dot2c_f32_bf16 v36, s84, v84
    v_dot2c_f32_bf16 v37, v84, v84
    buffer_load_dwordx4 v[88:91], v1, s[24:27], s87 offen offset:896
    v_dot2c_f32_bf16 v36, s84, v85
    v_dot2c_f32_bf16 v37, v85, v85
    v_dot2c_f32_bf16 v36, s84, v86
    v_dot2c_f32_bf16 v37, v86, v86
    v_dot2c_f32_bf16 v36, s84, v87
    v_dot2c_f32_bf16 v37, v87, v87
    s_waitcnt vmcnt(13)
    v_dot2c_f32_bf16 v36, s84, v100
    v_dot2c_f32_bf16 v37, v100, v100
    buffer_load_dwordx4 v[104:107], v1, s[24:27], s87 offen offset:1024
    v_dot2c_f32_bf16 v36, s84, v101
    v_dot2c_f32_bf16 v37, v101, v101
    v_dot2c_f32_bf16 v36, s84, v102
    v_dot2c_f32_bf16 v37, v102, v102
    v_dot2c_f32_bf16 v36, s84, v103
    v_dot2c_f32_bf16 v37, v103, v103
    s_nop 1
    v_add_f32_dpp v36, v36, v36 quad_perm:[1,0,3,2] row_mask:0xf bank_mask:0xf
    v_add_f32_dpp v37, v37, v37 quad_perm:[1,0,3,2] row_mask:0xf bank_mask:0xf
    s_nop 0
    v_add_f32_dpp v36, v36, v36 quad_perm:[2,3,0,1] row_mask:0xf bank_mask:0xf
    v_add_f32_dpp v37, v37, v37 quad_perm:[2,3,0,1] row_mask:0xf bank_mask:0xf
    s_nop 0
    v_add_f32_dpp v36, v36, v36 row_half_mirror row_mask:0xf bank_mask:0xf
    v_add_f32_dpp v37, v37, v37 row_half_mirror row_mask:0xf bank_mask:0xf
    v_mul_f32 v36, 0x3ae38e39, v36
    v_mul_f32 v37, 0x3ae38e39, v37
    v_fma_f32 v37, -v36, v36, v37
    v_max_f32 v37, 0, v37
    v_cvt_pk_bf16_f32 v36, v36, v37
    v_lshlrev_b32 v38, 16, v36
    v_and_b32 v37, 0xffff0000, v36
    v_add_f32 v37, 0x3727c5ac, v37
    v_cvt_pk_bf16_f32 v37, v37, v37
    v_and_b32 v37, 0xffff0000, v37
    v_sqrt_f32 v37, v37
    s_nop 0
    v_cvt_pk_bf16_f32 v37, v37, v37
    v_and_b32 v37, 0xffff0000, v37
    v_rcp_f32 v40, v37
    s_nop 0
    v_mul_f32 v40, 0xbeeff558, v40
    v_mul_f32 v38, v38, v40
    v_sub_f32 v38, 0, v38
    v_mov_b32 v34, v38
    v_mov_b32 v35, v40
    v_lshlrev_b32 v236, 16, v180
    v_and_b32 v237, 0xffff0000, v180
    v_lshlrev_b32 v238, 16, v181
    v_and_b32 v239, 0xffff0000, v181
    v_lshlrev_b32 v240, 16, v182
    v_and_b32 v241, 0xffff0000, v182
    v_lshlrev_b32 v242, 16, v183
    v_and_b32 v243, 0xffff0000, v183
    v_pk_fma_f32 v[236:237], v[236:237], v[40:41], v[38:39] op_sel_hi:[1,0,0]
    v_pk_fma_f32 v[238:239], v[238:239], v[40:41], v[38:39] op_sel_hi:[1,0,0]
    v_pk_fma_f32 v[240:241], v[240:241], v[40:41], v[38:39] op_sel_hi:[1,0,0]
    v_pk_fma_f32 v[242:243], v[242:243], v[40:41], v[38:39] op_sel_hi:[1,0,0]
    v_cvt_pk_bf16_f32 v180, v236, v237
    v_cvt_pk_bf16_f32 v181, v238, v239
    v_cvt_pk_bf16_f32 v182, v240, v241
    v_cvt_pk_bf16_f32 v183, v242, v243
    ds_write_b128 v42, v[180:183] offset:2048
    ds_read_b128 a[0:3], v28 offset:0
    ds_read_b128 a[4:7], v29 offset:1024
    s_add_u32 s72, s57, 1472512
    buffer_load_dwordx4 v8, s[36:39], s72 offen offset:2048 lds
    v_lshlrev_b32 v244, 16, v184
    v_and_b32 v245, 0xffff0000, v184
    v_lshlrev_b32 v246, 16, v185
    v_and_b32 v247, 0xffff0000, v185
    v_lshlrev_b32 v248, 16, v186
    v_and_b32 v249, 0xffff0000, v186
    v_lshlrev_b32 v250, 16, v187
    v_and_b32 v251, 0xffff0000, v187
    v_pk_fma_f32 v[244:245], v[244:245], v[40:41], v[38:39] op_sel_hi:[1,0,0]
    v_pk_fma_f32 v[246:247], v[246:247], v[40:41], v[38:39] op_sel_hi:[1,0,0]
    v_pk_fma_f32 v[248:249], v[248:249], v[40:41], v[38:39] op_sel_hi:[1,0,0]
    v_pk_fma_f32 v[250:251], v[250:251], v[40:41], v[38:39] op_sel_hi:[1,0,0]
    v_cvt_pk_bf16_f32 v184, v244, v245
    v_cvt_pk_bf16_f32 v185, v246, v247
    v_cvt_pk_bf16_f32 v186, v248, v249
    v_cvt_pk_bf16_f32 v187, v250, v251
    ds_write_b128 v42, v[184:187] offset:6144
    ds_read_b128 a[8:11], v28 offset:4096
    ds_read_b128 a[12:15], v29 offset:5120
    v_lshlrev_b32 v236, 16, v188
    v_and_b32 v237, 0xffff0000, v188
    v_lshlrev_b32 v238, 16, v189
    v_and_b32 v239, 0xffff0000, v189
    v_lshlrev_b32 v240, 16, v190
    v_and_b32 v241, 0xffff0000, v190
    v_lshlrev_b32 v242, 16, v191
    v_and_b32 v243, 0xffff0000, v191
    v_pk_fma_f32 v[236:237], v[236:237], v[40:41], v[38:39] op_sel_hi:[1,0,0]
    v_pk_fma_f32 v[238:239], v[238:239], v[40:41], v[38:39] op_sel_hi:[1,0,0]
    v_pk_fma_f32 v[240:241], v[240:241], v[40:41], v[38:39] op_sel_hi:[1,0,0]
    v_pk_fma_f32 v[242:243], v[242:243], v[40:41], v[38:39] op_sel_hi:[1,0,0]
    v_cvt_pk_bf16_f32 v188, v236, v237
    v_cvt_pk_bf16_f32 v189, v238, v239
    v_cvt_pk_bf16_f32 v190, v240, v241
    v_cvt_pk_bf16_f32 v191, v242, v243
    ds_write_b128 v42, v[188:191] offset:10240
    ds_read_b128 a[16:19], v28 offset:8192
    ds_read_b128 a[20:23], v29 offset:9216
    s_add_u32 s73, s57, 1471488
    buffer_load_dwordx4 v8, s[40:43], s73 offen offset:3072 lds
    v_lshlrev_b32 v244, 16, v192
    v_and_b32 v245, 0xffff0000, v192
    v_lshlrev_b32 v246, 16, v193
    v_and_b32 v247, 0xffff0000, v193
    v_lshlrev_b32 v248, 16, v194
    v_and_b32 v249, 0xffff0000, v194
    v_lshlrev_b32 v250, 16, v195
    v_and_b32 v251, 0xffff0000, v195
    v_pk_fma_f32 v[244:245], v[244:245], v[40:41], v[38:39] op_sel_hi:[1,0,0]
    v_pk_fma_f32 v[246:247], v[246:247], v[40:41], v[38:39] op_sel_hi:[1,0,0]
    v_pk_fma_f32 v[248:249], v[248:249], v[40:41], v[38:39] op_sel_hi:[1,0,0]
    v_pk_fma_f32 v[250:251], v[250:251], v[40:41], v[38:39] op_sel_hi:[1,0,0]
    v_cvt_pk_bf16_f32 v192, v244, v245
    v_cvt_pk_bf16_f32 v193, v246, v247
    v_cvt_pk_bf16_f32 v194, v248, v249
    v_cvt_pk_bf16_f32 v195, v250, v251
    ds_write_b128 v42, v[192:195] offset:14336
    ds_read_b128 a[24:27], v28 offset:12288
    ds_read_b128 a[28:31], v29 offset:13312
    v_lshlrev_b32 v236, 16, v196
    v_and_b32 v237, 0xffff0000, v196
    v_lshlrev_b32 v238, 16, v197
    v_and_b32 v239, 0xffff0000, v197
    v_lshlrev_b32 v240, 16, v198
    v_and_b32 v241, 0xffff0000, v198
    v_lshlrev_b32 v242, 16, v199
    v_and_b32 v243, 0xffff0000, v199
    v_pk_fma_f32 v[236:237], v[236:237], v[40:41], v[38:39] op_sel_hi:[1,0,0]
    v_pk_fma_f32 v[238:239], v[238:239], v[40:41], v[38:39] op_sel_hi:[1,0,0]
    v_pk_fma_f32 v[240:241], v[240:241], v[40:41], v[38:39] op_sel_hi:[1,0,0]
    v_pk_fma_f32 v[242:243], v[242:243], v[40:41], v[38:39] op_sel_hi:[1,0,0]
    v_cvt_pk_bf16_f32 v196, v236, v237
    v_cvt_pk_bf16_f32 v197, v238, v239
    v_cvt_pk_bf16_f32 v198, v240, v241
    v_cvt_pk_bf16_f32 v199, v242, v243
    ds_write_b128 v42, v[196:199] offset:18432
    ds_read_b128 a[32:35], v28 offset:16384
    ds_read_b128 a[36:39], v29 offset:17408
    s_add_u32 m0, s55, 49152
    s_add_u32 s70, s57, 1769472
    buffer_load_dwordx4 v8, s[36:39], s70 offen offset:0 lds
    v_mov_b32 v36, 0
    v_mov_b32 v37, 0
    s_waitcnt vmcnt(11)
    v_dot2c_f32_bf16 v36, s84, v200
    v_dot2c_f32_bf16 v37, v200, v200
    v_dot2c_f32_bf16 v36, s84, v201
    v_dot2c_f32_bf16 v37, v201, v201
    v_dot2c_f32_bf16 v36, s84, v202
    v_dot2c_f32_bf16 v37, v202, v202
    v_dot2c_f32_bf16 v36, s84, v203
    v_dot2c_f32_bf16 v37, v203, v203
    s_waitcnt vmcnt(10)
    v_dot2c_f32_bf16 v36, s84, v108
    v_dot2c_f32_bf16 v37, v108, v108
    v_dot2c_f32_bf16 v36, s84, v109
    v_dot2c_f32_bf16 v37, v109, v109
    v_dot2c_f32_bf16 v36, s84, v110
    v_dot2c_f32_bf16 v37, v110, v110
    v_dot2c_f32_bf16 v36, s84, v111
    v_dot2c_f32_bf16 v37, v111, v111
    s_waitcnt vmcnt(9)
    v_dot2c_f32_bf16 v36, s84, v112
    v_dot2c_f32_bf16 v37, v112, v112
    v_dot2c_f32_bf16 v36, s84, v113
    v_dot2c_f32_bf16 v37, v113, v113
    v_dot2c_f32_bf16 v36, s84, v114
    v_dot2c_f32_bf16 v37, v114, v114
    v_dot2c_f32_bf16 v36, s84, v115
    v_dot2c_f32_bf16 v37, v115, v115
    s_waitcnt vmcnt(8)
    v_dot2c_f32_bf16 v36, s84, v116
    v_dot2c_f32_bf16 v37, v116, v116
    s_add_u32 s71, s57, 1768448
    buffer_load_dwordx4 v8, s[40:43], s71 offen offset:1024 lds
    v_dot2c_f32_bf16 v36, s84, v117
    v_dot2c_f32_bf16 v37, v117, v117
    v_dot2c_f32_bf16 v36, s84, v118
    v_dot2c_f32_bf16 v37, v118, v118
    v_dot2c_f32_bf16 v36, s84, v119
    v_dot2c_f32_bf16 v37, v119, v119
    s_waitcnt vmcnt(8)
    v_dot2c_f32_bf16 v36, s84, v120
    v_dot2c_f32_bf16 v37, v120, v120
    v_dot2c_f32_bf16 v36, s84, v121
    v_dot2c_f32_bf16 v37, v121, v121
    v_dot2c_f32_bf16 v36, s84, v122
    v_dot2c_f32_bf16 v37, v122, v122
    v_dot2c_f32_bf16 v36, s84, v123
    v_dot2c_f32_bf16 v37, v123, v123
    s_waitcnt vmcnt(7)
    v_dot2c_f32_bf16 v36, s84, v56
    v_dot2c_f32_bf16 v37, v56, v56
    v_dot2c_f32_bf16 v36, s84, v57
    v_dot2c_f32_bf16 v37, v57, v57
    v_dot2c_f32_bf16 v36, s84, v58
    v_dot2c_f32_bf16 v37, v58, v58
    v_dot2c_f32_bf16 v36, s84, v59
    v_dot2c_f32_bf16 v37, v59, v59
    s_waitcnt vmcnt(6)
    v_dot2c_f32_bf16 v36, s84, v72
    v_dot2c_f32_bf16 v37, v72, v72
    v_dot2c_f32_bf16 v36, s84, v73
    v_dot2c_f32_bf16 v37, v73, v73
    v_dot2c_f32_bf16 v36, s84, v74
    v_dot2c_f32_bf16 v37, v74, v74
    v_dot2c_f32_bf16 v36, s84, v75
    v_dot2c_f32_bf16 v37, v75, v75
    s_waitcnt vmcnt(5)
    v_dot2c_f32_bf16 v36, s84, v88
    v_dot2c_f32_bf16 v37, v88, v88
    s_add_u32 s72, s57, 2062336
    buffer_load_dwordx4 v8, s[36:39], s72 offen offset:2048 lds
    v_dot2c_f32_bf16 v36, s84, v89
    v_dot2c_f32_bf16 v37, v89, v89
    v_dot2c_f32_bf16 v36, s84, v90
    v_dot2c_f32_bf16 v37, v90, v90
    v_dot2c_f32_bf16 v36, s84, v91
    v_dot2c_f32_bf16 v37, v91, v91
    s_waitcnt vmcnt(5)
    v_dot2c_f32_bf16 v36, s84, v104
    v_dot2c_f32_bf16 v37, v104, v104
    v_dot2c_f32_bf16 v36, s84, v105
    v_dot2c_f32_bf16 v37, v105, v105
    v_dot2c_f32_bf16 v36, s84, v106
    v_dot2c_f32_bf16 v37, v106, v106
    v_dot2c_f32_bf16 v36, s84, v107
    v_dot2c_f32_bf16 v37, v107, v107
    s_nop 1
    v_add_f32_dpp v36, v36, v36 quad_perm:[1,0,3,2] row_mask:0xf bank_mask:0xf
    v_add_f32_dpp v37, v37, v37 quad_perm:[1,0,3,2] row_mask:0xf bank_mask:0xf
    s_nop 0
    v_add_f32_dpp v36, v36, v36 quad_perm:[2,3,0,1] row_mask:0xf bank_mask:0xf
    v_add_f32_dpp v37, v37, v37 quad_perm:[2,3,0,1] row_mask:0xf bank_mask:0xf
    s_nop 0
    v_add_f32_dpp v36, v36, v36 row_half_mirror row_mask:0xf bank_mask:0xf
    v_add_f32_dpp v37, v37, v37 row_half_mirror row_mask:0xf bank_mask:0xf
    v_mul_f32 v36, 0x3ae38e39, v36
    v_mul_f32 v37, 0x3ae38e39, v37
    v_fma_f32 v37, -v36, v36, v37
    v_max_f32 v37, 0, v37
    v_cvt_pk_bf16_f32 v36, v36, v37
    v_lshlrev_b32 v38, 16, v36
    v_and_b32 v37, 0xffff0000, v36
    v_add_f32 v37, 0x3727c5ac, v37
    v_cvt_pk_bf16_f32 v37, v37, v37
    v_and_b32 v37, 0xffff0000, v37
    v_sqrt_f32 v37, v37
    s_nop 0
    v_cvt_pk_bf16_f32 v37, v37, v37
    v_and_b32 v37, 0xffff0000, v37
    v_rcp_f32 v40, v37
    s_nop 0
    v_mul_f32 v40, 0xbeeff558, v40
    v_mul_f32 v38, v38, v40
    v_sub_f32 v38, 0, v38
    v_lshlrev_b32 v236, 16, v200
    v_and_b32 v237, 0xffff0000, v200
    v_lshlrev_b32 v238, 16, v201
    v_and_b32 v239, 0xffff0000, v201
    v_lshlrev_b32 v240, 16, v202
    v_and_b32 v241, 0xffff0000, v202
    v_lshlrev_b32 v242, 16, v203
    v_and_b32 v243, 0xffff0000, v203
    v_pk_fma_f32 v[236:237], v[236:237], v[40:41], v[38:39] op_sel_hi:[1,0,0]
    v_pk_fma_f32 v[238:239], v[238:239], v[40:41], v[38:39] op_sel_hi:[1,0,0]
    v_pk_fma_f32 v[240:241], v[240:241], v[40:41], v[38:39] op_sel_hi:[1,0,0]
    v_pk_fma_f32 v[242:243], v[242:243], v[40:41], v[38:39] op_sel_hi:[1,0,0]
    v_cvt_pk_bf16_f32 v200, v236, v237
    v_cvt_pk_bf16_f32 v201, v238, v239
    v_cvt_pk_bf16_f32 v202, v240, v241
    v_cvt_pk_bf16_f32 v203, v242, v243
    ds_write_b128 v43, v[200:203] offset:2048
    ds_read_b128 a[64:67], v28 offset:2048
    ds_read_b128 a[68:71], v29 offset:3072
    s_add_u32 s73, s57, 2061312
    buffer_load_dwordx4 v8, s[40:43], s73 offen offset:3072 lds
    v_lshlrev_b32 v244, 16, v108
    v_and_b32 v245, 0xffff0000, v108
    v_lshlrev_b32 v246, 16, v109
    v_and_b32 v247, 0xffff0000, v109
    v_lshlrev_b32 v248, 16, v110
    v_and_b32 v249, 0xffff0000, v110
    v_lshlrev_b32 v250, 16, v111
    v_and_b32 v251, 0xffff0000, v111
    v_pk_fma_f32 v[244:245], v[244:245], v[40:41], v[38:39] op_sel_hi:[1,0,0]
    v_pk_fma_f32 v[246:247], v[246:247], v[40:41], v[38:39] op_sel_hi:[1,0,0]
    v_pk_fma_f32 v[248:249], v[248:249], v[40:41], v[38:39] op_sel_hi:[1,0,0]
    v_pk_fma_f32 v[250:251], v[250:251], v[40:41], v[38:39] op_sel_hi:[1,0,0]
    v_cvt_pk_bf16_f32 v108, v244, v245
    v_cvt_pk_bf16_f32 v109, v246, v247
    v_cvt_pk_bf16_f32 v110, v248, v249
    v_cvt_pk_bf16_f32 v111, v250, v251
    ds_write_b128 v43, v[108:111] offset:6144
    ds_read_b128 a[72:75], v28 offset:6144
    ds_read_b128 a[76:79], v29 offset:7168
    v_lshlrev_b32 v236, 16, v112
    v_and_b32 v237, 0xffff0000, v112
    v_lshlrev_b32 v238, 16, v113
    v_and_b32 v239, 0xffff0000, v113
    v_lshlrev_b32 v240, 16, v114
    v_and_b32 v241, 0xffff0000, v114
    v_lshlrev_b32 v242, 16, v115
    v_and_b32 v243, 0xffff0000, v115
    v_pk_fma_f32 v[236:237], v[236:237], v[40:41], v[38:39] op_sel_hi:[1,0,0]
    v_pk_fma_f32 v[238:239], v[238:239], v[40:41], v[38:39] op_sel_hi:[1,0,0]
    v_pk_fma_f32 v[240:241], v[240:241], v[40:41], v[38:39] op_sel_hi:[1,0,0]
    v_pk_fma_f32 v[242:243], v[242:243], v[40:41], v[38:39] op_sel_hi:[1,0,0]
    v_cvt_pk_bf16_f32 v112, v236, v237
    v_cvt_pk_bf16_f32 v113, v238, v239
    v_cvt_pk_bf16_f32 v114, v240, v241
    v_cvt_pk_bf16_f32 v115, v242, v243
    ds_write_b128 v43, v[112:115] offset:10240
    ds_read_b128 a[80:83], v28 offset:10240
    ds_read_b128 a[84:87], v29 offset:11264
    s_add_u32 s11, s0, 0
    buffer_load_dword v11, v6, s[36:39], s11 offen
    v_mov_b32 v32, 0
    buffer_store_dword v32, off, s[48:51], s17 sc1
    s_lshr_b32 s65, s65, 1
    s_lshl_b32 s65, s65, 10
    s_mov_b64 exec, 0
    s_cmp_eq_u32 s52, 0
    s_cbranch_scc1 L_chain0
    s_cmp_eq_u32 s52, 1
    s_cbranch_scc1 L_chain1
L_padretB:
    s_mov_b64 exec, -1
    s_branch L_main
.p2align 12
L_main:
L_chain2:
L_pad0:
    s_cbranch_execz L_pad1
    s_waitcnt lgkmcnt(0)
    s_barrier
    ds_read_b64_tr_b16 v[204:205], v12 offset:0
    ds_read_b64_tr_b16 v[206:207], v12 offset:512
    ds_read_b64_tr_b16 v[208:209], v12 offset:2048
    ds_read_b64_tr_b16 v[210:211], v12 offset:2560
    ds_read_b64_tr_b16 v[212:213], v12 offset:1024
    ds_read_b64_tr_b16 v[214:215], v12 offset:1536
    ds_read_b64_tr_b16 v[216:217], v12 offset:3072
    ds_read_b64_tr_b16 v[218:219], v12 offset:3584
    s_waitcnt lgkmcnt(4)
    v_mfma_f32_16x16x32_bf16 v[140:143], v[204:207], a[0:3], 0
    buffer_load_dword v11, v6, s[40:43], s11 offen
    v_mfma_f32_16x16x32_bf16 v[140:143], v[208:211], a[4:7], v[140:143]
    ds_read_b64_tr_b16 v[220:221], v13 offset:0
    ds_read_b128 a[128:131], v30 offset:0
    v_mfma_f32_16x16x32_bf16 v[144:147], v[204:207], a[64:67], 0
    ds_read_b64_tr_b16 v[222:223], v13 offset:512
    ds_read_b128 a[192:195], v30 offset:2048
    v_mfma_f32_16x16x32_bf16 v[144:147], v[208:211], a[68:71], v[144:147]
    ds_read_b64_tr_b16 v[224:225], v13 offset:2048
    ds_read_b128 a[132:135], v31 offset:1024
    s_waitcnt lgkmcnt(4)
    v_mfma_f32_16x16x32_bf16 v[148:151], v[204:207], a[128:131], 0
    ds_read_b64_tr_b16 v[226:227], v13 offset:2560
    ds_read_b128 a[196:199], v31 offset:3072
    ds_read_b128 a[136:139], v30 offset:4096
    s_waitcnt lgkmcnt(3)
    v_mfma_f32_16x16x32_bf16 v[148:151], v[208:211], a[132:135], v[148:151]
    ds_read_b128 a[200:203], v30 offset:6144
    ds_read_b128 a[140:143], v31 offset:5120
    v_mfma_f32_16x16x32_bf16 v[152:155], v[204:207], a[192:195], 0
    ds_read_b128 a[204:207], v31 offset:7168
    ds_read_b128 a[144:147], v30 offset:8192
    s_waitcnt lgkmcnt(5)
    v_mfma_f32_16x16x32_bf16 v[152:155], v[208:211], a[196:199], v[152:155]
    ds_read_b128 a[208:211], v30 offset:10240
    ds_read_b128 a[148:151], v31 offset:9216
    v_mfma_f32_16x16x32_bf16 v[156:159], v[212:215], a[0:3], 0
    ds_read_b64_tr_b16 v[204:205], v13 offset:1024
    ds_read_b128 a[212:215], v31 offset:11264
    v_mfma_f32_16x16x32_bf16 v[156:159], v[216:219], a[4:7], v[156:159]
    ds_read_b64_tr_b16 v[206:207], v13 offset:1536
    v_lshlrev_b32 v244, 16, v116
    v_mfma_f32_16x16x32_bf16 v[160:163], v[212:215], a[64:67], 0
    ds_read_b64_tr_b16 v[208:209], v13 offset:3072
    v_and_b32 v245, 0xffff0000, v116
    v_mfma_f32_16x16x32_bf16 v[160:163], v[216:219], a[68:71], v[160:163]
    ds_read_b64_tr_b16 v[210:211], v13 offset:3584
    v_lshlrev_b32 v246, 16, v117
    v_mfma_f32_16x16x32_bf16 v[164:167], v[212:215], a[128:131], 0
    v_and_b32 v247, 0xffff0000, v117
    v_lshlrev_b32 v248, 16, v118
    v_mfma_f32_16x16x32_bf16 v[164:167], v[216:219], a[132:135], v[164:167]
    v_and_b32 v249, 0xffff0000, v118
    v_lshlrev_b32 v250, 16, v119
    v_mfma_f32_16x16x32_bf16 v[168:171], v[212:215], a[192:195], 0
    v_and_b32 v251, 0xffff0000, v119
    v_fma_f32 v244, v244, v40, v38
    v_mfma_f32_16x16x32_bf16 v[168:171], v[216:219], a[196:199], v[168:171]
    v_fma_f32 v245, v245, v40, v38
    v_fma_f32 v246, v246, v40, v38
    v_mfma_f32_16x16x32_bf16 v[172:175], v[220:223], a[0:3], 0
    s_waitcnt lgkmcnt(0)
    s_barrier
    v_mfma_f32_16x16x32_bf16 v[172:175], v[224:227], a[4:7], v[172:175]
    s_add_u32 m0, s55, 0
    ds_read_b64_tr_b16 v[212:213], v12 offset:16384
    v_fma_f32 v247, v247, v40, v38
    v_mfma_f32_16x16x32_bf16 v[176:179], v[220:223], a[64:67], 0
    s_add_u32 s70, s57, 2359296
    ds_read_b64_tr_b16 v[214:215], v12 offset:16896
    v_fma_f32 v248, v248, v40, v38
    v_mfma_f32_16x16x32_bf16 v[176:179], v[224:227], a[68:71], v[176:179]
    buffer_load_dwordx4 v8, s[36:39], s70 offen offset:0 lds
    v_mfma_f32_16x16x32_bf16 v[180:183], v[220:223], a[128:131], 0
    s_add_u32 s71, s57, 2358272
    ds_read_b64_tr_b16 v[216:217], v12 offset:18432
    v_fma_f32 v249, v249, v40, v38
    v_fma_f32 v250, v250, v40, v38
    v_mfma_f32_16x16x32_bf16 v[180:183], v[224:227], a[132:135], v[180:183]
    ds_read_b64_tr_b16 v[218:219], v12 offset:18944
    v_fma_f32 v251, v251, v40, v38
    v_mfma_f32_16x16x32_bf16 v[184:187], v[220:223], a[192:195], 0
    ds_write_b128 v42, v[44:47] offset:0
    v_mfma_f32_16x16x32_bf16 v[184:187], v[224:227], a[196:199], v[184:187]
    v_cvt_pk_bf16_f32 v116, v244, v245
    v_cvt_pk_bf16_f32 v117, v246, v247
    v_mfma_f32_16x16x32_bf16 v[188:191], v[204:207], a[0:3], 0
    buffer_load_dwordx4 v8, s[40:43], s71 offen offset:1024 lds
    v_mfma_f32_16x16x32_bf16 v[188:191], v[208:211], a[4:7], v[188:191]
    s_add_u32 s72, s57, 2652160
    ds_read_b64_tr_b16 v[220:221], v12 offset:17408
    v_cvt_pk_bf16_f32 v118, v248, v249
    v_cvt_pk_bf16_f32 v119, v250, v251
    v_mfma_f32_16x16x32_bf16 v[192:195], v[204:207], a[64:67], 0
    ds_read_b64_tr_b16 v[222:223], v12 offset:17920
    ds_write_b128 v43, v[116:119] offset:14336
    v_mfma_f32_16x16x32_bf16 v[192:195], v[208:211], a[68:71], v[192:195]
    ds_read_b64_tr_b16 v[224:225], v12 offset:19456
    v_lshlrev_b32 v236, 16, v120
    v_mfma_f32_16x16x32_bf16 v[196:199], v[204:207], a[128:131], 0
    ds_read_b64_tr_b16 v[226:227], v12 offset:19968
    ds_read_b128 a[88:91], v28 offset:14336
    v_mfma_f32_16x16x32_bf16 v[196:199], v[208:211], a[132:135], v[196:199]
    buffer_load_dwordx4 v8, s[36:39], s72 offen offset:2048 lds
    v_and_b32 v237, 0xffff0000, v120
    v_mfma_f32_16x16x32_bf16 v[200:203], v[204:207], a[192:195], 0
    s_add_u32 s73, s57, 2651136
    ds_read_b128 a[92:95], v29 offset:15360
    v_lshlrev_b32 v238, 16, v121
    v_mfma_f32_16x16x32_bf16 v[200:203], v[208:211], a[196:199], v[200:203]
    s_waitcnt lgkmcnt(8)
    ds_write_b128 v43, v[48:51] offset:0
    v_mfma_f32_16x16x32_bf16 v[140:143], v[212:215], a[8:11], v[140:143]
    ds_read_b64_tr_b16 v[204:205], v13 offset:16384
    v_and_b32 v239, 0xffff0000, v121
    v_mfma_f32_16x16x32_bf16 v[140:143], v[216:219], a[12:15], v[140:143]
    ds_read_b64_tr_b16 v[206:207], v13 offset:16896
    v_lshlrev_b32 v240, 16, v122
    v_mfma_f32_16x16x32_bf16 v[144:147], v[212:215], a[72:75], v[144:147]
    ds_read_b64_tr_b16 v[208:209], v13 offset:18432
    v_and_b32 v241, 0xffff0000, v122
    v_lshlrev_b32 v242, 16, v123
    v_mfma_f32_16x16x32_bf16 v[144:147], v[216:219], a[76:79], v[144:147]
    buffer_load_dwordx4 v8, s[40:43], s73 offen offset:3072 lds
    v_and_b32 v243, 0xffff0000, v123
    v_mfma_f32_16x16x32_bf16 v[148:151], v[212:215], a[136:139], v[148:151]
    ds_read_b64_tr_b16 v[210:211], v13 offset:18944
    v_fma_f32 v236, v236, v40, v38
    v_mfma_f32_16x16x32_bf16 v[148:151], v[216:219], a[140:143], v[148:151]
    ds_write_b128 v42, v[60:63] offset:4096
    v_mfma_f32_16x16x32_bf16 v[152:155], v[212:215], a[200:203], v[152:155]
    v_fma_f32 v237, v237, v40, v38
    v_fma_f32 v238, v238, v40, v38
    v_mfma_f32_16x16x32_bf16 v[152:155], v[216:219], a[204:207], v[152:155]
    s_waitcnt lgkmcnt(8)
    v_fma_f32 v239, v239, v40, v38
    v_fma_f32 v240, v240, v40, v38
    v_mfma_f32_16x16x32_bf16 v[156:159], v[220:223], a[8:11], v[156:159]
    ds_read_b64_tr_b16 v[212:213], v13 offset:17408
    v_fma_f32 v241, v241, v40, v38
    v_mfma_f32_16x16x32_bf16 v[156:159], v[224:227], a[12:15], v[156:159]
    buffer_load_dword v11, v5, s[28:31], s86 offen
    v_mfma_f32_16x16x32_bf16 v[160:163], v[220:223], a[72:75], v[160:163]
    ds_read_b64_tr_b16 v[214:215], v13 offset:17920
    v_fma_f32 v242, v242, v40, v38
    v_fma_f32 v243, v243, v40, v38
    v_mfma_f32_16x16x32_bf16 v[160:163], v[224:227], a[76:79], v[160:163]
    ds_read_b64_tr_b16 v[216:217], v13 offset:19456
    v_cvt_pk_bf16_f32 v120, v236, v237
    v_mfma_f32_16x16x32_bf16 v[164:167], v[220:223], a[136:139], v[164:167]
    ds_read_b64_tr_b16 v[218:219], v13 offset:19968
    v_cvt_pk_bf16_f32 v121, v238, v239
    v_cvt_pk_bf16_f32 v122, v240, v241
    v_mfma_f32_16x16x32_bf16 v[164:167], v[224:227], a[140:143], v[164:167]
    ds_write_b128 v43, v[64:67] offset:4096
    v_mfma_f32_16x16x32_bf16 v[168:171], v[220:223], a[200:203], v[168:171]
    v_cvt_pk_bf16_f32 v123, v242, v243
    v_lshlrev_b32 v236, 16, v52
    v_mfma_f32_16x16x32_bf16 v[168:171], v[224:227], a[204:207], v[168:171]
    s_waitcnt lgkmcnt(6)
    v_and_b32 v237, 0xffff0000, v52
    v_lshlrev_b32 v238, 16, v53
    v_mfma_f32_16x16x32_bf16 v[172:175], v[204:207], a[8:11], v[172:175]
    v_and_b32 v239, 0xffff0000, v53
    v_lshlrev_b32 v240, 16, v54
    v_mfma_f32_16x16x32_bf16 v[172:175], v[208:211], a[12:15], v[172:175]
    s_waitcnt vmcnt(12) lgkmcnt(0)
    s_barrier
    v_mfma_f32_16x16x32_bf16 v[176:179], v[204:207], a[72:75], v[176:179]
    s_add_u32 m0, s55, 16384
    ds_read_b64_tr_b16 v[220:221], v12 offset:32768
    ds_read_b128 a[152:155], v30 offset:12288
    v_mfma_f32_16x16x32_bf16 v[176:179], v[208:211], a[76:79], v[176:179]
    s_add_u32 s70, s57, 2949120
    ds_read_b64_tr_b16 v[222:223], v12 offset:33280
    ds_read_b128 a[216:219], v30 offset:14336
    v_mfma_f32_16x16x32_bf16 v[180:183], v[204:207], a[136:139], v[180:183]
    buffer_load_dwordx4 v8, s[36:39], s70 offen offset:0 lds
    v_and_b32 v241, 0xffff0000, v54
    v_mfma_f32_16x16x32_bf16 v[180:183], v[208:211], a[140:143], v[180:183]
    s_add_u32 s71, s57, 2948096
    ds_read_b64_tr_b16 v[224:225], v12 offset:34816
    ds_read_b64_tr_b16 v[226:227], v12 offset:35328
    ds_read_b128 a[156:159], v31 offset:13312
    v_mfma_f32_16x16x32_bf16 v[184:187], v[204:207], a[200:203], v[184:187]
    ds_read_b128 a[220:223], v31 offset:15360
    ds_write_b128 v43, v[120:123] offset:18432
    v_mfma_f32_16x16x32_bf16 v[184:187], v[208:211], a[204:207], v[184:187]
    v_lshlrev_b32 v242, 16, v55
    v_and_b32 v243, 0xffff0000, v55
    v_mfma_f32_16x16x32_bf16 v[188:191], v[212:215], a[8:11], v[188:191]
    ds_read_b64_tr_b16 v[204:205], v12 offset:33792
    ds_read_b128 a[96:99], v28 offset:18432
    v_mfma_f32_16x16x32_bf16 v[188:191], v[216:219], a[12:15], v[188:191]
    ds_read_b64_tr_b16 v[206:207], v12 offset:34304
    ds_read_b128 a[100:103], v29 offset:19456
    v_mfma_f32_16x16x32_bf16 v[192:195], v[212:215], a[72:75], v[192:195]
    ds_read_b64_tr_b16 v[208:209], v12 offset:35840
    v_fma_f32 v236, v236, v35, v34
    v_mfma_f32_16x16x32_bf16 v[192:195], v[216:219], a[76:79], v[192:195]
    buffer_load_dwordx4 v8, s[40:43], s71 offen offset:1024 lds
    v_fma_f32 v237, v237, v35, v34
    v_mfma_f32_16x16x32_bf16 v[196:199], v[212:215], a[136:139], v[196:199]
    s_add_u32 s72, s57, 3241984
    ds_read_b64_tr_b16 v[210:211], v12 offset:36352
    v_fma_f32 v238, v238, v35, v34
    v_mfma_f32_16x16x32_bf16 v[196:199], v[216:219], a[140:143], v[196:199]
    ds_write_b128 v42, v[76:79] offset:8192
    v_mfma_f32_16x16x32_bf16 v[200:203], v[212:215], a[200:203], v[200:203]
    v_fma_f32 v239, v239, v35, v34
    v_fma_f32 v240, v240, v35, v34
    v_mfma_f32_16x16x32_bf16 v[200:203], v[216:219], a[204:207], v[200:203]
    s_waitcnt lgkmcnt(10)
    v_fma_f32 v241, v241, v35, v34
    v_fma_f32 v242, v242, v35, v34
    v_mfma_f32_16x16x32_bf16 v[140:143], v[220:223], a[16:19], v[140:143]
    ds_read_b64_tr_b16 v[212:213], v13 offset:32768
    v_fma_f32 v243, v243, v35, v34
    v_mfma_f32_16x16x32_bf16 v[140:143], v[224:227], a[20:23], v[140:143]
    ds_read_b64_tr_b16 v[214:215], v13 offset:33280
    v_cvt_pk_bf16_f32 v52, v236, v237
    v_mfma_f32_16x16x32_bf16 v[144:147], v[220:223], a[80:83], v[144:147]
    buffer_load_dwordx4 v8, s[36:39], s72 offen offset:2048 lds
    v_mfma_f32_16x16x32_bf16 v[144:147], v[224:227], a[84:87], v[144:147]
    s_add_u32 s73, s57, 3240960
    ds_read_b64_tr_b16 v[216:217], v13 offset:34816
    v_cvt_pk_bf16_f32 v53, v238, v239
    v_cvt_pk_bf16_f32 v54, v240, v241
    v_mfma_f32_16x16x32_bf16 v[148:151], v[220:223], a[144:147], v[148:151]
    ds_read_b64_tr_b16 v[218:219], v13 offset:35328
    v_cvt_pk_bf16_f32 v55, v242, v243
    v_mfma_f32_16x16x32_bf16 v[148:151], v[224:227], a[148:151], v[148:151]
    ds_write_b128 v42, v[52:55] offset:2048
    v_mfma_f32_16x16x32_bf16 v[152:155], v[220:223], a[208:211], v[152:155]
    v_lshlrev_b32 v244, 16, v56
    v_and_b32 v245, 0xffff0000, v56
    v_mfma_f32_16x16x32_bf16 v[152:155], v[224:227], a[212:215], v[152:155]
    s_waitcnt lgkmcnt(6)
    v_lshlrev_b32 v246, 16, v57
    v_and_b32 v247, 0xffff0000, v57
    v_mfma_f32_16x16x32_bf16 v[156:159], v[204:207], a[16:19], v[156:159]
    ds_read_b64_tr_b16 v[220:221], v13 offset:33792
    v_lshlrev_b32 v248, 16, v58
    v_mfma_f32_16x16x32_bf16 v[156:159], v[208:211], a[20:23], v[156:159]
    buffer_load_dwordx4 v8, s[40:43], s73 offen offset:3072 lds
    v_mfma_f32_16x16x32_bf16 v[160:163], v[204:207], a[80:83], v[160:163]
    ds_read_b64_tr_b16 v[222:223], v13 offset:34304
    v_and_b32 v249, 0xffff0000, v58
    v_lshlrev_b32 v250, 16, v59
    v_mfma_f32_16x16x32_bf16 v[160:163], v[208:211], a[84:87], v[160:163]
    ds_read_b64_tr_b16 v[224:225], v13 offset:35840
    v_and_b32 v251, 0xffff0000, v59
    v_mfma_f32_16x16x32_bf16 v[164:167], v[204:207], a[144:147], v[164:167]
    ds_read_b64_tr_b16 v[226:227], v13 offset:36352
    v_fma_f32 v244, v244, v40, v38
    v_mfma_f32_16x16x32_bf16 v[164:167], v[208:211], a[148:151], v[164:167]
    ds_write_b128 v43, v[80:83] offset:8192
    v_mfma_f32_16x16x32_bf16 v[168:171], v[204:207], a[208:211], v[168:171]
    v_fma_f32 v245, v245, v40, v38
    v_fma_f32 v246, v246, v40, v38
    v_mfma_f32_16x16x32_bf16 v[168:171], v[208:211], a[212:215], v[168:171]
    s_waitcnt lgkmcnt(6)
    v_fma_f32 v247, v247, v40, v38
    v_fma_f32 v248, v248, v40, v38
    v_mfma_f32_16x16x32_bf16 v[172:175], v[212:215], a[16:19], v[172:175]
    v_fma_f32 v249, v249, v40, v38
    v_fma_f32 v250, v250, v40, v38
    v_mfma_f32_16x16x32_bf16 v[172:175], v[216:219], a[20:23], v[172:175]
    s_waitcnt vmcnt(12) lgkmcnt(0)
    s_barrier
    v_mfma_f32_16x16x32_bf16 v[176:179], v[212:215], a[80:83], v[176:179]
    s_add_u32 m0, s55, 32768
    ds_read_b64_tr_b16 v[204:205], v12 offset:49152
    ds_read_b128 a[160:163], v30 offset:16384
    v_mfma_f32_16x16x32_bf16 v[176:179], v[216:219], a[84:87], v[176:179]
    s_add_u32 s70, s57, 3538944
    ds_read_b64_tr_b16 v[206:207], v12 offset:49664
    ds_read_b128 a[224:227], v30 offset:18432
    v_mfma_f32_16x16x32_bf16 v[180:183], v[212:215], a[144:147], v[180:183]
    buffer_load_dwordx4 v8, s[36:39], s70 offen offset:0 lds
    v_fma_f32 v251, v251, v40, v38
    v_cvt_pk_bf16_f32 v56, v244, v245
    v_mfma_f32_16x16x32_bf16 v[180:183], v[216:219], a[148:151], v[180:183]
    s_add_u32 s71, s57, 3537920
    ds_read_b64_tr_b16 v[208:209], v12 offset:51200
    ds_read_b64_tr_b16 v[210:211], v12 offset:51712
    ds_read_b128 a[164:167], v31 offset:17408
    v_mfma_f32_16x16x32_bf16 v[184:187], v[212:215], a[208:211], v[184:187]
    ds_read_b128 a[228:231], v31 offset:19456
    v_cvt_pk_bf16_f32 v57, v246, v247
    v_mfma_f32_16x16x32_bf16 v[184:187], v[216:219], a[212:215], v[184:187]
    ds_write_b128 v42, v[92:95] offset:12288
    v_mfma_f32_16x16x32_bf16 v[188:191], v[220:223], a[16:19], v[188:191]
    buffer_load_dwordx4 v8, s[40:43], s71 offen offset:1024 lds
    v_mfma_f32_16x16x32_bf16 v[188:191], v[224:227], a[20:23], v[188:191]
    s_add_u32 s72, s57, 3831808
    ds_read_b64_tr_b16 v[212:213], v12 offset:50176
    v_cvt_pk_bf16_f32 v58, v248, v249
    v_cvt_pk_bf16_f32 v59, v250, v251
    v_mfma_f32_16x16x32_bf16 v[192:195], v[220:223], a[80:83], v[192:195]
    ds_read_b64_tr_b16 v[214:215], v12 offset:50688
    ds_write_b128 v43, v[56:59] offset:2048
    v_mfma_f32_16x16x32_bf16 v[192:195], v[224:227], a[84:87], v[192:195]
    ds_read_b64_tr_b16 v[216:217], v12 offset:52224
    v_lshlrev_b32 v244, 16, v68
    v_mfma_f32_16x16x32_bf16 v[196:199], v[220:223], a[144:147], v[196:199]
    buffer_load_dwordx4 v8, s[36:39], s72 offen offset:2048 lds
    v_and_b32 v245, 0xffff0000, v68
    v_mfma_f32_16x16x32_bf16 v[196:199], v[224:227], a[148:151], v[196:199]
    s_add_u32 s73, s57, 3830784
    ds_read_b64_tr_b16 v[218:219], v12 offset:52736
    ds_read_b128 a[40:43], v28 offset:0
    v_mfma_f32_16x16x32_bf16 v[200:203], v[220:223], a[208:211], v[200:203]
    ds_read_b128 a[104:107], v28 offset:2048
    ds_read_b128 a[44:47], v29 offset:1024
    v_mfma_f32_16x16x32_bf16 v[200:203], v[224:227], a[212:215], v[200:203]
    s_waitcnt lgkmcnt(11)
    ds_read_b128 a[108:111], v29 offset:3072
    v_lshlrev_b32 v246, 16, v69
    v_mfma_f32_16x16x32_bf16 v[140:143], v[204:207], a[24:27], v[140:143]
    ds_read_b64_tr_b16 v[220:221], v13 offset:49152
    v_and_b32 v247, 0xffff0000, v69
    v_mfma_f32_16x16x32_bf16 v[140:143], v[208:211], a[28:31], v[140:143]
    buffer_load_dwordx4 v8, s[40:43], s73 offen offset:3072 lds
    v_lshlrev_b32 v248, 16, v70
    v_mfma_f32_16x16x32_bf16 v[144:147], v[204:207], a[88:91], v[144:147]
    s_lshl_b32 s11, s52, 10
    ds_read_b64_tr_b16 v[222:223], v13 offset:49664
    v_and_b32 v249, 0xffff0000, v70
    v_mfma_f32_16x16x32_bf16 v[144:147], v[208:211], a[92:95], v[144:147]
    s_add_u32 m0, s11, 158720
    ds_read_b64_tr_b16 v[224:225], v13 offset:51200
    v_lshlrev_b32 v250, 16, v71
    v_and_b32 v251, 0xffff0000, v71
    v_mfma_f32_16x16x32_bf16 v[148:151], v[204:207], a[152:155], v[148:151]
    s_mov_b32 s11, 4096
    ds_read_b64_tr_b16 v[226:227], v13 offset:51712
    v_fma_f32 v244, v244, v35, v34
    v_mfma_f32_16x16x32_bf16 v[148:151], v[208:211], a[156:159], v[148:151]
    ds_write_b128 v43, v[96:99] offset:12288
    v_mfma_f32_16x16x32_bf16 v[152:155], v[204:207], a[216:219], v[152:155]
    buffer_load_dwordx4 v253, s[32:35], s11 offen lds
    v_fma_f32 v245, v245, v35, v34
    v_mfma_f32_16x16x32_bf16 v[152:155], v[208:211], a[220:223], v[152:155]
    s_waitcnt lgkmcnt(9)
    v_fma_f32 v246, v246, v35, v34
    v_fma_f32 v247, v247, v35, v34
    v_mfma_f32_16x16x32_bf16 v[156:159], v[212:215], a[24:27], v[156:159]
    s_mov_b32 m0, 162816
    ds_read_b64_tr_b16 v[204:205], v13 offset:50176
    v_fma_f32 v248, v248, v35, v34
    v_mfma_f32_16x16x32_bf16 v[156:159], v[216:219], a[28:31], v[156:159]
    s_nop 0
    ds_read_b64_tr_b16 v[206:207], v13 offset:50688
    v_fma_f32 v249, v249, v35, v34
    v_mfma_f32_16x16x32_bf16 v[160:163], v[212:215], a[88:91], v[160:163]
    ds_read_b64_tr_b16 v[208:209], v13 offset:52224
    v_fma_f32 v250, v250, v35, v34
    v_mfma_f32_16x16x32_bf16 v[160:163], v[216:219], a[92:95], v[160:163]
    buffer_load_dwordx4 v254, s[32:35], s11 offen lds
    v_fma_f32 v251, v251, v35, v34
    v_cvt_pk_bf16_f32 v68, v244, v245
    v_mfma_f32_16x16x32_bf16 v[164:167], v[212:215], a[152:155], v[164:167]
    ds_read_b64_tr_b16 v[210:211], v13 offset:52736
    v_cvt_pk_bf16_f32 v69, v246, v247
    v_mfma_f32_16x16x32_bf16 v[164:167], v[216:219], a[156:159], v[164:167]
    v_cvt_pk_bf16_f32 v70, v248, v249
    v_cvt_pk_bf16_f32 v71, v250, v251
    v_mfma_f32_16x16x32_bf16 v[168:171], v[212:215], a[216:219], v[168:171]
    ds_write_b128 v42, v[68:71] offset:6144
    v_mfma_f32_16x16x32_bf16 v[168:171], v[216:219], a[220:223], v[168:171]
    s_waitcnt lgkmcnt(6)
    v_lshlrev_b32 v236, 16, v72
    v_and_b32 v237, 0xffff0000, v72
    v_mfma_f32_16x16x32_bf16 v[172:175], v[220:223], a[24:27], v[172:175]
    v_lshlrev_b32 v238, 16, v73
    v_and_b32 v239, 0xffff0000, v73
    v_mfma_f32_16x16x32_bf16 v[172:175], v[224:227], a[28:31], v[172:175]
    s_waitcnt vmcnt(11) lgkmcnt(0)
    s_barrier
    v_mfma_f32_16x16x32_bf16 v[176:179], v[220:223], a[88:91], v[176:179]
    s_add_u32 m0, s55, 49152
    ds_read_b64_tr_b16 v[212:213], v12 offset:0
    ds_read_b128 a[168:171], v30 offset:0
    v_mfma_f32_16x16x32_bf16 v[176:179], v[224:227], a[92:95], v[176:179]
    s_add_u32 s70, s57, 4128768
    ds_read_b64_tr_b16 v[214:215], v12 offset:512
    ds_read_b128 a[232:235], v30 offset:2048
    v_mfma_f32_16x16x32_bf16 v[180:183], v[220:223], a[152:155], v[180:183]
    buffer_load_dwordx4 v8, s[36:39], s70 offen offset:0 lds
    v_lshlrev_b32 v240, 16, v74
    v_mfma_f32_16x16x32_bf16 v[180:183], v[224:227], a[156:159], v[180:183]
    s_add_u32 s71, s57, 4127744
    ds_read_b64_tr_b16 v[216:217], v12 offset:2048
    ds_read_b64_tr_b16 v[218:219], v12 offset:2560
    ds_read_b128 a[172:175], v31 offset:1024
    ds_read_b128 a[236:239], v31 offset:3072
    v_mfma_f32_16x16x32_bf16 v[184:187], v[220:223], a[216:219], v[184:187]
    v_and_b32 v241, 0xffff0000, v74
    v_lshlrev_b32 v242, 16, v75
    v_mfma_f32_16x16x32_bf16 v[184:187], v[224:227], a[220:223], v[184:187]
    v_and_b32 v243, 0xffff0000, v75
    v_fma_f32 v236, v236, v40, v38
    v_mfma_f32_16x16x32_bf16 v[188:191], v[204:207], a[24:27], v[188:191]
    buffer_load_dwordx4 v8, s[40:43], s71 offen offset:1024 lds
    v_mfma_f32_16x16x32_bf16 v[188:191], v[208:211], a[28:31], v[188:191]
    s_add_u32 s72, s57, 4421632
    ds_read_b64_tr_b16 v[220:221], v12 offset:1024
    v_fma_f32 v237, v237, v40, v38
    v_mfma_f32_16x16x32_bf16 v[192:195], v[204:207], a[88:91], v[192:195]
    ds_read_b64_tr_b16 v[222:223], v12 offset:1536
    v_fma_f32 v238, v238, v40, v38
    v_fma_f32 v239, v239, v40, v38
    v_mfma_f32_16x16x32_bf16 v[192:195], v[208:211], a[92:95], v[192:195]
    ds_read_b64_tr_b16 v[224:225], v12 offset:3072
    v_fma_f32 v240, v240, v40, v38
    v_mfma_f32_16x16x32_bf16 v[196:199], v[204:207], a[152:155], v[196:199]
    buffer_load_dwordx4 v8, s[36:39], s72 offen offset:2048 lds
    v_fma_f32 v241, v241, v40, v38
    v_fma_f32 v242, v242, v40, v38
    v_mfma_f32_16x16x32_bf16 v[196:199], v[208:211], a[156:159], v[196:199]
    s_add_u32 s73, s57, 4420608
    ds_read_b64_tr_b16 v[226:227], v12 offset:3584
    v_fma_f32 v243, v243, v40, v38
    v_mfma_f32_16x16x32_bf16 v[200:203], v[204:207], a[216:219], v[200:203]
    v_cvt_pk_bf16_f32 v72, v236, v237
    v_cvt_pk_bf16_f32 v73, v238, v239
    v_mfma_f32_16x16x32_bf16 v[200:203], v[208:211], a[220:223], v[200:203]
    s_waitcnt lgkmcnt(6)
    v_cvt_pk_bf16_f32 v74, v240, v241
    v_cvt_pk_bf16_f32 v75, v242, v243
    v_mfma_f32_16x16x32_bf16 v[140:143], v[212:215], a[32:35], v[140:143]
    ds_read_b64_tr_b16 v[204:205], v13 offset:0
    v_lshlrev_b32 v236, 16, v84
    v_mfma_f32_16x16x32_bf16 v[140:143], v[216:219], a[36:39], v[140:143]
    buffer_load_dwordx4 v8, s[40:43], s73 offen offset:3072 lds
    v_and_b32 v237, 0xffff0000, v84
    v_mfma_f32_16x16x32_bf16 v[144:147], v[212:215], a[96:99], v[144:147]
    s_add_u32 s11, s0, 128
    ds_read_b64_tr_b16 v[206:207], v13 offset:512
    ds_write_b128 v43, v[72:75] offset:6144
    v_mfma_f32_16x16x32_bf16 v[144:147], v[216:219], a[100:103], v[144:147]
    ds_read_b64_tr_b16 v[208:209], v13 offset:2048
    v_lshlrev_b32 v238, 16, v85
    v_mfma_f32_16x16x32_bf16 v[148:151], v[212:215], a[160:163], v[148:151]
    ds_read_b64_tr_b16 v[210:211], v13 offset:2560
    ds_read_b128 a[48:51], v28 offset:4096
    v_mfma_f32_16x16x32_bf16 v[148:151], v[216:219], a[164:167], v[148:151]
    ds_read_b128 a[112:115], v28 offset:6144
    ds_read_b128 a[52:55], v29 offset:5120
    v_mfma_f32_16x16x32_bf16 v[152:155], v[212:215], a[224:227], v[152:155]
    buffer_load_dword v11, v6, s[36:39], s11 offen
    ds_read_b128 a[116:119], v29 offset:7168
    v_mfma_f32_16x16x32_bf16 v[152:155], v[216:219], a[228:231], v[152:155]
    s_waitcnt lgkmcnt(9)
    v_and_b32 v239, 0xffff0000, v85
    v_lshlrev_b32 v240, 16, v86
    v_mfma_f32_16x16x32_bf16 v[156:159], v[220:223], a[32:35], v[156:159]
    ds_read_b64_tr_b16 v[212:213], v13 offset:1024
    v_and_b32 v241, 0xffff0000, v86
    v_mfma_f32_16x16x32_bf16 v[156:159], v[224:227], a[36:39], v[156:159]
    ds_read_b64_tr_b16 v[214:215], v13 offset:1536
    v_lshlrev_b32 v242, 16, v87
    v_mfma_f32_16x16x32_bf16 v[160:163], v[220:223], a[96:99], v[160:163]
    ds_read_b64_tr_b16 v[216:217], v13 offset:3072
    v_and_b32 v243, 0xffff0000, v87
    v_mfma_f32_16x16x32_bf16 v[160:163], v[224:227], a[100:103], v[160:163]
    buffer_load_dword v11, v6, s[40:43], s11 offen
    v_fma_f32 v236, v236, v35, v34
    v_fma_f32 v237, v237, v35, v34
    v_mfma_f32_16x16x32_bf16 v[164:167], v[220:223], a[160:163], v[164:167]
    ds_read_b64_tr_b16 v[218:219], v13 offset:3584
    v_fma_f32 v238, v238, v35, v34
    v_mfma_f32_16x16x32_bf16 v[164:167], v[224:227], a[164:167], v[164:167]
    v_fma_f32 v239, v239, v35, v34
    v_fma_f32 v240, v240, v35, v34
    v_mfma_f32_16x16x32_bf16 v[168:171], v[220:223], a[224:227], v[168:171]
    v_fma_f32 v241, v241, v35, v34
    v_fma_f32 v242, v242, v35, v34
    v_mfma_f32_16x16x32_bf16 v[168:171], v[224:227], a[228:231], v[168:171]
    s_waitcnt lgkmcnt(8)
    v_fma_f32 v243, v243, v35, v34
    v_cvt_pk_bf16_f32 v84, v236, v237
    v_mfma_f32_16x16x32_bf16 v[172:175], v[204:207], a[32:35], v[172:175]
    v_cvt_pk_bf16_f32 v85, v238, v239
    v_cvt_pk_bf16_f32 v86, v240, v241
    v_mfma_f32_16x16x32_bf16 v[172:175], v[208:211], a[36:39], v[172:175]
    s_waitcnt vmcnt(12) lgkmcnt(0)
    s_barrier
    v_mfma_f32_16x16x32_bf16 v[176:179], v[204:207], a[96:99], v[176:179]
    s_add_u32 m0, s55, 0
    ds_read_b64_tr_b16 v[220:221], v12 offset:16384
    ds_read_b128 a[176:179], v30 offset:4096
    v_mfma_f32_16x16x32_bf16 v[176:179], v[208:211], a[100:103], v[176:179]
    s_add_u32 s70, s57, 4718592
    ds_read_b64_tr_b16 v[222:223], v12 offset:16896
    ds_read_b128 a[240:243], v30 offset:6144
    v_mfma_f32_16x16x32_bf16 v[180:183], v[204:207], a[160:163], v[180:183]
    buffer_load_dwordx4 v8, s[36:39], s70 offen offset:0 lds
    v_cvt_pk_bf16_f32 v87, v242, v243
    v_mfma_f32_16x16x32_bf16 v[180:183], v[208:211], a[164:167], v[180:183]
    s_add_u32 s71, s57, 4717568
    ds_read_b64_tr_b16 v[224:225], v12 offset:18432
    ds_read_b64_tr_b16 v[226:227], v12 offset:18944
    ds_read_b128 a[180:183], v31 offset:5120
    ds_read_b128 a[244:247], v31 offset:7168
    v_mfma_f32_16x16x32_bf16 v[184:187], v[204:207], a[224:227], v[184:187]
    ds_write_b128 v42, v[84:87] offset:10240
    v_mfma_f32_16x16x32_bf16 v[184:187], v[208:211], a[228:231], v[184:187]
    v_lshlrev_b32 v244, 16, v88
    v_and_b32 v245, 0xffff0000, v88
    v_mfma_f32_16x16x32_bf16 v[188:191], v[212:215], a[32:35], v[188:191]
    ds_read_b64_tr_b16 v[204:205], v12 offset:17408
    v_lshlrev_b32 v246, 16, v89
    v_mfma_f32_16x16x32_bf16 v[188:191], v[216:219], a[36:39], v[188:191]
    ds_read_b64_tr_b16 v[206:207], v12 offset:17920
    v_and_b32 v247, 0xffff0000, v89
    v_mfma_f32_16x16x32_bf16 v[192:195], v[212:215], a[96:99], v[192:195]
    ds_read_b64_tr_b16 v[208:209], v12 offset:19456
    v_lshlrev_b32 v248, 16, v90
    v_mfma_f32_16x16x32_bf16 v[192:195], v[216:219], a[100:103], v[192:195]
    buffer_load_dwordx4 v8, s[40:43], s71 offen offset:1024 lds
    v_and_b32 v249, 0xffff0000, v90
    v_mfma_f32_16x16x32_bf16 v[196:199], v[212:215], a[160:163], v[196:199]
    s_add_u32 s72, s57, 5011456
    ds_read_b64_tr_b16 v[210:211], v12 offset:19968
    v_lshlrev_b32 v250, 16, v91
    v_and_b32 v251, 0xffff0000, v91
    v_mfma_f32_16x16x32_bf16 v[196:199], v[216:219], a[164:167], v[196:199]
    global_load_dwordx4 v[228:231], v3, s[80:81] offset:0
    v_fma_f32 v244, v244, v40, v38
    v_mfma_f32_16x16x32_bf16 v[200:203], v[212:215], a[224:227], v[200:203]
    global_load_dwordx4 v[232:235], v3, s[80:81] offset:1024
    v_fma_f32 v245, v245, v40, v38
    v_mfma_f32_16x16x32_bf16 v[200:203], v[216:219], a[228:231], v[200:203]
    s_waitcnt lgkmcnt(7)
    v_fma_f32 v246, v246, v40, v38
    v_fma_f32 v247, v247, v40, v38
    v_mfma_f32_16x16x32_bf16 v[140:143], v[220:223], a[40:43], v[140:143]
    ds_read_b64_tr_b16 v[212:213], v13 offset:16384
    v_fma_f32 v248, v248, v40, v38
    v_mfma_f32_16x16x32_bf16 v[140:143], v[224:227], a[44:47], v[140:143]
L_pad1:
    s_cbranch_execz L_padretA
    ds_read_b64_tr_b16 v[214:215], v13 offset:16896
    v_fma_f32 v249, v249, v40, v38
    v_fma_f32 v250, v250, v40, v38
    v_mfma_f32_16x16x32_bf16 v[144:147], v[220:223], a[104:107], v[144:147]
    buffer_load_dwordx4 v8, s[36:39], s72 offen offset:2048 lds
    v_fma_f32 v251, v251, v40, v38
    v_mfma_f32_16x16x32_bf16 v[144:147], v[224:227], a[108:111], v[144:147]
    s_add_u32 s73, s57, 5010432
    ds_read_b64_tr_b16 v[216:217], v13 offset:18432
    v_cvt_pk_bf16_f32 v88, v244, v245
    v_mfma_f32_16x16x32_bf16 v[148:151], v[220:223], a[168:171], v[148:151]
    ds_read_b64_tr_b16 v[218:219], v13 offset:18944
    v_cvt_pk_bf16_f32 v89, v246, v247
    v_cvt_pk_bf16_f32 v90, v248, v249
    v_mfma_f32_16x16x32_bf16 v[148:151], v[224:227], a[172:175], v[148:151]
    v_cvt_pk_bf16_f32 v91, v250, v251
    v_lshlrev_b32 v244, 16, v100
    v_mfma_f32_16x16x32_bf16 v[152:155], v[220:223], a[232:235], v[152:155]
    ds_write_b128 v43, v[88:91] offset:10240
    v_mfma_f32_16x16x32_bf16 v[152:155], v[224:227], a[236:239], v[152:155]
    s_waitcnt lgkmcnt(5)
    v_and_b32 v245, 0xffff0000, v100
    v_lshlrev_b32 v246, 16, v101
    v_mfma_f32_16x16x32_bf16 v[156:159], v[204:207], a[40:43], v[156:159]
    ds_read_b64_tr_b16 v[220:221], v13 offset:17408
    ds_read_b128 a[56:59], v28 offset:8192
    v_mfma_f32_16x16x32_bf16 v[156:159], v[208:211], a[44:47], v[156:159]
    buffer_load_dwordx4 v8, s[40:43], s73 offen offset:3072 lds
    v_mfma_f32_16x16x32_bf16 v[160:163], v[204:207], a[104:107], v[160:163]
    ds_read_b64_tr_b16 v[222:223], v13 offset:17920
    ds_read_b128 a[120:123], v28 offset:10240
    v_mfma_f32_16x16x32_bf16 v[160:163], v[208:211], a[108:111], v[160:163]
    ds_read_b64_tr_b16 v[224:225], v13 offset:19456
    ds_read_b128 a[60:63], v29 offset:9216
    ds_read_b128 a[124:127], v29 offset:11264
    v_mfma_f32_16x16x32_bf16 v[164:167], v[204:207], a[168:171], v[164:167]
    ds_read_b64_tr_b16 v[226:227], v13 offset:19968
    v_and_b32 v247, 0xffff0000, v101
    v_mfma_f32_16x16x32_bf16 v[164:167], v[208:211], a[172:175], v[164:167]
    v_lshlrev_b32 v248, 16, v102
    v_and_b32 v249, 0xffff0000, v102
    v_mfma_f32_16x16x32_bf16 v[168:171], v[204:207], a[232:235], v[168:171]
    v_lshlrev_b32 v250, 16, v103
    v_and_b32 v251, 0xffff0000, v103
    v_mfma_f32_16x16x32_bf16 v[168:171], v[208:211], a[236:239], v[168:171]
    s_waitcnt lgkmcnt(9)
    v_fma_f32 v244, v244, v35, v34
    v_fma_f32 v245, v245, v35, v34
    v_mfma_f32_16x16x32_bf16 v[172:175], v[212:215], a[40:43], v[172:175]
    v_fma_f32 v246, v246, v35, v34
    v_fma_f32 v247, v247, v35, v34
    v_mfma_f32_16x16x32_bf16 v[172:175], v[216:219], a[44:47], v[172:175]
    s_waitcnt vmcnt(14) lgkmcnt(0)
    s_barrier
    v_mfma_f32_16x16x32_bf16 v[176:179], v[212:215], a[104:107], v[176:179]
    s_add_u32 m0, s55, 16384
    ds_read_b64_tr_b16 v[204:205], v12 offset:32768
    ds_read_b128 a[184:187], v30 offset:8192
    v_mfma_f32_16x16x32_bf16 v[176:179], v[216:219], a[108:111], v[176:179]
    s_add_u32 s70, s56, 0
    ds_read_b64_tr_b16 v[206:207], v12 offset:33280
    ds_read_b128 a[248:251], v30 offset:10240
    v_mfma_f32_16x16x32_bf16 v[180:183], v[212:215], a[168:171], v[180:183]
    buffer_load_dwordx4 v4, s[28:31], s70 offen offset:0 lds
    v_fma_f32 v248, v248, v35, v34
    v_mfma_f32_16x16x32_bf16 v[180:183], v[216:219], a[172:175], v[180:183]
    s_add_u32 s71, s56, 12800
    ds_read_b64_tr_b16 v[208:209], v12 offset:34816
    ds_read_b64_tr_b16 v[210:211], v12 offset:35328
    ds_read_b128 a[188:191], v31 offset:9216
    ds_read_b128 a[252:255], v31 offset:11264
    v_mfma_f32_16x16x32_bf16 v[184:187], v[212:215], a[232:235], v[184:187]
    v_fma_f32 v249, v249, v35, v34
    v_fma_f32 v250, v250, v35, v34
    v_mfma_f32_16x16x32_bf16 v[184:187], v[216:219], a[236:239], v[184:187]
    v_fma_f32 v251, v251, v35, v34
    v_cvt_pk_bf16_f32 v100, v244, v245
    v_mfma_f32_16x16x32_bf16 v[188:191], v[220:223], a[40:43], v[188:191]
    ds_read_b64_tr_b16 v[212:213], v12 offset:33792
    v_cvt_pk_bf16_f32 v101, v246, v247
    v_mfma_f32_16x16x32_bf16 v[188:191], v[224:227], a[44:47], v[188:191]
    ds_read_b64_tr_b16 v[214:215], v12 offset:34304
    v_cvt_pk_bf16_f32 v102, v248, v249
    v_mfma_f32_16x16x32_bf16 v[192:195], v[220:223], a[104:107], v[192:195]
    ds_read_b64_tr_b16 v[216:217], v12 offset:35840
    v_cvt_pk_bf16_f32 v103, v250, v251
    v_lshlrev_b32 v236, 16, v104
    v_mfma_f32_16x16x32_bf16 v[192:195], v[224:227], a[108:111], v[192:195]
    buffer_load_dwordx4 v4, s[28:31], s71 offen offset:1024 lds
    v_and_b32 v237, 0xffff0000, v104
    v_mfma_f32_16x16x32_bf16 v[196:199], v[220:223], a[168:171], v[196:199]
    s_add_u32 s72, s56, 108544
    ds_read_b64_tr_b16 v[218:219], v12 offset:36352
    v_lshlrev_b32 v238, 16, v105
    v_and_b32 v239, 0xffff0000, v105
    v_mfma_f32_16x16x32_bf16 v[196:199], v[224:227], a[172:175], v[196:199]
    ds_write_b128 v42, v[100:103] offset:14336
    v_mfma_f32_16x16x32_bf16 v[200:203], v[220:223], a[232:235], v[200:203]
    v_lshlrev_b32 v240, 16, v106
    v_and_b32 v241, 0xffff0000, v106
    v_mfma_f32_16x16x32_bf16 v[200:203], v[224:227], a[236:239], v[200:203]
    s_waitcnt lgkmcnt(7)
    v_lshlrev_b32 v242, 16, v107
    v_and_b32 v243, 0xffff0000, v107
    v_mfma_f32_16x16x32_bf16 v[140:143], v[204:207], a[48:51], v[140:143]
    ds_read_b64_tr_b16 v[220:221], v13 offset:32768
    v_fma_f32 v236, v236, v40, v38
    v_mfma_f32_16x16x32_bf16 v[140:143], v[208:211], a[52:55], v[140:143]
    ds_read_b64_tr_b16 v[222:223], v13 offset:33280
    v_fma_f32 v237, v237, v40, v38
    v_mfma_f32_16x16x32_bf16 v[144:147], v[204:207], a[112:115], v[144:147]
    buffer_load_dwordx4 v4, s[28:31], s72 offen offset:2048 lds
    v_fma_f32 v238, v238, v40, v38
    v_mfma_f32_16x16x32_bf16 v[144:147], v[208:211], a[116:119], v[144:147]
    s_add_u32 s73, s56, 121344
    ds_read_b64_tr_b16 v[224:225], v13 offset:34816
    v_fma_f32 v239, v239, v40, v38
    v_fma_f32 v240, v240, v40, v38
    v_mfma_f32_16x16x32_bf16 v[148:151], v[204:207], a[176:179], v[148:151]
    ds_read_b64_tr_b16 v[226:227], v13 offset:35328
    v_fma_f32 v241, v241, v40, v38
    v_fma_f32 v242, v242, v40, v38
    v_mfma_f32_16x16x32_bf16 v[148:151], v[208:211], a[180:183], v[148:151]
    v_fma_f32 v243, v243, v40, v38
    v_cvt_pk_bf16_f32 v104, v236, v237
    v_mfma_f32_16x16x32_bf16 v[152:155], v[204:207], a[240:243], v[152:155]
    v_cvt_pk_bf16_f32 v105, v238, v239
    v_cvt_pk_bf16_f32 v106, v240, v241
    v_mfma_f32_16x16x32_bf16 v[152:155], v[208:211], a[244:247], v[152:155]
    s_waitcnt lgkmcnt(5)
    v_cvt_pk_bf16_f32 v107, v242, v243
    v_mfma_f32_16x16x32_bf16 v[156:159], v[212:215], a[48:51], v[156:159]
    ds_read_b64_tr_b16 v[204:205], v13 offset:33792
    ds_write_b128 v43, v[104:107] offset:14336
    v_mfma_f32_16x16x32_bf16 v[156:159], v[216:219], a[52:55], v[156:159]
    buffer_load_dwordx4 v4, s[28:31], s73 offen offset:3072 lds
    v_mfma_f32_16x16x32_bf16 v[160:163], v[212:215], a[112:115], v[160:163]
    ds_read_b64_tr_b16 v[206:207], v13 offset:34304
    v_mfma_f32_16x16x32_bf16 v[160:163], v[216:219], a[116:119], v[160:163]
    ds_read_b64_tr_b16 v[208:209], v13 offset:35840
    ds_read_b128 v[44:47], v28 offset:12288
    ds_read_b128 v[52:55], v28 offset:14336
    v_mfma_f32_16x16x32_bf16 v[164:167], v[212:215], a[176:179], v[164:167]
    ds_read_b64_tr_b16 v[210:211], v13 offset:36352
    ds_read_b128 v[48:51], v29 offset:13312
    v_mfma_f32_16x16x32_bf16 v[164:167], v[216:219], a[180:183], v[164:167]
    ds_read_b128 v[56:59], v29 offset:15360
    v_mfma_f32_16x16x32_bf16 v[168:171], v[212:215], a[240:243], v[168:171]
    v_mfma_f32_16x16x32_bf16 v[168:171], v[216:219], a[244:247], v[168:171]
    s_waitcnt lgkmcnt(9)
    v_mfma_f32_16x16x32_bf16 v[172:175], v[220:223], a[48:51], v[172:175]
    v_mfma_f32_16x16x32_bf16 v[172:175], v[224:227], a[52:55], v[172:175]
    s_waitcnt vmcnt(12) lgkmcnt(0)
    s_barrier
    v_mfma_f32_16x16x32_bf16 v[176:179], v[220:223], a[112:115], v[176:179]
    s_add_u32 m0, s55, 32768
    ds_read_b64_tr_b16 v[212:213], v12 offset:49152
    ds_read_b128 v[60:63], v30 offset:12288
    v_mfma_f32_16x16x32_bf16 v[176:179], v[224:227], a[116:119], v[176:179]
    s_add_u32 s70, s56, 221184
    ds_read_b64_tr_b16 v[214:215], v12 offset:49664
    ds_read_b128 v[68:71], v30 offset:14336
    v_mfma_f32_16x16x32_bf16 v[180:183], v[220:223], a[176:179], v[180:183]
    buffer_load_dwordx4 v4, s[28:31], s70 offen offset:0 lds
    v_mfma_f32_16x16x32_bf16 v[180:183], v[224:227], a[180:183], v[180:183]
    s_add_u32 s71, s56, 233984
    ds_read_b64_tr_b16 v[216:217], v12 offset:51200
    ds_read_b64_tr_b16 v[218:219], v12 offset:51712
    v_mfma_f32_16x16x32_bf16 v[184:187], v[220:223], a[240:243], v[184:187]
    ds_read_b128 v[64:67], v31 offset:13312
    ds_read_b128 v[72:75], v31 offset:15360
    v_mfma_f32_16x16x32_bf16 v[184:187], v[224:227], a[244:247], v[184:187]
    v_mfma_f32_16x16x32_bf16 v[188:191], v[204:207], a[48:51], v[188:191]
    ds_read_b64_tr_b16 v[220:221], v12 offset:50176
    v_mfma_f32_16x16x32_bf16 v[188:191], v[208:211], a[52:55], v[188:191]
    ds_read_b64_tr_b16 v[222:223], v12 offset:50688
    v_mfma_f32_16x16x32_bf16 v[192:195], v[204:207], a[112:115], v[192:195]
    ds_read_b64_tr_b16 v[224:225], v12 offset:52224
    v_mfma_f32_16x16x32_bf16 v[192:195], v[208:211], a[116:119], v[192:195]
    buffer_load_dwordx4 v4, s[28:31], s71 offen offset:1024 lds
    v_mfma_f32_16x16x32_bf16 v[196:199], v[204:207], a[176:179], v[196:199]
    s_add_u32 s72, s56, 329728
    ds_read_b64_tr_b16 v[226:227], v12 offset:52736
    v_mfma_f32_16x16x32_bf16 v[196:199], v[208:211], a[180:183], v[196:199]
    v_mfma_f32_16x16x32_bf16 v[200:203], v[204:207], a[240:243], v[200:203]
    v_mfma_f32_16x16x32_bf16 v[200:203], v[208:211], a[244:247], v[200:203]
    s_waitcnt lgkmcnt(6)
    v_mfma_f32_16x16x32_bf16 v[140:143], v[212:215], a[56:59], v[140:143]
    ds_read_b64_tr_b16 v[204:205], v13 offset:49152
    v_mfma_f32_16x16x32_bf16 v[140:143], v[216:219], a[60:63], v[140:143]
    ds_read_b64_tr_b16 v[206:207], v13 offset:49664
    v_mfma_f32_16x16x32_bf16 v[144:147], v[212:215], a[120:123], v[144:147]
    buffer_load_dwordx4 v4, s[28:31], s72 offen offset:2048 lds
    v_mfma_f32_16x16x32_bf16 v[144:147], v[216:219], a[124:127], v[144:147]
    s_add_u32 s73, s56, 342528
    ds_read_b64_tr_b16 v[208:209], v13 offset:51200
    v_mfma_f32_16x16x32_bf16 v[148:151], v[212:215], a[184:187], v[148:151]
    ds_read_b64_tr_b16 v[210:211], v13 offset:51712
    v_mfma_f32_16x16x32_bf16 v[148:151], v[216:219], a[188:191], v[148:151]
    v_mfma_f32_16x16x32_bf16 v[152:155], v[212:215], a[248:251], v[152:155]
    v_mfma_f32_16x16x32_bf16 v[152:155], v[216:219], a[252:255], v[152:155]
    s_waitcnt lgkmcnt(4)
    v_mfma_f32_16x16x32_bf16 v[156:159], v[220:223], a[56:59], v[156:159]
    ds_read_b64_tr_b16 v[212:213], v13 offset:50176
    v_mfma_f32_16x16x32_bf16 v[156:159], v[224:227], a[60:63], v[156:159]
    buffer_load_dwordx4 v4, s[28:31], s73 offen offset:3072 lds
    v_mfma_f32_16x16x32_bf16 v[160:163], v[220:223], a[120:123], v[160:163]
    ds_read_b64_tr_b16 v[214:215], v13 offset:50688
    v_mfma_f32_16x16x32_bf16 v[160:163], v[224:227], a[124:127], v[160:163]
    ds_read_b64_tr_b16 v[216:217], v13 offset:52224
    v_mfma_f32_16x16x32_bf16 v[164:167], v[220:223], a[184:187], v[164:167]
    ds_read_b64_tr_b16 v[218:219], v13 offset:52736
    v_mfma_f32_16x16x32_bf16 v[164:167], v[224:227], a[188:191], v[164:167]
    v_mfma_f32_16x16x32_bf16 v[168:171], v[220:223], a[248:251], v[168:171]
    v_mfma_f32_16x16x32_bf16 v[168:171], v[224:227], a[252:255], v[168:171]
    s_waitcnt lgkmcnt(4)
    v_mfma_f32_16x16x32_bf16 v[172:175], v[204:207], a[56:59], v[172:175]
    v_mfma_f32_16x16x32_bf16 v[172:175], v[208:211], a[60:63], v[172:175]
    s_waitcnt vmcnt(8) lgkmcnt(0)
    s_barrier
    s_and_b32 s16, s54, 7
    s_cmp_eq_u32 s52, 0
    s_cselect_b32 s16, s16, 0xff
    v_mfma_f32_16x16x32_bf16 v[176:179], v[204:207], a[120:123], v[176:179]
    s_add_u32 m0, s55, 49152
    ds_read_b64_tr_b16 v[220:221], v12 offset:0
    v_mfma_f32_16x16x32_bf16 v[176:179], v[208:211], a[124:127], v[176:179]
    s_add_u32 s70, s56, 442368
    ds_read_b64_tr_b16 v[222:223], v12 offset:512
    v_mfma_f32_16x16x32_bf16 v[180:183], v[204:207], a[184:187], v[180:183]
    buffer_load_dwordx4 v4, s[28:31], s70 offen offset:0 lds
    v_mfma_f32_16x16x32_bf16 v[180:183], v[208:211], a[188:191], v[180:183]
    s_add_u32 s71, s56, 455168
    ds_read_b64_tr_b16 v[224:225], v12 offset:2048
    ds_read_b64_tr_b16 v[226:227], v12 offset:2560
    v_mfma_f32_16x16x32_bf16 v[184:187], v[204:207], a[248:251], v[184:187]
    v_mfma_f32_16x16x32_bf16 v[184:187], v[208:211], a[252:255], v[184:187]
    v_mfma_f32_16x16x32_bf16 v[188:191], v[212:215], a[56:59], v[188:191]
    ds_read_b64_tr_b16 v[204:205], v12 offset:1024
    v_mfma_f32_16x16x32_bf16 v[188:191], v[216:219], a[60:63], v[188:191]
    ds_read_b64_tr_b16 v[206:207], v12 offset:1536
    v_mfma_f32_16x16x32_bf16 v[192:195], v[212:215], a[120:123], v[192:195]
    ds_read_b64_tr_b16 v[208:209], v12 offset:3072
    v_mfma_f32_16x16x32_bf16 v[192:195], v[216:219], a[124:127], v[192:195]
    buffer_load_dwordx4 v4, s[28:31], s71 offen offset:1024 lds
    v_mfma_f32_16x16x32_bf16 v[196:199], v[212:215], a[184:187], v[196:199]
    s_add_u32 s72, s56, 550912
    ds_read_b64_tr_b16 v[210:211], v12 offset:3584
    v_mfma_f32_16x16x32_bf16 v[196:199], v[216:219], a[188:191], v[196:199]
    v_mfma_f32_16x16x32_bf16 v[200:203], v[212:215], a[248:251], v[200:203]
    v_mfma_f32_16x16x32_bf16 v[200:203], v[216:219], a[252:255], v[200:203]
    s_waitcnt lgkmcnt(4)
    v_mfma_f32_16x16x32_bf16 v[140:143], v[220:223], v[44:47], v[140:143]
    ds_read_b64_tr_b16 v[212:213], v13 offset:0
    v_mfma_f32_16x16x32_bf16 v[140:143], v[224:227], v[48:51], v[140:143]
    ds_read_b64_tr_b16 v[214:215], v13 offset:512
    v_mfma_f32_16x16x32_bf16 v[144:147], v[220:223], v[52:55], v[144:147]
    buffer_load_dwordx4 v4, s[28:31], s72 offen offset:2048 lds
    v_mfma_f32_16x16x32_bf16 v[144:147], v[224:227], v[56:59], v[144:147]
    s_add_u32 s73, s56, 563712
    ds_read_b64_tr_b16 v[216:217], v13 offset:2048
    v_mfma_f32_16x16x32_bf16 v[148:151], v[220:223], v[60:63], v[148:151]
    ds_read_b64_tr_b16 v[218:219], v13 offset:2560
    v_mfma_f32_16x16x32_bf16 v[148:151], v[224:227], v[64:67], v[148:151]
    v_mfma_f32_16x16x32_bf16 v[152:155], v[220:223], v[68:71], v[152:155]
    v_mfma_f32_16x16x32_bf16 v[152:155], v[224:227], v[72:75], v[152:155]
    s_waitcnt lgkmcnt(4)
    v_mfma_f32_16x16x32_bf16 v[156:159], v[204:207], v[44:47], v[156:159]
    ds_read_b64_tr_b16 v[220:221], v13 offset:1024
    v_mfma_f32_16x16x32_bf16 v[156:159], v[208:211], v[48:51], v[156:159]
    buffer_load_dwordx4 v4, s[28:31], s73 offen offset:3072 lds
    v_mfma_f32_16x16x32_bf16 v[160:163], v[204:207], v[52:55], v[160:163]
    ds_read_b64_tr_b16 v[222:223], v13 offset:1536
    v_mfma_f32_16x16x32_bf16 v[160:163], v[208:211], v[56:59], v[160:163]
    ds_read_b64_tr_b16 v[224:225], v13 offset:3072
    v_mfma_f32_16x16x32_bf16 v[164:167], v[204:207], v[60:63], v[164:167]
    ds_read_b64_tr_b16 v[226:227], v13 offset:3584
    v_mfma_f32_16x16x32_bf16 v[164:167], v[208:211], v[64:67], v[164:167]
    v_mfma_f32_16x16x32_bf16 v[168:171], v[204:207], v[68:71], v[168:171]
    v_mfma_f32_16x16x32_bf16 v[168:171], v[208:211], v[72:75], v[168:171]
    s_waitcnt lgkmcnt(4)
    v_mfma_f32_16x16x32_bf16 v[172:175], v[212:215], v[44:47], v[172:175]
    v_mfma_f32_16x16x32_bf16 v[172:175], v[216:219], v[48:51], v[172:175]
    s_waitcnt vmcnt(8) lgkmcnt(0)
    s_barrier
    s_cmp_eq_u32 s16, 0
    s_cbranch_scc1 L_sig0
L_sigb0:
    v_mfma_f32_16x16x32_bf16 v[176:179], v[212:215], v[52:55], v[176:179]
    s_add_u32 m0, s55, 0
    ds_read_b64_tr_b16 v[236:237], v20 offset:16384
    ds_read_b64_tr_b16 v[238:239], v20 offset:17408
    v_mfma_f32_16x16x32_bf16 v[176:179], v[216:219], v[56:59], v[176:179]
    s_add_u32 s70, s56, 663552
    ds_read_b64_tr_b16 v[240:241], v20 offset:18432
    ds_read_b64_tr_b16 v[242:243], v20 offset:19456
    v_mfma_f32_16x16x32_bf16 v[180:183], v[212:215], v[60:63], v[180:183]
    buffer_load_dwordx4 v4, s[28:31], s70 offen offset:0 lds
    v_mfma_f32_16x16x32_bf16 v[180:183], v[216:219], v[64:67], v[180:183]
    s_add_u32 s71, s56, 676352
    ds_read_b64_tr_b16 v[244:245], v21 offset:16384
    ds_read_b64_tr_b16 v[246:247], v21 offset:17408
    v_mfma_f32_16x16x32_bf16 v[184:187], v[212:215], v[68:71], v[184:187]
    ds_read_b64_tr_b16 v[248:249], v21 offset:18432
    ds_read_b64_tr_b16 v[250:251], v21 offset:19456
    v_mfma_f32_16x16x32_bf16 v[184:187], v[216:219], v[72:75], v[184:187]
    v_mfma_f32_16x16x32_bf16 v[188:191], v[220:223], v[44:47], v[188:191]
    ds_read_b64_tr_b16 v[204:205], v23 offset:16384
    ds_read_b64_tr_b16 v[206:207], v23 offset:17408
    v_mfma_f32_16x16x32_bf16 v[188:191], v[224:227], v[48:51], v[188:191]
    ds_read_b64_tr_b16 v[208:209], v23 offset:18432
    ds_read_b64_tr_b16 v[210:211], v23 offset:19456
    v_mfma_f32_16x16x32_bf16 v[192:195], v[220:223], v[52:55], v[192:195]
    buffer_load_dwordx4 v4, s[28:31], s71 offen offset:1024 lds
    v_mfma_f32_16x16x32_bf16 v[192:195], v[224:227], v[56:59], v[192:195]
    s_add_u32 s72, s56, 772096
    v_mfma_f32_16x16x32_bf16 v[196:199], v[220:223], v[60:63], v[196:199]
    ds_read_b64_tr_b16 v[212:213], v24 offset:16384
    ds_read_b64_tr_b16 v[214:215], v24 offset:17408
    v_mfma_f32_16x16x32_bf16 v[196:199], v[224:227], v[64:67], v[196:199]
    ds_read_b64_tr_b16 v[216:217], v24 offset:18432
    ds_read_b64_tr_b16 v[218:219], v24 offset:19456
    v_mfma_f32_16x16x32_bf16 v[200:203], v[220:223], v[68:71], v[200:203]
    v_mfma_f32_16x16x32_bf16 v[200:203], v[224:227], v[72:75], v[200:203]
    s_waitcnt lgkmcnt(12)
    v_mfma_f32_16x16x32_bf16 v[76:79], v[236:239], a[0:3], 0
    buffer_load_dwordx4 v4, s[28:31], s72 offen offset:2048 lds
    v_mfma_f32_16x16x32_bf16 v[76:79], v[240:243], a[4:7], v[76:79]
    s_add_u32 s73, s56, 784896
    ds_read_b64_tr_b16 v[220:221], v25 offset:16384
    ds_read_b64_tr_b16 v[222:223], v25 offset:17408
    v_mfma_f32_16x16x32_bf16 v[80:83], v[236:239], a[64:67], 0
    ds_read_b64_tr_b16 v[224:225], v25 offset:18432
    ds_read_b64_tr_b16 v[226:227], v25 offset:19456
    v_fma_f32 v1, v140, v140, s64
    v_mul_f32 v156, v140, v156
    v_mfma_f32_16x16x32_bf16 v[80:83], v[240:243], a[68:71], v[80:83]
    s_waitcnt lgkmcnt(12)
    v_mul_f32 v140, v1, v140
    v_fma_f32 v2, v141, v141, s64
    v_mfma_f32_16x16x32_bf16 v[84:87], v[244:247], a[0:3], 0
    ds_read_b64_tr_b16 v[236:237], v26 offset:16384
    ds_read_b64_tr_b16 v[238:239], v26 offset:17408
    v_mfma_f32_16x16x32_bf16 v[84:87], v[248:251], a[4:7], v[84:87]
    ds_read_b64_tr_b16 v[240:241], v26 offset:18432
    ds_read_b64_tr_b16 v[242:243], v26 offset:19456
    v_exp_f32 v140, v140
    v_mfma_f32_16x16x32_bf16 v[88:91], v[244:247], a[64:67], 0
    buffer_load_dwordx4 v4, s[28:31], s73 offen offset:3072 lds
    v_add_f32 v140, 1.0, v140
    v_mfma_f32_16x16x32_bf16 v[88:91], v[248:251], a[68:71], v[88:91]
    s_waitcnt lgkmcnt(12)
    v_rcp_f32 v140, v140
    v_mfma_f32_16x16x32_bf16 v[100:103], a[0:3], v[204:207], 0
    ds_read_b64_tr_b16 v[244:245], v27 offset:16384
    ds_read_b64_tr_b16 v[246:247], v27 offset:17408
    v_mul_f32 v156, v156, v140
    v_mfma_f32_16x16x32_bf16 v[100:103], a[4:7], v[208:211], v[100:103]
    ds_read_b64_tr_b16 v[248:249], v27 offset:18432
    ds_read_b64_tr_b16 v[250:251], v27 offset:19456
    v_mul_f32 v157, v141, v157
    v_mfma_f32_16x16x32_bf16 v[104:107], a[64:67], v[204:207], 0
    v_mul_f32 v141, v2, v141
    v_fma_f32 v3, v142, v142, s64
    v_mfma_f32_16x16x32_bf16 v[104:107], a[68:71], v[208:211], v[104:107]
    s_waitcnt lgkmcnt(12)
    v_exp_f32 v141, v141
    v_mfma_f32_16x16x32_bf16 v[108:111], a[0:3], v[212:215], 0
    v_add_f32 v141, 1.0, v141
    v_mul_f32 v158, v142, v158
    v_mfma_f32_16x16x32_bf16 v[108:111], a[4:7], v[216:219], v[108:111]
    v_rcp_f32 v141, v141
    v_mfma_f32_16x16x32_bf16 v[112:115], a[64:67], v[212:215], 0
    s_waitcnt vmcnt(8) lgkmcnt(0)
    s_barrier
    s_cmp_eq_u32 s16, 1
    s_cbranch_scc1 L_sig1
L_sigb1:
    v_mfma_f32_16x16x32_bf16 v[112:115], a[68:71], v[216:219], v[112:115]
    ds_read_b64_tr_b16 v[204:205], v20 offset:32768
    ds_read_b64_tr_b16 v[206:207], v20 offset:33792
    v_mfma_f32_16x16x32_bf16 v[116:119], a[0:3], v[220:223], 0
    s_add_u32 m0, s55, 16384
    ds_read_b64_tr_b16 v[208:209], v20 offset:34816
    ds_read_b64_tr_b16 v[210:211], v20 offset:35840
    v_mul_f32 v157, v157, v141
    v_mfma_f32_16x16x32_bf16 v[116:119], a[4:7], v[224:227], v[116:119]
    s_add_u32 s70, s56, 884736
    ds_read_b64_tr_b16 v[212:213], v21 offset:32768
    ds_read_b64_tr_b16 v[214:215], v21 offset:33792
    v_mul_f32 v142, v3, v142
    v_fma_f32 v252, v143, v143, s64
    v_mfma_f32_16x16x32_bf16 v[120:123], a[64:67], v[220:223], 0
    buffer_load_dwordx4 v4, s[28:31], s70 offen offset:0 lds
    v_exp_f32 v142, v142
    v_mfma_f32_16x16x32_bf16 v[120:123], a[68:71], v[224:227], v[120:123]
    ds_read_b64_tr_b16 v[216:217], v21 offset:34816
    ds_read_b64_tr_b16 v[218:219], v21 offset:35840
    v_mfma_f32_16x16x32_bf16 v[124:127], a[0:3], v[236:239], 0
    s_add_u32 s71, s56, 897536
    ds_read_b64_tr_b16 v[220:221], v23 offset:32768
    ds_read_b64_tr_b16 v[222:223], v23 offset:33792
    v_add_f32 v142, 1.0, v142
    v_mul_f32 v159, v143, v159
    v_mfma_f32_16x16x32_bf16 v[124:127], a[4:7], v[240:243], v[124:127]
    ds_read_b64_tr_b16 v[224:225], v23 offset:34816
    ds_read_b64_tr_b16 v[226:227], v23 offset:35840
    v_rcp_f32 v142, v142
    v_mfma_f32_16x16x32_bf16 v[128:131], a[64:67], v[236:239], 0
    v_mul_f32 v158, v158, v142
    v_mul_f32 v143, v252, v143
    v_mfma_f32_16x16x32_bf16 v[128:131], a[68:71], v[240:243], v[128:131]
    v_exp_f32 v143, v143
    v_mfma_f32_16x16x32_bf16 v[132:135], a[0:3], v[244:247], 0
    buffer_load_dwordx4 v4, s[28:31], s71 offen offset:1024 lds
    v_mfma_f32_16x16x32_bf16 v[132:135], a[4:7], v[248:251], v[132:135]
    s_add_u32 s72, s56, 993280
    ds_read_b64_tr_b16 v[236:237], v24 offset:32768
    ds_read_b64_tr_b16 v[238:239], v24 offset:33792
    v_mfma_f32_16x16x32_bf16 v[136:139], a[64:67], v[244:247], 0
    ds_read_b64_tr_b16 v[240:241], v24 offset:34816
    ds_read_b64_tr_b16 v[242:243], v24 offset:35840
    v_add_f32 v143, 1.0, v143
    v_cvt_pk_bf16_f32 v140, v156, v157
    v_mfma_f32_16x16x32_bf16 v[136:139], a[68:71], v[248:251], v[136:139]
    s_waitcnt lgkmcnt(12)
    v_rcp_f32 v143, v143
    v_mfma_f32_16x16x32_bf16 v[76:79], v[204:207], a[8:11], v[76:79]
    ds_read_b64_tr_b16 v[244:245], v25 offset:32768
    ds_read_b64_tr_b16 v[246:247], v25 offset:33792
    v_mul_f32 v159, v159, v143
    v_mfma_f32_16x16x32_bf16 v[76:79], v[208:211], a[12:15], v[76:79]
    buffer_load_dwordx4 v4, s[28:31], s72 offen offset:2048 lds
    v_cvt_pk_bf16_f32 v141, v158, v159
    v_mfma_f32_16x16x32_bf16 v[80:83], v[204:207], a[72:75], v[80:83]
    s_add_u32 s73, s56, 1006080
    ds_read_b64_tr_b16 v[248:249], v25 offset:34816
    ds_read_b64_tr_b16 v[250:251], v25 offset:35840
    v_fma_f32 v1, v172, v172, s64
    v_mfma_f32_16x16x32_bf16 v[80:83], v[208:211], a[76:79], v[80:83]
    s_waitcnt lgkmcnt(12)
    v_mul_f32 v188, v172, v188
    v_mul_f32 v172, v1, v172
    v_mfma_f32_16x16x32_bf16 v[84:87], v[212:215], a[8:11], v[84:87]
    ds_read_b64_tr_b16 v[204:205], v26 offset:32768
    ds_read_b64_tr_b16 v[206:207], v26 offset:33792
    v_exp_f32 v172, v172
    v_mfma_f32_16x16x32_bf16 v[84:87], v[216:219], a[12:15], v[84:87]
    ds_read_b64_tr_b16 v[208:209], v26 offset:34816
    ds_read_b64_tr_b16 v[210:211], v26 offset:35840
    v_mfma_f32_16x16x32_bf16 v[88:91], v[212:215], a[72:75], v[88:91]
    v_add_f32 v172, 1.0, v172
    v_fma_f32 v2, v173, v173, s64
    v_mfma_f32_16x16x32_bf16 v[88:91], v[216:219], a[76:79], v[88:91]
    s_waitcnt lgkmcnt(12)
    v_rcp_f32 v172, v172
    v_mfma_f32_16x16x32_bf16 v[100:103], a[8:11], v[220:223], v[100:103]
    buffer_load_dwordx4 v4, s[28:31], s73 offen offset:3072 lds
    v_mfma_f32_16x16x32_bf16 v[100:103], a[12:15], v[224:227], v[100:103]
    ds_read_b64_tr_b16 v[212:213], v27 offset:32768
    ds_read_b64_tr_b16 v[214:215], v27 offset:33792
    v_mul_f32 v188, v188, v172
    v_mul_f32 v189, v173, v189
    v_mfma_f32_16x16x32_bf16 v[104:107], a[72:75], v[220:223], v[104:107]
    ds_read_b64_tr_b16 v[216:217], v27 offset:34816
    ds_read_b64_tr_b16 v[218:219], v27 offset:35840
    v_mul_f32 v173, v2, v173
    v_mfma_f32_16x16x32_bf16 v[104:107], a[76:79], v[224:227], v[104:107]
    s_waitcnt lgkmcnt(12)
    v_exp_f32 v173, v173
    v_mfma_f32_16x16x32_bf16 v[108:111], a[8:11], v[236:239], v[108:111]
    v_add_f32 v173, 1.0, v173
    v_fma_f32 v3, v174, v174, s64
    v_mfma_f32_16x16x32_bf16 v[108:111], a[12:15], v[240:243], v[108:111]
    v_rcp_f32 v173, v173
    v_mfma_f32_16x16x32_bf16 v[112:115], a[72:75], v[236:239], v[112:115]
    v_mul_f32 v189, v189, v173
    v_mul_f32 v190, v174, v190
    v_mfma_f32_16x16x32_bf16 v[112:115], a[76:79], v[240:243], v[112:115]
    s_waitcnt lgkmcnt(8)
    s_waitcnt vmcnt(8) lgkmcnt(0)
    s_barrier
    s_cmp_eq_u32 s16, 2
    s_cbranch_scc1 L_sig2
L_sigb2:
    v_mfma_f32_16x16x32_bf16 v[116:119], a[8:11], v[244:247], v[116:119]
    s_add_u32 m0, s55, 32768
    ds_read_b64_tr_b16 v[220:221], v20 offset:49152
    ds_read_b64_tr_b16 v[222:223], v20 offset:50176
    v_mfma_f32_16x16x32_bf16 v[116:119], a[12:15], v[248:251], v[116:119]
    s_add_u32 s70, s56, 1105920
    ds_read_b64_tr_b16 v[224:225], v20 offset:51200
    ds_read_b64_tr_b16 v[226:227], v20 offset:52224
    v_mul_f32 v174, v3, v174
    v_mfma_f32_16x16x32_bf16 v[120:123], a[72:75], v[244:247], v[120:123]
    buffer_load_dwordx4 v4, s[28:31], s70 offen offset:0 lds
    v_exp_f32 v174, v174
    v_mfma_f32_16x16x32_bf16 v[120:123], a[76:79], v[248:251], v[120:123]
    ds_read_b64_tr_b16 v[236:237], v21 offset:49152
    ds_read_b64_tr_b16 v[238:239], v21 offset:50176
    v_add_f32 v174, 1.0, v174
    v_mfma_f32_16x16x32_bf16 v[124:127], a[8:11], v[204:207], v[124:127]
    s_add_u32 s71, s56, 1118720
    ds_read_b64_tr_b16 v[240:241], v21 offset:51200
    ds_read_b64_tr_b16 v[242:243], v21 offset:52224
    v_rcp_f32 v174, v174
    v_mfma_f32_16x16x32_bf16 v[124:127], a[12:15], v[208:211], v[124:127]
    ds_read_b64_tr_b16 v[244:245], v23 offset:49152
    ds_read_b64_tr_b16 v[246:247], v23 offset:50176
    v_mul_f32 v190, v190, v174
    v_mfma_f32_16x16x32_bf16 v[128:131], a[72:75], v[204:207], v[128:131]
    ds_read_b64_tr_b16 v[248:249], v23 offset:51200
    ds_read_b64_tr_b16 v[250:251], v23 offset:52224
    v_fma_f32 v252, v175, v175, s64
    v_mfma_f32_16x16x32_bf16 v[128:131], a[76:79], v[208:211], v[128:131]
    v_mul_f32 v191, v175, v191
    v_mul_f32 v175, v252, v175
    v_mfma_f32_16x16x32_bf16 v[132:135], a[8:11], v[212:215], v[132:135]
    buffer_load_dwordx4 v4, s[28:31], s71 offen offset:1024 lds
    v_exp_f32 v175, v175
    v_mfma_f32_16x16x32_bf16 v[132:135], a[12:15], v[216:219], v[132:135]
    s_add_u32 s72, s56, 1214464
    ds_read_b64_tr_b16 v[204:205], v24 offset:49152
    ds_read_b64_tr_b16 v[206:207], v24 offset:50176
    v_mfma_f32_16x16x32_bf16 v[136:139], a[72:75], v[212:215], v[136:139]
    ds_read_b64_tr_b16 v[208:209], v24 offset:51200
    ds_read_b64_tr_b16 v[210:211], v24 offset:52224
    v_add_f32 v175, 1.0, v175
    v_cvt_pk_bf16_f32 v142, v188, v189
    v_mfma_f32_16x16x32_bf16 v[136:139], a[76:79], v[216:219], v[136:139]
    s_waitcnt lgkmcnt(12)
    v_rcp_f32 v175, v175
    v_mfma_f32_16x16x32_bf16 v[76:79], v[220:223], a[16:19], v[76:79]
    ds_read_b64_tr_b16 v[212:213], v25 offset:49152
    ds_read_b64_tr_b16 v[214:215], v25 offset:50176
    v_mfma_f32_16x16x32_bf16 v[76:79], v[224:227], a[20:23], v[76:79]
    ds_read_b64_tr_b16 v[216:217], v25 offset:51200
    ds_read_b64_tr_b16 v[218:219], v25 offset:52224
    v_mul_f32 v191, v191, v175
    v_fma_f32 v1, v144, v144, s64
    v_mfma_f32_16x16x32_bf16 v[80:83], v[220:223], a[80:83], v[80:83]
    buffer_load_dwordx4 v4, s[28:31], s72 offen offset:2048 lds
    v_cvt_pk_bf16_f32 v143, v190, v191
    v_mfma_f32_16x16x32_bf16 v[80:83], v[224:227], a[84:87], v[80:83]
    s_waitcnt lgkmcnt(12)
    ds_write_b128 v18, v[140:143] offset:0
    v_mfma_f32_16x16x32_bf16 v[84:87], v[236:239], a[16:19], v[84:87]
    s_add_u32 s73, s56, 1227264
    ds_read_b64_tr_b16 v[220:221], v26 offset:49152
    ds_read_b64_tr_b16 v[222:223], v26 offset:50176
    v_and_b32 v140, -2, v140
    v_mfma_f32_16x16x32_bf16 v[84:87], v[240:243], a[20:23], v[84:87]
    ds_read_b64_tr_b16 v[224:225], v26 offset:51200
    ds_read_b64_tr_b16 v[226:227], v26 offset:52224
    v_and_b32 v141, -2, v141
    v_mfma_f32_16x16x32_bf16 v[88:91], v[236:239], a[80:83], v[88:91]
    v_and_b32 v142, -2, v142
    v_and_b32 v143, -2, v143
    v_mfma_f32_16x16x32_bf16 v[88:91], v[240:243], a[84:87], v[88:91]
    s_waitcnt lgkmcnt(13)
    v_mul_f32 v160, v144, v160
    v_mul_f32 v144, v1, v144
    v_mfma_f32_16x16x32_bf16 v[100:103], a[16:19], v[244:247], v[100:103]
    buffer_store_dwordx4 v[140:143], v18, s[48:51], s12 offen offset:0 sc1
    v_mfma_f32_16x16x32_bf16 v[100:103], a[20:23], v[248:251], v[100:103]
    buffer_load_dwordx4 v4, s[28:31], s73 offen offset:3072 lds
    v_exp_f32 v144, v144
    v_mfma_f32_16x16x32_bf16 v[104:107], a[80:83], v[244:247], v[104:107]
    ds_read_b64_tr_b16 v[236:237], v27 offset:49152
    ds_read_b64_tr_b16 v[238:239], v27 offset:50176
    v_add_f32 v144, 1.0, v144
    v_mfma_f32_16x16x32_bf16 v[104:107], a[84:87], v[248:251], v[104:107]
    s_waitcnt lgkmcnt(11)
    ds_read_b64_tr_b16 v[240:241], v27 offset:51200
    ds_read_b64_tr_b16 v[242:243], v27 offset:52224
L_chain3:
L_pad2:
    s_cbranch_execz L_pad3
    v_rcp_f32 v144, v144
    v_mfma_f32_16x16x32_bf16 v[108:111], a[16:19], v[204:207], v[108:111]
    v_mul_f32 v160, v160, v144
    v_fma_f32 v2, v145, v145, s64
    v_mfma_f32_16x16x32_bf16 v[108:111], a[20:23], v[208:211], v[108:111]
    v_mul_f32 v161, v145, v161
    v_mul_f32 v145, v2, v145
    v_mfma_f32_16x16x32_bf16 v[112:115], a[80:83], v[204:207], v[112:115]
    v_exp_f32 v145, v145
    v_mfma_f32_16x16x32_bf16 v[112:115], a[84:87], v[208:211], v[112:115]
    s_waitcnt lgkmcnt(9)
    v_add_f32 v145, 1.0, v145
    v_fma_f32 v3, v146, v146, s64
    v_mfma_f32_16x16x32_bf16 v[116:119], a[16:19], v[212:215], v[116:119]
    s_waitcnt vmcnt(9) lgkmcnt(0)
    s_barrier
    s_cmp_eq_u32 s16, 3
    s_cbranch_scc1 L_sig3
L_sigb3:
    v_mfma_f32_16x16x32_bf16 v[116:119], a[20:23], v[216:219], v[116:119]
    s_add_u32 m0, s55, 49152
    ds_read_b64_tr_b16 v[244:245], v20 offset:0
    ds_read_b64_tr_b16 v[246:247], v20 offset:1024
    v_mfma_f32_16x16x32_bf16 v[120:123], a[80:83], v[212:215], v[120:123]
    s_add_u32 s70, s56, 1327104
    ds_read_b64_tr_b16 v[248:249], v20 offset:2048
    ds_read_b64_tr_b16 v[250:251], v20 offset:3072
    v_mfma_f32_16x16x32_bf16 v[120:123], a[84:87], v[216:219], v[120:123]
    ds_read_b64_tr_b16 v[204:205], v21 offset:0
    ds_read_b64_tr_b16 v[206:207], v21 offset:1024
    v_rcp_f32 v145, v145
    v_mfma_f32_16x16x32_bf16 v[124:127], a[16:19], v[220:223], v[124:127]
    buffer_load_dwordx4 v4, s[28:31], s70 offen offset:0 lds
    v_mul_f32 v161, v161, v145
    v_mfma_f32_16x16x32_bf16 v[124:127], a[20:23], v[224:227], v[124:127]
    s_add_u32 s71, s56, 1339904
    ds_read_b64_tr_b16 v[208:209], v21 offset:2048
    ds_read_b64_tr_b16 v[210:211], v21 offset:3072
    v_mul_f32 v162, v146, v162
    v_mfma_f32_16x16x32_bf16 v[128:131], a[80:83], v[220:223], v[128:131]
    ds_read_b64_tr_b16 v[212:213], v23 offset:0
    ds_read_b64_tr_b16 v[214:215], v23 offset:1024
    v_mul_f32 v146, v3, v146
    v_fma_f32 v252, v147, v147, s64
    v_mfma_f32_16x16x32_bf16 v[128:131], a[84:87], v[224:227], v[128:131]
    ds_read_b64_tr_b16 v[216:217], v23 offset:2048
    ds_read_b64_tr_b16 v[218:219], v23 offset:3072
    v_exp_f32 v146, v146
    v_mfma_f32_16x16x32_bf16 v[132:135], a[16:19], v[236:239], v[132:135]
    ds_read_b64_tr_b16 v[220:221], v24 offset:0
    ds_read_b64_tr_b16 v[222:223], v24 offset:1024
    v_mfma_f32_16x16x32_bf16 v[132:135], a[20:23], v[240:243], v[132:135]
    buffer_load_dwordx4 v4, s[28:31], s71 offen offset:1024 lds
    v_add_f32 v146, 1.0, v146
    v_mul_f32 v163, v147, v163
    v_mfma_f32_16x16x32_bf16 v[136:139], a[80:83], v[236:239], v[136:139]
    s_add_u32 s72, s56, 1435648
    ds_read_b64_tr_b16 v[224:225], v24 offset:2048
    ds_read_b64_tr_b16 v[226:227], v24 offset:3072
    v_rcp_f32 v146, v146
    v_mfma_f32_16x16x32_bf16 v[136:139], a[84:87], v[240:243], v[136:139]
    s_waitcnt lgkmcnt(12)
    v_mul_f32 v162, v162, v146
    v_mul_f32 v147, v252, v147
    v_mfma_f32_16x16x32_bf16 v[76:79], v[244:247], a[24:27], v[76:79]
    ds_read_b64_tr_b16 v[236:237], v25 offset:0
    ds_read_b64_tr_b16 v[238:239], v25 offset:1024
    v_mfma_f32_16x16x32_bf16 v[76:79], v[248:251], a[28:31], v[76:79]
    ds_read_b64_tr_b16 v[240:241], v25 offset:2048
    ds_read_b64_tr_b16 v[242:243], v25 offset:3072
    v_exp_f32 v147, v147
    v_mfma_f32_16x16x32_bf16 v[80:83], v[244:247], a[88:91], v[80:83]
    v_add_f32 v147, 1.0, v147
    v_cvt_pk_bf16_f32 v144, v160, v161
    v_mfma_f32_16x16x32_bf16 v[80:83], v[248:251], a[92:95], v[80:83]
    s_waitcnt lgkmcnt(12)
    v_rcp_f32 v147, v147
    v_mfma_f32_16x16x32_bf16 v[84:87], v[204:207], a[24:27], v[84:87]
    buffer_load_dwordx4 v4, s[28:31], s72 offen offset:2048 lds
    v_mfma_f32_16x16x32_bf16 v[84:87], v[208:211], a[28:31], v[84:87]
    s_add_u32 s73, s56, 1448448
    ds_read_b64_tr_b16 v[244:245], v26 offset:0
    ds_read_b64_tr_b16 v[246:247], v26 offset:1024
    v_mfma_f32_16x16x32_bf16 v[88:91], v[204:207], a[88:91], v[88:91]
    ds_read_b64_tr_b16 v[248:249], v26 offset:2048
    ds_read_b64_tr_b16 v[250:251], v26 offset:3072
    v_mul_f32 v163, v163, v147
    v_fma_f32 v1, v176, v176, s64
    v_mfma_f32_16x16x32_bf16 v[88:91], v[208:211], a[92:95], v[88:91]
    s_waitcnt lgkmcnt(12)
    v_cvt_pk_bf16_f32 v145, v162, v163
    v_mul_f32 v192, v176, v192
    v_mfma_f32_16x16x32_bf16 v[100:103], a[24:27], v[212:215], v[100:103]
    ds_read_b64_tr_b16 v[204:205], v27 offset:0
    ds_read_b64_tr_b16 v[206:207], v27 offset:1024
    v_mfma_f32_16x16x32_bf16 v[100:103], a[28:31], v[216:219], v[100:103]
    buffer_load_dwordx4 v4, s[28:31], s73 offen offset:3072 lds
    v_mul_f32 v176, v1, v176
    v_fma_f32 v2, v177, v177, s64
    v_mfma_f32_16x16x32_bf16 v[104:107], a[88:91], v[212:215], v[104:107]
    ds_read_b64_tr_b16 v[208:209], v27 offset:2048
    ds_read_b64_tr_b16 v[210:211], v27 offset:3072
    v_exp_f32 v176, v176
    v_mfma_f32_16x16x32_bf16 v[104:107], a[92:95], v[216:219], v[104:107]
    s_waitcnt lgkmcnt(12)
    v_add_f32 v176, 1.0, v176
    v_mul_f32 v193, v177, v193
    v_mfma_f32_16x16x32_bf16 v[108:111], a[24:27], v[220:223], v[108:111]
    v_rcp_f32 v176, v176
    v_mfma_f32_16x16x32_bf16 v[108:111], a[28:31], v[224:227], v[108:111]
    v_mul_f32 v192, v192, v176
    v_mul_f32 v177, v2, v177
    v_mfma_f32_16x16x32_bf16 v[112:115], a[88:91], v[220:223], v[112:115]
    v_exp_f32 v177, v177
    v_mfma_f32_16x16x32_bf16 v[112:115], a[92:95], v[224:227], v[112:115]
    s_waitcnt lgkmcnt(8)
    s_waitcnt vmcnt(9) lgkmcnt(0)
    s_barrier
    s_cmp_eq_u32 s16, 4
    s_cbranch_scc1 L_sig4
L_sigb4:
    v_mfma_f32_16x16x32_bf16 v[116:119], a[24:27], v[236:239], v[116:119]
    s_add_u32 m0, s55, 0
    ds_read_b64_tr_b16 v[212:213], v20 offset:16384
    ds_read_b64_tr_b16 v[214:215], v20 offset:17408
    v_mfma_f32_16x16x32_bf16 v[116:119], a[28:31], v[240:243], v[116:119]
    s_add_u32 s70, s56, 1548288
    ds_read_b64_tr_b16 v[216:217], v20 offset:18432
    ds_read_b64_tr_b16 v[218:219], v20 offset:19456
    v_mfma_f32_16x16x32_bf16 v[120:123], a[88:91], v[236:239], v[120:123]
    buffer_load_dwordx4 v4, s[28:31], s70 offen offset:0 lds
    v_add_f32 v177, 1.0, v177
    v_fma_f32 v3, v178, v178, s64
    v_mfma_f32_16x16x32_bf16 v[120:123], a[92:95], v[240:243], v[120:123]
    ds_read_b64_tr_b16 v[220:221], v21 offset:16384
    ds_read_b64_tr_b16 v[222:223], v21 offset:17408
    v_rcp_f32 v177, v177
    v_mfma_f32_16x16x32_bf16 v[124:127], a[24:27], v[244:247], v[124:127]
    s_add_u32 s71, s56, 1561088
    ds_read_b64_tr_b16 v[224:225], v21 offset:18432
    ds_read_b64_tr_b16 v[226:227], v21 offset:19456
    v_mfma_f32_16x16x32_bf16 v[124:127], a[28:31], v[248:251], v[124:127]
    ds_read_b64_tr_b16 v[236:237], v23 offset:16384
    ds_read_b64_tr_b16 v[238:239], v23 offset:17408
    v_mul_f32 v193, v193, v177
    v_mul_f32 v194, v178, v194
    v_mfma_f32_16x16x32_bf16 v[128:131], a[88:91], v[244:247], v[128:131]
    ds_read_b64_tr_b16 v[240:241], v23 offset:18432
    ds_read_b64_tr_b16 v[242:243], v23 offset:19456
    v_mul_f32 v178, v3, v178
    v_mfma_f32_16x16x32_bf16 v[128:131], a[92:95], v[248:251], v[128:131]
    v_exp_f32 v178, v178
    v_mfma_f32_16x16x32_bf16 v[132:135], a[24:27], v[204:207], v[132:135]
    buffer_load_dwordx4 v4, s[28:31], s71 offen offset:1024 lds
    v_add_f32 v178, 1.0, v178
    v_mfma_f32_16x16x32_bf16 v[132:135], a[28:31], v[208:211], v[132:135]
    s_add_u32 s72, s56, 1656832
    ds_read_b64_tr_b16 v[244:245], v24 offset:16384
    ds_read_b64_tr_b16 v[246:247], v24 offset:17408
    v_rcp_f32 v178, v178
    v_mfma_f32_16x16x32_bf16 v[136:139], a[88:91], v[204:207], v[136:139]
    ds_read_b64_tr_b16 v[248:249], v24 offset:18432
    ds_read_b64_tr_b16 v[250:251], v24 offset:19456
    v_mfma_f32_16x16x32_bf16 v[136:139], a[92:95], v[208:211], v[136:139]
    s_waitcnt lgkmcnt(12)
    v_mul_f32 v194, v194, v178
    v_fma_f32 v252, v179, v179, s64
    v_mfma_f32_16x16x32_bf16 v[76:79], v[212:215], a[32:35], v[76:79]
    ds_read_b64_tr_b16 v[204:205], v25 offset:16384
    ds_read_b64_tr_b16 v[206:207], v25 offset:17408
    v_mul_f32 v195, v179, v195
    v_mfma_f32_16x16x32_bf16 v[76:79], v[216:219], a[36:39], v[76:79]
    ds_read_b64_tr_b16 v[208:209], v25 offset:18432
    ds_read_b64_tr_b16 v[210:211], v25 offset:19456
    v_mul_f32 v179, v252, v179
    v_mfma_f32_16x16x32_bf16 v[80:83], v[212:215], a[96:99], v[80:83]
    buffer_load_dwordx4 v4, s[28:31], s72 offen offset:2048 lds
    v_exp_f32 v179, v179
    v_mfma_f32_16x16x32_bf16 v[80:83], v[216:219], a[100:103], v[80:83]
    s_waitcnt lgkmcnt(12)
    v_add_f32 v179, 1.0, v179
    v_cvt_pk_bf16_f32 v146, v192, v193
    v_mfma_f32_16x16x32_bf16 v[84:87], v[220:223], a[32:35], v[84:87]
    s_add_u32 s73, s56, 1669632
    ds_read_b64_tr_b16 v[212:213], v26 offset:16384
    ds_read_b64_tr_b16 v[214:215], v26 offset:17408
    v_mfma_f32_16x16x32_bf16 v[84:87], v[224:227], a[36:39], v[84:87]
    ds_read_b64_tr_b16 v[216:217], v26 offset:18432
    ds_read_b64_tr_b16 v[218:219], v26 offset:19456
    v_rcp_f32 v179, v179
    v_mfma_f32_16x16x32_bf16 v[88:91], v[220:223], a[96:99], v[88:91]
    v_mul_f32 v195, v195, v179
    v_fma_f32 v1, v148, v148, s64
    v_mfma_f32_16x16x32_bf16 v[88:91], v[224:227], a[100:103], v[88:91]
    s_waitcnt lgkmcnt(12)
    v_cvt_pk_bf16_f32 v147, v194, v195
    v_mul_f32 v164, v148, v164
    v_mfma_f32_16x16x32_bf16 v[100:103], a[32:35], v[236:239], v[100:103]
    buffer_load_dwordx4 v4, s[28:31], s73 offen offset:3072 lds
    v_mfma_f32_16x16x32_bf16 v[100:103], a[36:39], v[240:243], v[100:103]
    ds_read_b64_tr_b16 v[220:221], v27 offset:16384
    ds_read_b64_tr_b16 v[222:223], v27 offset:17408
    ds_write_b128 v18, v[144:147] offset:1024
    v_mfma_f32_16x16x32_bf16 v[104:107], a[96:99], v[236:239], v[104:107]
    ds_read_b64_tr_b16 v[224:225], v27 offset:18432
    ds_read_b64_tr_b16 v[226:227], v27 offset:19456
    v_mfma_f32_16x16x32_bf16 v[104:107], a[100:103], v[240:243], v[104:107]
    s_waitcnt lgkmcnt(13)
    v_and_b32 v144, -2, v144
    v_and_b32 v145, -2, v145
    v_mfma_f32_16x16x32_bf16 v[108:111], a[32:35], v[244:247], v[108:111]
    v_and_b32 v146, -2, v146
    v_and_b32 v147, -2, v147
    v_mfma_f32_16x16x32_bf16 v[108:111], a[36:39], v[248:251], v[108:111]
    buffer_store_dwordx4 v[144:147], v18, s[48:51], s12 offen offset:1024 sc1
    v_mfma_f32_16x16x32_bf16 v[112:115], a[96:99], v[244:247], v[112:115]
    v_mul_f32 v148, v1, v148
    v_fma_f32 v2, v149, v149, s64
    v_mfma_f32_16x16x32_bf16 v[112:115], a[100:103], v[248:251], v[112:115]
    s_waitcnt lgkmcnt(9)
    s_waitcnt vmcnt(9) lgkmcnt(0)
    s_barrier
    s_cmp_eq_u32 s16, 5
    s_cbranch_scc1 L_sig5
L_sigb5:
    v_exp_f32 v148, v148
    v_mfma_f32_16x16x32_bf16 v[116:119], a[32:35], v[204:207], v[116:119]
    s_add_u32 m0, s55, 16384
    ds_read_b64_tr_b16 v[236:237], v20 offset:32768
    ds_read_b64_tr_b16 v[238:239], v20 offset:33792
    v_mfma_f32_16x16x32_bf16 v[116:119], a[36:39], v[208:211], v[116:119]
    s_add_u32 s70, s56, 1769472
    ds_read_b64_tr_b16 v[240:241], v20 offset:34816
    ds_read_b64_tr_b16 v[242:243], v20 offset:35840
    v_add_f32 v148, 1.0, v148
    v_mul_f32 v165, v149, v165
    v_mfma_f32_16x16x32_bf16 v[120:123], a[96:99], v[204:207], v[120:123]
    buffer_load_dwordx4 v4, s[28:31], s70 offen offset:0 lds
    v_rcp_f32 v148, v148
    v_mfma_f32_16x16x32_bf16 v[120:123], a[100:103], v[208:211], v[120:123]
    ds_read_b64_tr_b16 v[244:245], v21 offset:32768
    ds_read_b64_tr_b16 v[246:247], v21 offset:33792
    v_mfma_f32_16x16x32_bf16 v[124:127], a[32:35], v[212:215], v[124:127]
    s_add_u32 s71, s56, 1782272
    ds_read_b64_tr_b16 v[248:249], v21 offset:34816
    ds_read_b64_tr_b16 v[250:251], v21 offset:35840
    v_mul_f32 v164, v164, v148
    v_mul_f32 v149, v2, v149
    v_mfma_f32_16x16x32_bf16 v[124:127], a[36:39], v[216:219], v[124:127]
    ds_read_b64_tr_b16 v[204:205], v23 offset:32768
    ds_read_b64_tr_b16 v[206:207], v23 offset:33792
    v_exp_f32 v149, v149
    v_mfma_f32_16x16x32_bf16 v[128:131], a[96:99], v[212:215], v[128:131]
    ds_read_b64_tr_b16 v[208:209], v23 offset:34816
    ds_read_b64_tr_b16 v[210:211], v23 offset:35840
    v_mfma_f32_16x16x32_bf16 v[128:131], a[100:103], v[216:219], v[128:131]
    v_add_f32 v149, 1.0, v149
    v_fma_f32 v3, v150, v150, s64
    v_mfma_f32_16x16x32_bf16 v[132:135], a[32:35], v[220:223], v[132:135]
    buffer_load_dwordx4 v4, s[28:31], s71 offen offset:1024 lds
    v_rcp_f32 v149, v149
    v_mfma_f32_16x16x32_bf16 v[132:135], a[36:39], v[224:227], v[132:135]
    s_add_u32 s72, s56, 1878016
    ds_read_b64_tr_b16 v[212:213], v24 offset:32768
    ds_read_b64_tr_b16 v[214:215], v24 offset:33792
    v_mfma_f32_16x16x32_bf16 v[136:139], a[96:99], v[220:223], v[136:139]
    ds_read_b64_tr_b16 v[216:217], v24 offset:34816
    ds_read_b64_tr_b16 v[218:219], v24 offset:35840
    v_mul_f32 v165, v165, v149
    v_mul_f32 v166, v150, v166
    v_mfma_f32_16x16x32_bf16 v[136:139], a[100:103], v[224:227], v[136:139]
    s_waitcnt lgkmcnt(12)
    v_mul_f32 v150, v3, v150
    v_fma_f32 v252, v151, v151, s64
    v_mfma_f32_16x16x32_bf16 v[76:79], v[236:239], a[40:43], v[76:79]
    ds_read_b64_tr_b16 v[220:221], v25 offset:32768
    ds_read_b64_tr_b16 v[222:223], v25 offset:33792
    v_mfma_f32_16x16x32_bf16 v[76:79], v[240:243], a[44:47], v[76:79]
    ds_read_b64_tr_b16 v[224:225], v25 offset:34816
    ds_read_b64_tr_b16 v[226:227], v25 offset:35840
    v_exp_f32 v150, v150
    v_mfma_f32_16x16x32_bf16 v[80:83], v[236:239], a[104:107], v[80:83]
    buffer_load_dwordx4 v4, s[28:31], s72 offen offset:2048 lds
    v_add_f32 v150, 1.0, v150
    v_mfma_f32_16x16x32_bf16 v[80:83], v[240:243], a[108:111], v[80:83]
    s_waitcnt lgkmcnt(12)
    v_rcp_f32 v150, v150
    v_mfma_f32_16x16x32_bf16 v[84:87], v[244:247], a[40:43], v[84:87]
    s_add_u32 s73, s56, 1890816
    ds_read_b64_tr_b16 v[236:237], v26 offset:32768
    ds_read_b64_tr_b16 v[238:239], v26 offset:33792
    v_mul_f32 v166, v166, v150
    v_mfma_f32_16x16x32_bf16 v[84:87], v[248:251], a[44:47], v[84:87]
    ds_read_b64_tr_b16 v[240:241], v26 offset:34816
    ds_read_b64_tr_b16 v[242:243], v26 offset:35840
    v_mul_f32 v167, v151, v167
    v_mfma_f32_16x16x32_bf16 v[88:91], v[244:247], a[104:107], v[88:91]
    v_mul_f32 v151, v252, v151
    v_cvt_pk_bf16_f32 v148, v164, v165
    v_mfma_f32_16x16x32_bf16 v[88:91], v[248:251], a[108:111], v[88:91]
    s_waitcnt lgkmcnt(12)
    v_exp_f32 v151, v151
    v_mfma_f32_16x16x32_bf16 v[100:103], a[40:43], v[204:207], v[100:103]
    buffer_load_dwordx4 v4, s[28:31], s73 offen offset:3072 lds
    v_mfma_f32_16x16x32_bf16 v[100:103], a[44:47], v[208:211], v[100:103]
    ds_read_b64_tr_b16 v[244:245], v27 offset:32768
    ds_read_b64_tr_b16 v[246:247], v27 offset:33792
    v_add_f32 v151, 1.0, v151
    v_mfma_f32_16x16x32_bf16 v[104:107], a[104:107], v[204:207], v[104:107]
    ds_read_b64_tr_b16 v[248:249], v27 offset:34816
    ds_read_b64_tr_b16 v[250:251], v27 offset:35840
    v_rcp_f32 v151, v151
    v_mfma_f32_16x16x32_bf16 v[104:107], a[108:111], v[208:211], v[104:107]
    s_waitcnt lgkmcnt(12)
    v_mul_f32 v167, v167, v151
    v_fma_f32 v1, v180, v180, s64
    v_mfma_f32_16x16x32_bf16 v[108:111], a[40:43], v[212:215], v[108:111]
    v_cvt_pk_bf16_f32 v149, v166, v167
    v_mul_f32 v196, v180, v196
    v_mfma_f32_16x16x32_bf16 v[108:111], a[44:47], v[216:219], v[108:111]
    v_mul_f32 v180, v1, v180
    v_fma_f32 v2, v181, v181, s64
    v_mfma_f32_16x16x32_bf16 v[112:115], a[104:107], v[212:215], v[112:115]
    v_exp_f32 v180, v180
    v_mfma_f32_16x16x32_bf16 v[112:115], a[108:111], v[216:219], v[112:115]
    s_waitcnt lgkmcnt(8)
    s_waitcnt vmcnt(9) lgkmcnt(0)
    s_barrier
    s_cmp_eq_u32 s16, 6
    s_cbranch_scc1 L_sig6
L_sigb6:
    v_mfma_f32_16x16x32_bf16 v[116:119], a[40:43], v[220:223], v[116:119]
    s_add_u32 m0, s55, 32768
    ds_read_b64_tr_b16 v[204:205], v20 offset:49152
    ds_read_b64_tr_b16 v[206:207], v20 offset:50176
    v_mfma_f32_16x16x32_bf16 v[116:119], a[44:47], v[224:227], v[116:119]
    s_add_u32 s70, s57, 128
    ds_read_b64_tr_b16 v[208:209], v20 offset:51200
    ds_read_b64_tr_b16 v[210:211], v20 offset:52224
    v_add_f32 v180, 1.0, v180
    v_mfma_f32_16x16x32_bf16 v[120:123], a[104:107], v[220:223], v[120:123]
    buffer_load_dwordx4 v8, s[36:39], s70 offen offset:0 lds
    v_rcp_f32 v180, v180
    v_mfma_f32_16x16x32_bf16 v[120:123], a[108:111], v[224:227], v[120:123]
    ds_read_b64_tr_b16 v[212:213], v21 offset:49152
    ds_read_b64_tr_b16 v[214:215], v21 offset:50176
    v_mfma_f32_16x16x32_bf16 v[124:127], a[40:43], v[236:239], v[124:127]
    s_sub_u32 s71, s57, 896
    ds_read_b64_tr_b16 v[216:217], v21 offset:51200
    ds_read_b64_tr_b16 v[218:219], v21 offset:52224
    v_mul_f32 v196, v196, v180
    v_mul_f32 v197, v181, v197
    v_mfma_f32_16x16x32_bf16 v[124:127], a[44:47], v[240:243], v[124:127]
    ds_read_b64_tr_b16 v[220:221], v23 offset:49152
    ds_read_b64_tr_b16 v[222:223], v23 offset:50176
    v_mul_f32 v181, v2, v181
    v_mfma_f32_16x16x32_bf16 v[128:131], a[104:107], v[236:239], v[128:131]
    ds_read_b64_tr_b16 v[224:225], v23 offset:51200
    ds_read_b64_tr_b16 v[226:227], v23 offset:52224
    v_exp_f32 v181, v181
    v_mfma_f32_16x16x32_bf16 v[128:131], a[108:111], v[240:243], v[128:131]
    v_add_f32 v181, 1.0, v181
    v_fma_f32 v3, v182, v182, s64
    v_mfma_f32_16x16x32_bf16 v[132:135], a[40:43], v[244:247], v[132:135]
    buffer_load_dwordx4 v8, s[40:43], s71 offen offset:1024 lds
    v_mfma_f32_16x16x32_bf16 v[132:135], a[44:47], v[248:251], v[132:135]
    s_add_u32 s72, s57, 292992
    ds_read_b64_tr_b16 v[236:237], v24 offset:49152
    ds_read_b64_tr_b16 v[238:239], v24 offset:50176
    v_rcp_f32 v181, v181
    v_mfma_f32_16x16x32_bf16 v[136:139], a[104:107], v[244:247], v[136:139]
    ds_read_b64_tr_b16 v[240:241], v24 offset:51200
    ds_read_b64_tr_b16 v[242:243], v24 offset:52224
    v_mfma_f32_16x16x32_bf16 v[136:139], a[108:111], v[248:251], v[136:139]
    s_waitcnt lgkmcnt(12)
    v_mul_f32 v197, v197, v181
    v_mul_f32 v198, v182, v198
    v_mfma_f32_16x16x32_bf16 v[76:79], v[204:207], a[48:51], v[76:79]
    ds_read_b64_tr_b16 v[244:245], v25 offset:49152
    ds_read_b64_tr_b16 v[246:247], v25 offset:50176
    v_mul_f32 v182, v3, v182
    v_mfma_f32_16x16x32_bf16 v[76:79], v[208:211], a[52:55], v[76:79]
    ds_read_b64_tr_b16 v[248:249], v25 offset:51200
    ds_read_b64_tr_b16 v[250:251], v25 offset:52224
    v_exp_f32 v182, v182
    v_mfma_f32_16x16x32_bf16 v[80:83], v[204:207], a[112:115], v[80:83]
    buffer_load_dwordx4 v8, s[36:39], s72 offen offset:2048 lds
    v_add_f32 v182, 1.0, v182
    v_mfma_f32_16x16x32_bf16 v[80:83], v[208:211], a[116:119], v[80:83]
    s_waitcnt lgkmcnt(12)
    v_rcp_f32 v182, v182
    v_mfma_f32_16x16x32_bf16 v[84:87], v[212:215], a[48:51], v[84:87]
    s_add_u32 s73, s57, 291968
    ds_read_b64_tr_b16 v[204:205], v26 offset:49152
    ds_read_b64_tr_b16 v[206:207], v26 offset:50176
    v_mfma_f32_16x16x32_bf16 v[84:87], v[216:219], a[52:55], v[84:87]
    ds_read_b64_tr_b16 v[208:209], v26 offset:51200
    ds_read_b64_tr_b16 v[210:211], v26 offset:52224
    v_mul_f32 v198, v198, v182
    v_fma_f32 v252, v183, v183, s64
    v_mfma_f32_16x16x32_bf16 v[88:91], v[212:215], a[112:115], v[88:91]
    v_mul_f32 v199, v183, v199
    v_mul_f32 v183, v252, v183
    v_mfma_f32_16x16x32_bf16 v[88:91], v[216:219], a[116:119], v[88:91]
    s_waitcnt lgkmcnt(12)
    v_exp_f32 v183, v183
    v_mfma_f32_16x16x32_bf16 v[100:103], a[48:51], v[220:223], v[100:103]
    buffer_load_dwordx4 v8, s[40:43], s73 offen offset:3072 lds
    v_mfma_f32_16x16x32_bf16 v[100:103], a[52:55], v[224:227], v[100:103]
    ds_read_b64_tr_b16 v[212:213], v27 offset:49152
    ds_read_b64_tr_b16 v[214:215], v27 offset:50176
    v_add_f32 v183, 1.0, v183
    v_mfma_f32_16x16x32_bf16 v[104:107], a[112:115], v[220:223], v[104:107]
    ds_read_b64_tr_b16 v[216:217], v27 offset:51200
    ds_read_b64_tr_b16 v[218:219], v27 offset:52224
    v_rcp_f32 v183, v183
    v_mfma_f32_16x16x32_bf16 v[104:107], a[116:119], v[224:227], v[104:107]
    s_waitcnt lgkmcnt(12)
    v_mul_f32 v199, v199, v183
    v_cvt_pk_bf16_f32 v150, v196, v197
    v_mfma_f32_16x16x32_bf16 v[108:111], a[48:51], v[236:239], v[108:111]
    v_cvt_pk_bf16_f32 v151, v198, v199
    v_fma_f32 v1, v152, v152, s64
    v_mfma_f32_16x16x32_bf16 v[108:111], a[52:55], v[240:243], v[108:111]
    ds_write_b128 v19, v[148:151] offset:0
    v_mfma_f32_16x16x32_bf16 v[112:115], a[112:115], v[236:239], v[112:115]
    s_nop 0
    v_and_b32 v148, -2, v148
    v_and_b32 v149, -2, v149
    v_mfma_f32_16x16x32_bf16 v[112:115], a[116:119], v[240:243], v[112:115]
    s_waitcnt lgkmcnt(9)
    s_waitcnt vmcnt(9) lgkmcnt(0)
    s_barrier
    s_cmp_eq_u32 s16, 7
    s_cbranch_scc1 L_sig7
L_sigb7:
    v_mfma_f32_16x16x32_bf16 v[116:119], a[48:51], v[244:247], v[116:119]
    s_add_u32 m0, s55, 49152
    ds_read_b64_tr_b16 v[220:221], v20 offset:0
    ds_read_b64_tr_b16 v[222:223], v20 offset:1024
    v_mfma_f32_16x16x32_bf16 v[116:119], a[52:55], v[248:251], v[116:119]
    s_add_u32 s70, s57, 589952
    ds_read_b64_tr_b16 v[224:225], v20 offset:2048
    ds_read_b64_tr_b16 v[226:227], v20 offset:3072
    v_mfma_f32_16x16x32_bf16 v[120:123], a[112:115], v[244:247], v[120:123]
    buffer_load_dwordx4 v8, s[36:39], s70 offen offset:0 lds
    v_and_b32 v150, -2, v150
    v_and_b32 v151, -2, v151
    v_mfma_f32_16x16x32_bf16 v[120:123], a[116:119], v[248:251], v[120:123]
    ds_read_b64_tr_b16 v[236:237], v21 offset:0
    ds_read_b64_tr_b16 v[238:239], v21 offset:1024
    v_mul_f32 v168, v152, v168
    v_mfma_f32_16x16x32_bf16 v[124:127], a[48:51], v[204:207], v[124:127]
    s_add_u32 s71, s57, 588928
    ds_read_b64_tr_b16 v[240:241], v21 offset:2048
    ds_read_b64_tr_b16 v[242:243], v21 offset:3072
    v_mul_f32 v152, v1, v152
    v_mfma_f32_16x16x32_bf16 v[124:127], a[52:55], v[208:211], v[124:127]
    buffer_store_dwordx4 v[148:151], v19, s[48:51], s12 offen offset:0 sc1
    v_exp_f32 v152, v152
    v_mfma_f32_16x16x32_bf16 v[128:131], a[112:115], v[204:207], v[128:131]
    buffer_load_dwordx4 v8, s[40:43], s71 offen offset:1024 lds
    v_add_f32 v152, 1.0, v152
    v_mfma_f32_16x16x32_bf16 v[128:131], a[116:119], v[208:211], v[128:131]
    ds_read_b64_tr_b16 v[244:245], v23 offset:0
    ds_read_b64_tr_b16 v[246:247], v23 offset:1024
    v_rcp_f32 v152, v152
    v_mfma_f32_16x16x32_bf16 v[132:135], a[48:51], v[212:215], v[132:135]
    s_add_u32 s72, s57, 882816
    ds_read_b64_tr_b16 v[248:249], v23 offset:2048
    ds_read_b64_tr_b16 v[250:251], v23 offset:3072
    v_mul_f32 v168, v168, v152
    v_mfma_f32_16x16x32_bf16 v[132:135], a[52:55], v[216:219], v[132:135]
    ds_read_b64_tr_b16 v[204:205], v24 offset:0
    ds_read_b64_tr_b16 v[206:207], v24 offset:1024
    v_fma_f32 v2, v153, v153, s64
    v_mfma_f32_16x16x32_bf16 v[136:139], a[112:115], v[212:215], v[136:139]
    buffer_load_dwordx4 v8, s[36:39], s72 offen offset:2048 lds
    v_mul_f32 v169, v153, v169
    v_mfma_f32_16x16x32_bf16 v[136:139], a[116:119], v[216:219], v[136:139]
    s_waitcnt lgkmcnt(10)
    ds_read_b64_tr_b16 v[208:209], v24 offset:2048
    ds_read_b64_tr_b16 v[210:211], v24 offset:3072
    v_mul_f32 v153, v2, v153
    v_fma_f32 v3, v154, v154, s64
    v_mfma_f32_16x16x32_bf16 v[76:79], v[220:223], a[56:59], v[76:79]
    s_add_u32 s73, s57, 881792
    ds_read_b64_tr_b16 v[212:213], v25 offset:0
    ds_read_b64_tr_b16 v[214:215], v25 offset:1024
    v_exp_f32 v153, v153
    v_mfma_f32_16x16x32_bf16 v[76:79], v[224:227], a[60:63], v[76:79]
    ds_read_b64_tr_b16 v[216:217], v25 offset:2048
    ds_read_b64_tr_b16 v[218:219], v25 offset:3072
    v_mfma_f32_16x16x32_bf16 v[80:83], v[220:223], a[120:123], v[80:83]
    buffer_load_dwordx4 v8, s[40:43], s73 offen offset:3072 lds
    v_add_f32 v153, 1.0, v153
    v_mfma_f32_16x16x32_bf16 v[80:83], v[224:227], a[124:127], v[80:83]
    s_waitcnt lgkmcnt(12)
    v_rcp_f32 v153, v153
    v_mfma_f32_16x16x32_bf16 v[84:87], v[236:239], a[56:59], v[84:87]
    s_add_u32 s11, s0, 256
    ds_read_b64_tr_b16 v[220:221], v26 offset:0
    ds_read_b64_tr_b16 v[222:223], v26 offset:1024
    v_mul_f32 v169, v169, v153
    v_mfma_f32_16x16x32_bf16 v[84:87], v[240:243], a[60:63], v[84:87]
    ds_read_b64_tr_b16 v[224:225], v26 offset:2048
    ds_read_b64_tr_b16 v[226:227], v26 offset:3072
    v_mul_f32 v170, v154, v170
    v_mfma_f32_16x16x32_bf16 v[88:91], v[236:239], a[120:123], v[88:91]
    buffer_load_dword v11, v6, s[36:39], s11 offen
    v_mul_f32 v154, v3, v154
    v_fma_f32 v252, v155, v155, s64
    v_mfma_f32_16x16x32_bf16 v[88:91], v[240:243], a[124:127], v[88:91]
    s_waitcnt lgkmcnt(12)
    v_exp_f32 v154, v154
    v_mfma_f32_16x16x32_bf16 v[100:103], a[56:59], v[244:247], v[100:103]
    ds_read_b64_tr_b16 v[236:237], v27 offset:0
    ds_read_b64_tr_b16 v[238:239], v27 offset:1024
    v_mfma_f32_16x16x32_bf16 v[100:103], a[60:63], v[248:251], v[100:103]
    ds_read_b64_tr_b16 v[240:241], v27 offset:2048
    ds_read_b64_tr_b16 v[242:243], v27 offset:3072
    v_add_f32 v154, 1.0, v154
    v_mul_f32 v171, v155, v171
    v_mfma_f32_16x16x32_bf16 v[104:107], a[120:123], v[244:247], v[104:107]
    buffer_load_dword v11, v6, s[40:43], s11 offen
    v_rcp_f32 v154, v154
    v_mfma_f32_16x16x32_bf16 v[104:107], a[124:127], v[248:251], v[104:107]
    s_waitcnt lgkmcnt(12)
    v_mul_f32 v170, v170, v154
    v_mul_f32 v155, v252, v155
    v_mfma_f32_16x16x32_bf16 v[108:111], a[56:59], v[204:207], v[108:111]
    v_exp_f32 v155, v155
    v_mfma_f32_16x16x32_bf16 v[108:111], a[60:63], v[208:211], v[108:111]
    v_add_f32 v155, 1.0, v155
    v_cvt_pk_bf16_f32 v152, v168, v169
    v_mfma_f32_16x16x32_bf16 v[112:115], a[120:123], v[204:207], v[112:115]
    s_waitcnt vmcnt(11) lgkmcnt(0)
    s_barrier
    v_mfma_f32_16x16x32_bf16 v[112:115], a[124:127], v[208:211], v[112:115]
    ds_read_b64_tr_b16 v[244:245], v20 offset:16384
    ds_read_b64_tr_b16 v[246:247], v20 offset:17408
    v_mfma_f32_16x16x32_bf16 v[116:119], a[56:59], v[212:215], v[116:119]
    s_add_u32 m0, s55, 0
    ds_read_b64_tr_b16 v[248:249], v20 offset:18432
    ds_read_b64_tr_b16 v[250:251], v20 offset:19456
    v_mfma_f32_16x16x32_bf16 v[116:119], a[60:63], v[216:219], v[116:119]
    s_add_u32 s70, s57, 1179776
    ds_read_b64_tr_b16 v[204:205], v21 offset:16384
    ds_read_b64_tr_b16 v[206:207], v21 offset:17408
    v_rcp_f32 v155, v155
    v_mfma_f32_16x16x32_bf16 v[120:123], a[120:123], v[212:215], v[120:123]
    buffer_load_dwordx4 v8, s[36:39], s70 offen offset:0 lds
    v_mul_f32 v171, v171, v155
    v_mfma_f32_16x16x32_bf16 v[120:123], a[124:127], v[216:219], v[120:123]
    ds_read_b64_tr_b16 v[208:209], v21 offset:18432
    ds_read_b64_tr_b16 v[210:211], v21 offset:19456
    v_cvt_pk_bf16_f32 v153, v170, v171
    v_mfma_f32_16x16x32_bf16 v[124:127], a[56:59], v[220:223], v[124:127]
    s_add_u32 s71, s57, 1178752
    ds_read_b64_tr_b16 v[212:213], v23 offset:16384
    ds_read_b64_tr_b16 v[214:215], v23 offset:17408
    v_fma_f32 v1, v184, v184, s64
    v_mul_f32 v200, v184, v200
    v_mfma_f32_16x16x32_bf16 v[124:127], a[60:63], v[224:227], v[124:127]
    ds_read_b64_tr_b16 v[216:217], v23 offset:18432
    ds_read_b64_tr_b16 v[218:219], v23 offset:19456
    v_mul_f32 v184, v1, v184
    v_mfma_f32_16x16x32_bf16 v[128:131], a[120:123], v[220:223], v[128:131]
    v_exp_f32 v184, v184
    v_mfma_f32_16x16x32_bf16 v[128:131], a[124:127], v[224:227], v[128:131]
    v_add_f32 v184, 1.0, v184
    v_fma_f32 v2, v185, v185, s64
    v_mfma_f32_16x16x32_bf16 v[132:135], a[56:59], v[236:239], v[132:135]
    buffer_load_dwordx4 v8, s[40:43], s71 offen offset:1024 lds
    v_mfma_f32_16x16x32_bf16 v[132:135], a[60:63], v[240:243], v[132:135]
    s_add_u32 s72, s57, 1472640
    ds_read_b64_tr_b16 v[220:221], v24 offset:16384
    ds_read_b64_tr_b16 v[222:223], v24 offset:17408
    v_rcp_f32 v184, v184
    v_mfma_f32_16x16x32_bf16 v[136:139], a[120:123], v[236:239], v[136:139]
    ds_read_b64_tr_b16 v[224:225], v24 offset:18432
    ds_read_b64_tr_b16 v[226:227], v24 offset:19456
    v_mfma_f32_16x16x32_bf16 v[136:139], a[124:127], v[240:243], v[136:139]
    s_waitcnt lgkmcnt(12)
    v_mul_f32 v200, v200, v184
    v_mul_f32 v201, v185, v201
    v_mfma_f32_16x16x32_bf16 v[76:79], v[244:247], v[44:47], v[76:79]
    ds_read_b64_tr_b16 v[236:237], v25 offset:16384
    ds_read_b64_tr_b16 v[238:239], v25 offset:17408
    v_mul_f32 v185, v2, v185
    v_mfma_f32_16x16x32_bf16 v[76:79], v[248:251], v[48:51], v[76:79]
    buffer_load_dwordx4 v8, s[36:39], s72 offen offset:2048 lds
    v_exp_f32 v185, v185
    v_mfma_f32_16x16x32_bf16 v[80:83], v[244:247], v[52:55], v[80:83]
    s_add_u32 s73, s57, 1471616
    ds_read_b64_tr_b16 v[240:241], v25 offset:18432
    ds_read_b64_tr_b16 v[242:243], v25 offset:19456
    v_mfma_f32_16x16x32_bf16 v[80:83], v[248:251], v[56:59], v[80:83]
    s_waitcnt lgkmcnt(12)
    v_add_f32 v185, 1.0, v185
    v_fma_f32 v3, v186, v186, s64
    v_mfma_f32_16x16x32_bf16 v[84:87], v[204:207], v[44:47], v[84:87]
    ds_read_b64_tr_b16 v[244:245], v26 offset:16384
    ds_read_b64_tr_b16 v[246:247], v26 offset:17408
    v_rcp_f32 v185, v185
    v_mfma_f32_16x16x32_bf16 v[84:87], v[208:211], v[48:51], v[84:87]
L_pad3:
    s_cbranch_execz L_pad4
    ds_read_b64_tr_b16 v[248:249], v26 offset:18432
    ds_read_b64_tr_b16 v[250:251], v26 offset:19456
    v_mfma_f32_16x16x32_bf16 v[88:91], v[204:207], v[52:55], v[88:91]
    v_mul_f32 v201, v201, v185
    v_mul_f32 v202, v186, v202
    v_mfma_f32_16x16x32_bf16 v[88:91], v[208:211], v[56:59], v[88:91]
    s_waitcnt lgkmcnt(12)
    v_mul_f32 v186, v3, v186
    v_fma_f32 v252, v187, v187, s64
    v_mfma_f32_16x16x32_bf16 v[100:103], v[44:47], v[212:215], v[100:103]
    buffer_load_dwordx4 v8, s[40:43], s73 offen offset:3072 lds
    v_mfma_f32_16x16x32_bf16 v[100:103], v[48:51], v[216:219], v[100:103]
    ds_read_b64_tr_b16 v[204:205], v27 offset:16384
    ds_read_b64_tr_b16 v[206:207], v27 offset:17408
    v_exp_f32 v186, v186
    v_mfma_f32_16x16x32_bf16 v[104:107], v[52:55], v[212:215], v[104:107]
    ds_read_b64_tr_b16 v[208:209], v27 offset:18432
    ds_read_b64_tr_b16 v[210:211], v27 offset:19456
    v_add_f32 v186, 1.0, v186
    v_mfma_f32_16x16x32_bf16 v[104:107], v[56:59], v[216:219], v[104:107]
    s_waitcnt lgkmcnt(12)
    v_rcp_f32 v186, v186
    v_mfma_f32_16x16x32_bf16 v[108:111], v[44:47], v[220:223], v[108:111]
    v_mul_f32 v202, v202, v186
    v_mul_f32 v203, v187, v203
    v_mfma_f32_16x16x32_bf16 v[108:111], v[48:51], v[224:227], v[108:111]
    v_mul_f32 v187, v252, v187
    v_cvt_pk_bf16_f32 v154, v200, v201
    v_mfma_f32_16x16x32_bf16 v[112:115], v[52:55], v[220:223], v[112:115]
    v_exp_f32 v187, v187
    v_mfma_f32_16x16x32_bf16 v[112:115], v[56:59], v[224:227], v[112:115]
    s_waitcnt lgkmcnt(8)
    s_waitcnt vmcnt(11) lgkmcnt(0)
    s_barrier
    v_mfma_f32_16x16x32_bf16 v[116:119], v[44:47], v[236:239], v[116:119]
    s_add_u32 m0, s55, 16384
    ds_read_b64_tr_b16 v[212:213], v12 offset:32768
    v_add_f32 v187, 1.0, v187
    v_mfma_f32_16x16x32_bf16 v[116:119], v[48:51], v[240:243], v[116:119]
    s_add_u32 s70, s57, 1769600
    ds_read_b64_tr_b16 v[214:215], v12 offset:33280
    ds_read_b64_tr_b16 v[216:217], v12 offset:34816
    v_mfma_f32_16x16x32_bf16 v[120:123], v[52:55], v[236:239], v[120:123]
    buffer_load_dwordx4 v8, s[36:39], s70 offen offset:0 lds
    v_rcp_f32 v187, v187
    v_mfma_f32_16x16x32_bf16 v[120:123], v[56:59], v[240:243], v[120:123]
    ds_read_b64_tr_b16 v[218:219], v12 offset:35328
    v_mul_f32 v203, v203, v187
    v_mfma_f32_16x16x32_bf16 v[124:127], v[44:47], v[244:247], v[124:127]
    s_add_u32 s71, s57, 1768576
    ds_read_b64_tr_b16 v[220:221], v12 offset:33792
    v_cvt_pk_bf16_f32 v155, v202, v203
    v_mfma_f32_16x16x32_bf16 v[124:127], v[48:51], v[248:251], v[124:127]
    ds_read_b64_tr_b16 v[222:223], v12 offset:34304
    ds_write_b128 v19, v[152:155] offset:1024
    v_mfma_f32_16x16x32_bf16 v[128:131], v[52:55], v[244:247], v[128:131]
    ds_read_b64_tr_b16 v[224:225], v12 offset:35840
    v_and_b32 v152, -2, v152
    v_mfma_f32_16x16x32_bf16 v[128:131], v[56:59], v[248:251], v[128:131]
    ds_read_b64_tr_b16 v[226:227], v12 offset:36352
    v_and_b32 v153, -2, v153
    v_mfma_f32_16x16x32_bf16 v[132:135], v[44:47], v[204:207], v[132:135]
    v_and_b32 v154, -2, v154
    v_and_b32 v155, -2, v155
    v_mfma_f32_16x16x32_bf16 v[132:135], v[48:51], v[208:211], v[132:135]
    buffer_store_dwordx4 v[152:155], v19, s[48:51], s12 offen offset:1024 sc1
    v_mfma_f32_16x16x32_bf16 v[136:139], v[52:55], v[204:207], v[136:139]
    buffer_load_dwordx4 v8, s[40:43], s71 offen offset:1024 lds
    v_mfma_f32_16x16x32_bf16 v[136:139], v[56:59], v[208:211], v[136:139]
    s_waitcnt lgkmcnt(5)
    s_add_u32 s12, s12, 16384
    v_mfma_f32_16x16x32_bf16 v[140:143], v[212:215], a[0:3], 0
    s_add_u32 s72, s57, 2062464
    ds_read_b64_tr_b16 v[204:205], v13 offset:32768
    s_mov_b32 s83, 0xb4fb9d56
    v_mfma_f32_16x16x32_bf16 v[140:143], v[216:219], a[4:7], v[140:143]
    s_mul_i32 s82, s54, 3072
    ds_read_b64_tr_b16 v[206:207], v13 offset:33280
    v_mov_b32 v255, 0x3f803f80
    v_mfma_f32_16x16x32_bf16 v[144:147], v[212:215], a[64:67], 0
    s_add_u32 s82, s82, s63
    ds_read_b64_tr_b16 v[208:209], v13 offset:34816
    v_mul_f32 v1, s66, v100
    v_mfma_f32_16x16x32_bf16 v[144:147], v[216:219], a[68:71], v[144:147]
    s_mov_b32 s84, 0x00c0000c
    ds_read_b64_tr_b16 v[210:211], v13 offset:35328
    v_min_f32 v100, s83, v100
    v_mfma_f32_16x16x32_bf16 v[148:151], v[212:215], a[128:131], 0
    buffer_load_dwordx4 v8, s[36:39], s72 offen offset:2048 lds
    v_mfma_f32_16x16x32_bf16 v[148:151], v[216:219], a[132:135], v[148:151]
    s_add_u32 s73, s57, 2061440
    v_exp_f32_e64 v1, v1 clamp
    v_mfma_f32_16x16x32_bf16 v[152:155], v[212:215], a[192:195], 0
    s_mov_b32 s85, 0xc0000c00
    v_fma_f32 v100, v100, s67, v1
    v_mul_f32 v2, s66, v101
    v_mfma_f32_16x16x32_bf16 v[152:155], v[216:219], a[196:199], v[152:155]
    s_waitcnt lgkmcnt(4)
    v_exp_f32_e64 v2, v2 clamp
    v_mfma_f32_16x16x32_bf16 v[156:159], v[220:223], a[0:3], 0
    s_lshl_b32 s87, s52, 10
    ds_read_b64_tr_b16 v[212:213], v13 offset:33792
    v_min_f32 v101, s83, v101
    v_mfma_f32_16x16x32_bf16 v[156:159], v[224:227], a[4:7], v[156:159]
    s_add_u32 s87, s87, 4096
    ds_read_b64_tr_b16 v[214:215], v13 offset:34304
    v_fma_f32 v101, v101, s67, v2
    v_mfma_f32_16x16x32_bf16 v[160:163], v[220:223], a[64:67], 0
    ds_read_b64_tr_b16 v[216:217], v13 offset:35840
    v_mul_f32 v3, s66, v102
    v_mfma_f32_16x16x32_bf16 v[160:163], v[224:227], a[68:71], v[160:163]
    buffer_load_dwordx4 v8, s[40:43], s73 offen offset:3072 lds
    v_mfma_f32_16x16x32_bf16 v[164:167], v[220:223], a[128:131], 0
    ds_read_b64_tr_b16 v[218:219], v13 offset:36352
    v_min_f32 v102, s83, v102
    v_mfma_f32_16x16x32_bf16 v[164:167], v[224:227], a[132:135], v[164:167]
    v_exp_f32_e64 v3, v3 clamp
    v_mfma_f32_16x16x32_bf16 v[168:171], v[220:223], a[192:195], 0
    v_fma_f32 v102, v102, s67, v3
    v_mul_f32 v4, s66, v103
    v_mfma_f32_16x16x32_bf16 v[168:171], v[224:227], a[196:199], v[168:171]
    s_waitcnt lgkmcnt(4)
    v_exp_f32_e64 v4, v4 clamp
    v_mfma_f32_16x16x32_bf16 v[172:175], v[204:207], a[0:3], 0
    v_min_f32 v103, s83, v103
    v_mul_f32 v252, s66, v104
    v_mfma_f32_16x16x32_bf16 v[172:175], v[208:211], a[4:7], v[172:175]
    s_waitcnt vmcnt(11) lgkmcnt(0)
    s_barrier
    v_mfma_f32_16x16x32_bf16 v[176:179], v[204:207], a[64:67], 0
    s_add_u32 m0, s55, 32768
    ds_read_b64_tr_b16 v[220:221], v12 offset:49152
    v_fma_f32 v103, v103, s67, v4
    v_mfma_f32_16x16x32_bf16 v[176:179], v[208:211], a[68:71], v[176:179]
    s_add_u32 s70, s57, 2359424
    ds_read_b64_tr_b16 v[222:223], v12 offset:49664
    v_min_f32 v104, s83, v104
    v_mfma_f32_16x16x32_bf16 v[180:183], v[204:207], a[128:131], 0
    buffer_load_dwordx4 v8, s[36:39], s70 offen offset:0 lds
    v_mfma_f32_16x16x32_bf16 v[180:183], v[208:211], a[132:135], v[180:183]
    s_add_u32 s71, s57, 2358400
    ds_read_b64_tr_b16 v[224:225], v12 offset:51200
    ds_read_b64_tr_b16 v[226:227], v12 offset:51712
    v_mfma_f32_16x16x32_bf16 v[184:187], v[204:207], a[192:195], 0
    v_exp_f32_e64 v252, v252 clamp
    v_mfma_f32_16x16x32_bf16 v[184:187], v[208:211], a[196:199], v[184:187]
    v_fma_f32 v104, v104, s67, v252
    v_mul_f32 v253, s66, v105
    v_mfma_f32_16x16x32_bf16 v[188:191], v[212:215], a[0:3], 0
    ds_read_b64_tr_b16 v[204:205], v12 offset:50176
    v_min_f32 v105, s83, v105
    v_mfma_f32_16x16x32_bf16 v[188:191], v[216:219], a[4:7], v[188:191]
    ds_read_b64_tr_b16 v[206:207], v12 offset:50688
    v_mul_f32 v254, s66, v106
    v_mfma_f32_16x16x32_bf16 v[192:195], v[212:215], a[64:67], 0
    ds_read_b64_tr_b16 v[208:209], v12 offset:52224
    v_min_f32 v106, s83, v106
    v_mfma_f32_16x16x32_bf16 v[192:195], v[216:219], a[68:71], v[192:195]
    buffer_load_dwordx4 v8, s[40:43], s71 offen offset:1024 lds
    v_mfma_f32_16x16x32_bf16 v[196:199], v[212:215], a[128:131], 0
    s_add_u32 s72, s57, 2652288
    ds_read_b64_tr_b16 v[210:211], v12 offset:52736
    v_mul_f32 v1, s66, v107
    v_mfma_f32_16x16x32_bf16 v[196:199], v[216:219], a[132:135], v[196:199]
    v_exp_f32_e64 v253, v253 clamp
    v_mfma_f32_16x16x32_bf16 v[200:203], v[212:215], a[192:195], 0
    v_exp_f32_e64 v254, v254 clamp
    v_mfma_f32_16x16x32_bf16 v[200:203], v[216:219], a[196:199], v[200:203]
    s_waitcnt lgkmcnt(4)
    v_exp_f32_e64 v1, v1 clamp
    v_mfma_f32_16x16x32_bf16 v[140:143], v[220:223], a[8:11], v[140:143]
    ds_read_b64_tr_b16 v[212:213], v13 offset:49152
    v_fma_f32 v105, v105, s67, v253
    v_mfma_f32_16x16x32_bf16 v[140:143], v[224:227], a[12:15], v[140:143]
    ds_read_b64_tr_b16 v[214:215], v13 offset:49664
    v_fma_f32 v106, v106, s67, v254
    v_mfma_f32_16x16x32_bf16 v[144:147], v[220:223], a[72:75], v[144:147]
    buffer_load_dwordx4 v8, s[36:39], s72 offen offset:2048 lds
    v_mfma_f32_16x16x32_bf16 v[144:147], v[224:227], a[76:79], v[144:147]
    s_add_u32 s73, s57, 2651264
    ds_read_b64_tr_b16 v[216:217], v13 offset:51200
    v_min_f32 v107, s83, v107
    v_mfma_f32_16x16x32_bf16 v[148:151], v[220:223], a[136:139], v[148:151]
    ds_read_b64_tr_b16 v[218:219], v13 offset:51712
    v_fma_f32 v107, v107, s67, v1
    v_mfma_f32_16x16x32_bf16 v[148:151], v[224:227], a[140:143], v[148:151]
    v_mul_f32 v2, s66, v108
    v_min_f32 v108, s83, v108
    v_mfma_f32_16x16x32_bf16 v[152:155], v[220:223], a[200:203], v[152:155]
    v_exp_f32_e64 v2, v2 clamp
    v_mfma_f32_16x16x32_bf16 v[152:155], v[224:227], a[204:207], v[152:155]
    s_waitcnt lgkmcnt(4)
    v_fma_f32 v108, v108, s67, v2
    v_mul_f32 v3, s66, v109
    v_mfma_f32_16x16x32_bf16 v[156:159], v[204:207], a[8:11], v[156:159]
    ds_read_b64_tr_b16 v[220:221], v13 offset:50176
    v_min_f32 v109, s83, v109
    v_mfma_f32_16x16x32_bf16 v[156:159], v[208:211], a[12:15], v[156:159]
    buffer_load_dwordx4 v8, s[40:43], s73 offen offset:3072 lds
    v_mfma_f32_16x16x32_bf16 v[160:163], v[204:207], a[72:75], v[160:163]
    ds_read_b64_tr_b16 v[222:223], v13 offset:50688
    v_mul_f32 v4, s66, v110
    v_mfma_f32_16x16x32_bf16 v[160:163], v[208:211], a[76:79], v[160:163]
    ds_read_b64_tr_b16 v[224:225], v13 offset:52224
    v_min_f32 v110, s83, v110
    v_mfma_f32_16x16x32_bf16 v[164:167], v[204:207], a[136:139], v[164:167]
    ds_read_b64_tr_b16 v[226:227], v13 offset:52736
    v_mul_f32 v252, s66, v111
    v_mfma_f32_16x16x32_bf16 v[164:167], v[208:211], a[140:143], v[164:167]
    v_exp_f32_e64 v3, v3 clamp
    v_mfma_f32_16x16x32_bf16 v[168:171], v[204:207], a[200:203], v[168:171]
    v_exp_f32_e64 v4, v4 clamp
    v_mfma_f32_16x16x32_bf16 v[168:171], v[208:211], a[204:207], v[168:171]
    s_waitcnt lgkmcnt(4)
    v_exp_f32_e64 v252, v252 clamp
    v_mfma_f32_16x16x32_bf16 v[172:175], v[212:215], a[8:11], v[172:175]
    v_fma_f32 v109, v109, s67, v3
    v_fma_f32 v110, v110, s67, v4
    v_mfma_f32_16x16x32_bf16 v[172:175], v[216:219], a[12:15], v[172:175]
    s_waitcnt vmcnt(9) lgkmcnt(0)
    s_barrier
    v_mfma_f32_16x16x32_bf16 v[176:179], v[212:215], a[72:75], v[176:179]
    s_add_u32 m0, s55, 49152
    ds_read_b64_tr_b16 v[204:205], v12 offset:0
    v_min_f32 v111, s83, v111
    v_mfma_f32_16x16x32_bf16 v[176:179], v[216:219], a[76:79], v[176:179]
    s_add_u32 s70, s57, 2949248
    ds_read_b64_tr_b16 v[206:207], v12 offset:512
    v_fma_f32 v111, v111, s67, v252
    v_mfma_f32_16x16x32_bf16 v[180:183], v[212:215], a[136:139], v[180:183]
    buffer_load_dwordx4 v8, s[36:39], s70 offen offset:0 lds
    v_mfma_f32_16x16x32_bf16 v[180:183], v[216:219], a[140:143], v[180:183]
    s_add_u32 s71, s57, 2948224
    ds_read_b64_tr_b16 v[208:209], v12 offset:2048
    ds_read_b64_tr_b16 v[210:211], v12 offset:2560
    v_mfma_f32_16x16x32_bf16 v[184:187], v[212:215], a[200:203], v[184:187]
    v_mul_f32 v253, s66, v112
    v_min_f32 v112, s83, v112
    v_mfma_f32_16x16x32_bf16 v[184:187], v[216:219], a[204:207], v[184:187]
    v_exp_f32_e64 v253, v253 clamp
    v_mfma_f32_16x16x32_bf16 v[188:191], v[220:223], a[8:11], v[188:191]
    buffer_load_dwordx4 v8, s[40:43], s71 offen offset:1024 lds
    v_mfma_f32_16x16x32_bf16 v[188:191], v[224:227], a[12:15], v[188:191]
    s_add_u32 s72, s57, 3242112
    ds_read_b64_tr_b16 v[212:213], v12 offset:1024
    v_fma_f32 v112, v112, s67, v253
    v_mfma_f32_16x16x32_bf16 v[192:195], v[220:223], a[72:75], v[192:195]
    ds_read_b64_tr_b16 v[214:215], v12 offset:1536
    v_mul_f32 v254, s66, v113
    v_mfma_f32_16x16x32_bf16 v[192:195], v[224:227], a[76:79], v[192:195]
    ds_read_b64_tr_b16 v[216:217], v12 offset:3072
    v_min_f32 v113, s83, v113
    v_mfma_f32_16x16x32_bf16 v[196:199], v[220:223], a[136:139], v[196:199]
    buffer_load_dwordx4 v8, s[36:39], s72 offen offset:2048 lds
    v_mfma_f32_16x16x32_bf16 v[196:199], v[224:227], a[140:143], v[196:199]
    s_add_u32 s73, s57, 3241088
    ds_read_b64_tr_b16 v[218:219], v12 offset:3584
    v_mul_f32 v1, s66, v114
    v_mfma_f32_16x16x32_bf16 v[200:203], v[220:223], a[200:203], v[200:203]
    v_exp_f32_e64 v254, v254 clamp
    v_mfma_f32_16x16x32_bf16 v[200:203], v[224:227], a[204:207], v[200:203]
    s_waitcnt lgkmcnt(4)
    v_exp_f32_e64 v1, v1 clamp
    v_mfma_f32_16x16x32_bf16 v[140:143], v[204:207], a[16:19], v[140:143]
    ds_read_b64_tr_b16 v[220:221], v13 offset:0
    v_fma_f32 v113, v113, s67, v254
    v_mfma_f32_16x16x32_bf16 v[140:143], v[208:211], a[20:23], v[140:143]
    buffer_load_dwordx4 v8, s[40:43], s73 offen offset:3072 lds
    v_mfma_f32_16x16x32_bf16 v[144:147], v[204:207], a[80:83], v[144:147]
    s_add_u32 s11, s3, 0
    ds_read_b64_tr_b16 v[222:223], v13 offset:512
    v_min_f32 v114, s83, v114
    v_mfma_f32_16x16x32_bf16 v[144:147], v[208:211], a[84:87], v[144:147]
    ds_read_b64_tr_b16 v[224:225], v13 offset:2048
    v_fma_f32 v114, v114, s67, v1
    v_mfma_f32_16x16x32_bf16 v[148:151], v[204:207], a[144:147], v[148:151]
    ds_read_b64_tr_b16 v[226:227], v13 offset:2560
    v_mul_f32 v2, s66, v115
    v_mfma_f32_16x16x32_bf16 v[148:151], v[208:211], a[148:151], v[148:151]
    v_exp_f32_e64 v2, v2 clamp
    v_mfma_f32_16x16x32_bf16 v[152:155], v[204:207], a[208:211], v[152:155]
    buffer_load_dword v11, v7, s[44:47], s11 offen
    v_mfma_f32_16x16x32_bf16 v[152:155], v[208:211], a[212:215], v[152:155]
    s_waitcnt lgkmcnt(4)
    v_min_f32 v115, s83, v115
    v_mul_f32 v3, s66, v132
    v_mfma_f32_16x16x32_bf16 v[156:159], v[212:215], a[16:19], v[156:159]
    ds_read_b64_tr_b16 v[204:205], v13 offset:1024
    v_fma_f32 v115, v115, s67, v2
    v_mfma_f32_16x16x32_bf16 v[156:159], v[216:219], a[20:23], v[156:159]
    ds_read_b64_tr_b16 v[206:207], v13 offset:1536
    v_min_f32 v236, s83, v132
    v_mfma_f32_16x16x32_bf16 v[160:163], v[212:215], a[80:83], v[160:163]
    ds_read_b64_tr_b16 v[208:209], v13 offset:3072
    v_mul_f32 v4, s66, v133
    v_mfma_f32_16x16x32_bf16 v[160:163], v[216:219], a[84:87], v[160:163]
    buffer_load_dword v11, v7, s[32:35], s10 offen
    v_mfma_f32_16x16x32_bf16 v[164:167], v[212:215], a[144:147], v[164:167]
    ds_read_b64_tr_b16 v[210:211], v13 offset:3584
    v_min_f32 v237, s83, v133
    v_mfma_f32_16x16x32_bf16 v[164:167], v[216:219], a[148:151], v[164:167]
    v_exp_f32_e64 v3, v3 clamp
    v_mfma_f32_16x16x32_bf16 v[168:171], v[212:215], a[208:211], v[168:171]
    v_exp_f32_e64 v4, v4 clamp
    v_mfma_f32_16x16x32_bf16 v[168:171], v[216:219], a[212:215], v[168:171]
    s_waitcnt lgkmcnt(4)
    v_fma_f32 v236, v236, s67, v3
    v_fma_f32 v237, v237, s67, v4
    v_mfma_f32_16x16x32_bf16 v[172:175], v[220:223], a[16:19], v[172:175]
    v_cndmask_b32 v132, v132, v236, s[74:75]
    v_cndmask_b32 v133, v133, v237, s[74:75]
    v_mfma_f32_16x16x32_bf16 v[172:175], v[224:227], a[20:23], v[172:175]
    s_waitcnt vmcnt(10) lgkmcnt(0)
    s_barrier
    v_mfma_f32_16x16x32_bf16 v[176:179], v[220:223], a[80:83], v[176:179]
    s_add_u32 m0, s55, 0
    ds_read_b64_tr_b16 v[212:213], v12 offset:16384
    v_mul_f32 v252, s66, v134
    v_mfma_f32_16x16x32_bf16 v[176:179], v[224:227], a[84:87], v[176:179]
    s_add_u32 s70, s57, 3539072
    ds_read_b64_tr_b16 v[214:215], v12 offset:16896
    v_min_f32 v238, s83, v134
    v_mfma_f32_16x16x32_bf16 v[180:183], v[220:223], a[144:147], v[180:183]
    buffer_load_dwordx4 v8, s[36:39], s70 offen offset:0 lds
    v_mfma_f32_16x16x32_bf16 v[180:183], v[224:227], a[148:151], v[180:183]
    s_add_u32 s71, s57, 3538048
    ds_read_b64_tr_b16 v[216:217], v12 offset:18432
    ds_read_b64_tr_b16 v[218:219], v12 offset:18944
    v_mfma_f32_16x16x32_bf16 v[184:187], v[220:223], a[208:211], v[184:187]
    v_exp_f32_e64 v252, v252 clamp
    v_mfma_f32_16x16x32_bf16 v[184:187], v[224:227], a[212:215], v[184:187]
    v_fma_f32 v238, v238, s67, v252
    v_mul_f32 v253, s66, v135
    v_mfma_f32_16x16x32_bf16 v[188:191], v[204:207], a[16:19], v[188:191]
    ds_read_b64_tr_b16 v[220:221], v12 offset:17408
    v_cndmask_b32 v134, v134, v238, s[74:75]
    v_mfma_f32_16x16x32_bf16 v[188:191], v[208:211], a[20:23], v[188:191]
    ds_read_b64_tr_b16 v[222:223], v12 offset:17920
    v_min_f32 v239, s83, v135
    v_mfma_f32_16x16x32_bf16 v[192:195], v[204:207], a[80:83], v[192:195]
    ds_read_b64_tr_b16 v[224:225], v12 offset:19456
    v_mul_f32 v254, s66, v136
    v_mfma_f32_16x16x32_bf16 v[192:195], v[208:211], a[84:87], v[192:195]
    buffer_load_dwordx4 v8, s[40:43], s71 offen offset:1024 lds
    v_mfma_f32_16x16x32_bf16 v[196:199], v[204:207], a[144:147], v[196:199]
    s_add_u32 s72, s57, 3831936
    ds_read_b64_tr_b16 v[226:227], v12 offset:19968
    v_min_f32 v240, s83, v136
    v_mfma_f32_16x16x32_bf16 v[196:199], v[208:211], a[148:151], v[196:199]
    v_exp_f32_e64 v253, v253 clamp
    v_mfma_f32_16x16x32_bf16 v[200:203], v[204:207], a[208:211], v[200:203]
    v_exp_f32_e64 v254, v254 clamp
    v_mfma_f32_16x16x32_bf16 v[200:203], v[208:211], a[212:215], v[200:203]
    s_waitcnt lgkmcnt(4)
    v_fma_f32 v239, v239, s67, v253
    v_fma_f32 v240, v240, s67, v254
    v_mfma_f32_16x16x32_bf16 v[140:143], v[212:215], a[24:27], v[140:143]
    ds_read_b64_tr_b16 v[204:205], v13 offset:16384
    v_cndmask_b32 v135, v135, v239, s[74:75]
    v_mfma_f32_16x16x32_bf16 v[140:143], v[216:219], a[28:31], v[140:143]
    ds_read_b64_tr_b16 v[206:207], v13 offset:16896
    v_cndmask_b32 v136, v136, v240, s[74:75]
    v_mfma_f32_16x16x32_bf16 v[144:147], v[212:215], a[88:91], v[144:147]
    buffer_load_dwordx4 v8, s[36:39], s72 offen offset:2048 lds
    v_mfma_f32_16x16x32_bf16 v[144:147], v[216:219], a[92:95], v[144:147]
    s_add_u32 s73, s57, 3830912
    ds_read_b64_tr_b16 v[208:209], v13 offset:18432
    v_mul_f32 v1, s66, v137
    v_mfma_f32_16x16x32_bf16 v[148:151], v[212:215], a[152:155], v[148:151]
    ds_read_b64_tr_b16 v[210:211], v13 offset:18944
    v_min_f32 v241, s83, v137
    v_mfma_f32_16x16x32_bf16 v[148:151], v[216:219], a[156:159], v[148:151]
    v_exp_f32_e64 v1, v1 clamp
    v_mfma_f32_16x16x32_bf16 v[152:155], v[212:215], a[216:219], v[152:155]
    v_fma_f32 v241, v241, s67, v1
    v_mul_f32 v2, s66, v138
    v_mfma_f32_16x16x32_bf16 v[152:155], v[216:219], a[220:223], v[152:155]
    s_waitcnt lgkmcnt(4)
    v_exp_f32_e64 v2, v2 clamp
    v_mfma_f32_16x16x32_bf16 v[156:159], v[220:223], a[24:27], v[156:159]
    ds_read_b64_tr_b16 v[212:213], v13 offset:17408
    v_cndmask_b32 v137, v137, v241, s[74:75]
    v_mfma_f32_16x16x32_bf16 v[156:159], v[224:227], a[28:31], v[156:159]
    buffer_load_dwordx4 v8, s[40:43], s73 offen offset:3072 lds
    v_mfma_f32_16x16x32_bf16 v[160:163], v[220:223], a[88:91], v[160:163]
    ds_read_b64_tr_b16 v[214:215], v13 offset:17920
    v_min_f32 v242, s83, v138
    v_mfma_f32_16x16x32_bf16 v[160:163], v[224:227], a[92:95], v[160:163]
    ds_read_b64_tr_b16 v[216:217], v13 offset:19456
    v_fma_f32 v242, v242, s67, v2
    v_mfma_f32_16x16x32_bf16 v[164:167], v[220:223], a[152:155], v[164:167]
    ds_read_b64_tr_b16 v[218:219], v13 offset:19968
    v_cndmask_b32 v138, v138, v242, s[74:75]
    v_mfma_f32_16x16x32_bf16 v[164:167], v[224:227], a[156:159], v[164:167]
    v_mul_f32 v3, s66, v139
    v_min_f32 v243, s83, v139
    v_mfma_f32_16x16x32_bf16 v[168:171], v[220:223], a[216:219], v[168:171]
    v_exp_f32_e64 v3, v3 clamp
    v_mfma_f32_16x16x32_bf16 v[168:171], v[224:227], a[220:223], v[168:171]
    s_waitcnt lgkmcnt(4)
    v_fma_f32 v243, v243, s67, v3
    v_cvt_pk_bf16_f32 v100, v100, v101
    v_mfma_f32_16x16x32_bf16 v[172:175], v[204:207], a[24:27], v[172:175]
    v_cndmask_b32 v139, v139, v243, s[74:75]
    v_cvt_pk_bf16_f32 v101, v102, v103
    v_mfma_f32_16x16x32_bf16 v[172:175], v[208:211], a[28:31], v[172:175]
    s_waitcnt vmcnt(10) lgkmcnt(0)
    s_barrier
    v_mfma_f32_16x16x32_bf16 v[176:179], v[204:207], a[88:91], v[176:179]
    s_add_u32 m0, s55, 16384
    ds_read_b64_tr_b16 v[220:221], v12 offset:32768
    v_cvt_pk_bf16_f32 v102, v104, v105
    v_mfma_f32_16x16x32_bf16 v[176:179], v[208:211], a[92:95], v[176:179]
    s_add_u32 s70, s57, 4128896
    ds_read_b64_tr_b16 v[222:223], v12 offset:33280
    v_cvt_pk_bf16_f32 v103, v106, v107
    v_mfma_f32_16x16x32_bf16 v[180:183], v[204:207], a[152:155], v[180:183]
    buffer_load_dwordx4 v8, s[36:39], s70 offen offset:0 lds
    v_mfma_f32_16x16x32_bf16 v[180:183], v[208:211], a[156:159], v[180:183]
    s_add_u32 s71, s57, 4127872
    ds_read_b64_tr_b16 v[224:225], v12 offset:34816
    ds_read_b64_tr_b16 v[226:227], v12 offset:35328
    v_mfma_f32_16x16x32_bf16 v[184:187], v[204:207], a[216:219], v[184:187]
    v_cvt_pk_bf16_f32 v108, v108, v109
    v_cvt_pk_bf16_f32 v109, v110, v111
    v_mfma_f32_16x16x32_bf16 v[184:187], v[208:211], a[220:223], v[184:187]
    v_cvt_pk_bf16_f32 v110, v112, v113
    v_cvt_pk_bf16_f32 v111, v114, v115
    v_mfma_f32_16x16x32_bf16 v[188:191], v[212:215], a[24:27], v[188:191]
    ds_read_b64_tr_b16 v[204:205], v12 offset:33792
    v_cvt_pk_bf16_f32 v116, v116, v117
    v_mfma_f32_16x16x32_bf16 v[188:191], v[216:219], a[28:31], v[188:191]
    ds_read_b64_tr_b16 v[206:207], v12 offset:34304
    v_cvt_pk_bf16_f32 v117, v118, v119
    v_mfma_f32_16x16x32_bf16 v[192:195], v[212:215], a[88:91], v[192:195]
    ds_read_b64_tr_b16 v[208:209], v12 offset:35840
    v_cvt_pk_bf16_f32 v118, v120, v121
    v_mfma_f32_16x16x32_bf16 v[192:195], v[216:219], a[92:95], v[192:195]
    buffer_load_dwordx4 v8, s[40:43], s71 offen offset:1024 lds
    v_mfma_f32_16x16x32_bf16 v[196:199], v[212:215], a[152:155], v[196:199]
    s_add_u32 s72, s57, 4421760
    ds_read_b64_tr_b16 v[210:211], v12 offset:36352
    v_cvt_pk_bf16_f32 v119, v122, v123
    v_mfma_f32_16x16x32_bf16 v[196:199], v[216:219], a[156:159], v[196:199]
    s_nop 0
    v_mfma_f32_16x16x32_bf16 v[104:107], v[100:103], v[116:119], 0
    v_mfma_f32_16x16x32_bf16 v[200:203], v[212:215], a[216:219], v[200:203]
    v_cvt_pk_bf16_f32 v124, v124, v125
    v_cvt_pk_bf16_f32 v125, v126, v127
    v_mfma_f32_16x16x32_bf16 v[200:203], v[216:219], a[220:223], v[200:203]
    s_waitcnt lgkmcnt(4)
    v_cvt_pk_bf16_f32 v126, v128, v129
    v_cvt_pk_bf16_f32 v127, v130, v131
    v_mfma_f32_16x16x32_bf16 v[140:143], v[220:223], a[32:35], v[140:143]
    ds_read_b64_tr_b16 v[212:213], v13 offset:32768
    v_cvt_pk_bf16_f32 v132, v132, v133
    v_mfma_f32_16x16x32_bf16 v[140:143], v[224:227], a[36:39], v[140:143]
    ds_read_b64_tr_b16 v[214:215], v13 offset:33280
    v_cndmask_b32 v132, v132, v255, s[76:77]
    v_mfma_f32_16x16x32_bf16 v[144:147], v[220:223], a[96:99], v[144:147]
    buffer_load_dwordx4 v8, s[36:39], s72 offen offset:2048 lds
    v_mfma_f32_16x16x32_bf16 v[144:147], v[224:227], a[100:103], v[144:147]
    s_add_u32 s73, s57, 4420736
    ds_read_b64_tr_b16 v[216:217], v13 offset:34816
    v_cvt_pk_bf16_f32 v133, v134, v135
    v_mfma_f32_16x16x32_bf16 v[148:151], v[220:223], a[160:163], v[148:151]
    ds_read_b64_tr_b16 v[218:219], v13 offset:35328
    v_cndmask_b32 v133, v133, v255, s[76:77]
    v_mfma_f32_16x16x32_bf16 v[148:151], v[224:227], a[164:167], v[148:151]
    v_mfma_f32_16x16x32_bf16 v[112:115], v[100:103], v[124:127], 0
    v_mfma_f32_16x16x32_bf16 v[152:155], v[220:223], a[224:227], v[152:155]
    v_mfma_f32_16x16x32_bf16 v[128:131], v[108:111], v[116:119], 0
    v_mfma_f32_16x16x32_bf16 v[152:155], v[224:227], a[228:231], v[152:155]
    s_waitcnt lgkmcnt(4)
    v_cvt_pk_bf16_f32 v134, v136, v137
    v_cvt_pk_bf16_f32 v135, v138, v139
    v_mfma_f32_16x16x32_bf16 v[156:159], v[204:207], a[32:35], v[156:159]
    ds_read_b64_tr_b16 v[220:221], v13 offset:33792
    v_cndmask_b32 v134, v134, v255, s[76:77]
    v_mfma_f32_16x16x32_bf16 v[156:159], v[208:211], a[36:39], v[156:159]
    buffer_load_dwordx4 v8, s[40:43], s73 offen offset:3072 lds
    v_mfma_f32_16x16x32_bf16 v[160:163], v[204:207], a[96:99], v[160:163]
    ds_read_b64_tr_b16 v[222:223], v13 offset:34304
    v_cndmask_b32 v135, v135, v255, s[76:77]
    v_mfma_f32_16x16x32_bf16 v[160:163], v[208:211], a[100:103], v[160:163]
    ds_read_b64_tr_b16 v[224:225], v13 offset:35840
    v_add_u32 v228, s55, v228
    v_mfma_f32_16x16x32_bf16 v[164:167], v[204:207], a[160:163], v[164:167]
    ds_read_b64_tr_b16 v[226:227], v13 offset:36352
    v_add_u32 v229, s55, v229
    v_mfma_f32_16x16x32_bf16 v[164:167], v[208:211], a[164:167], v[164:167]
    v_mfma_f32_16x16x32_bf16 v[120:123], v[100:103], v[132:135], 0
    v_mfma_f32_16x16x32_bf16 v[168:171], v[204:207], a[224:227], v[168:171]
    v_mfma_f32_16x16x32_bf16 v[136:139], v[108:111], v[124:127], 0
    v_mfma_f32_16x16x32_bf16 v[168:171], v[208:211], a[228:231], v[168:171]
    s_waitcnt lgkmcnt(4)
    v_mfma_f32_16x16x32_bf16 v[236:239], v[108:111], v[132:135], 0
    v_mfma_f32_16x16x32_bf16 v[172:175], v[212:215], a[32:35], v[172:175]
    v_mfma_f32_16x16x32_bf16 v[240:243], v[132:135], v[124:127], 0
    v_mfma_f32_16x16x32_bf16 v[172:175], v[216:219], a[36:39], v[172:175]
    s_waitcnt vmcnt(10) lgkmcnt(0)
    s_barrier
    v_mfma_f32_16x16x32_bf16 v[176:179], v[212:215], a[96:99], v[176:179]
    s_add_u32 m0, s55, 32768
    ds_read_b64_tr_b16 v[204:205], v12 offset:49152
    v_add_u32 v230, s55, v230
    v_mfma_f32_16x16x32_bf16 v[176:179], v[216:219], a[100:103], v[176:179]
    s_add_u32 s70, s57, 4718720
    ds_read_b64_tr_b16 v[206:207], v12 offset:49664
    v_add_u32 v231, s55, v231
    v_mfma_f32_16x16x32_bf16 v[180:183], v[212:215], a[160:163], v[180:183]
    buffer_load_dwordx4 v8, s[36:39], s70 offen offset:0 lds
    v_mfma_f32_16x16x32_bf16 v[180:183], v[216:219], a[164:167], v[180:183]
    s_add_u32 s71, s57, 4717696
    ds_read_b64_tr_b16 v[208:209], v12 offset:51200
    ds_read_b64_tr_b16 v[210:211], v12 offset:51712
    v_mfma_f32_16x16x32_bf16 v[184:187], v[212:215], a[224:227], v[184:187]
    v_mfma_f32_16x16x32_bf16 v[244:247], v[132:135], v[132:135], 0
    v_mfma_f32_16x16x32_bf16 v[184:187], v[216:219], a[228:231], v[184:187]
    ds_write_b128 v228, v[104:107]
    v_mfma_f32_16x16x32_bf16 v[188:191], v[220:223], a[32:35], v[188:191]
    ds_read_b64_tr_b16 v[212:213], v12 offset:50176
    v_add_u32 v232, s55, v232
    v_mfma_f32_16x16x32_bf16 v[188:191], v[224:227], a[36:39], v[188:191]
    ds_read_b64_tr_b16 v[214:215], v12 offset:50688
    v_add_u32 v233, s55, v233
    v_mfma_f32_16x16x32_bf16 v[192:195], v[220:223], a[96:99], v[192:195]
    ds_read_b64_tr_b16 v[216:217], v12 offset:52224
    v_add_u32 v234, s55, v234
    v_mfma_f32_16x16x32_bf16 v[192:195], v[224:227], a[100:103], v[192:195]
    buffer_load_dwordx4 v8, s[40:43], s71 offen offset:1024 lds
    v_mfma_f32_16x16x32_bf16 v[196:199], v[220:223], a[160:163], v[196:199]
    s_add_u32 s72, s57, 5011584
    ds_read_b64_tr_b16 v[218:219], v12 offset:52736
    v_add_u32 v235, s55, v235
    v_mfma_f32_16x16x32_bf16 v[196:199], v[224:227], a[164:167], v[196:199]
    ds_write_b128 v229, v[112:115]
    v_mfma_f32_16x16x32_bf16 v[200:203], v[220:223], a[224:227], v[200:203]
    v_min_u32 v250, 3056, v15
    v_mov_b32 v248, 1
    v_mfma_f32_16x16x32_bf16 v[200:203], v[224:227], a[228:231], v[200:203]
    s_waitcnt lgkmcnt(6)
    v_add_u32 v250, 139264, v250
    v_mul_f32 v4, s66, v76
    v_mfma_f32_16x16x32_bf16 v[140:143], v[204:207], a[40:43], v[140:143]
    ds_read_b64_tr_b16 v[220:221], v13 offset:49152
    v_min_f32 v76, s83, v76
    v_mfma_f32_16x16x32_bf16 v[140:143], v[208:211], a[44:47], v[140:143]
    ds_read_b64_tr_b16 v[222:223], v13 offset:49664
    v_mul_f32 v252, s66, v77
    v_mfma_f32_16x16x32_bf16 v[144:147], v[204:207], a[104:107], v[144:147]
    buffer_load_dwordx4 v8, s[36:39], s72 offen offset:2048 lds
    v_mfma_f32_16x16x32_bf16 v[144:147], v[208:211], a[108:111], v[144:147]
    s_add_u32 s73, s57, 5010560
    ds_read_b64_tr_b16 v[224:225], v13 offset:51200
    v_min_f32 v77, s83, v77
    v_mfma_f32_16x16x32_bf16 v[148:151], v[204:207], a[168:171], v[148:151]
    ds_read_b64_tr_b16 v[226:227], v13 offset:51712
    v_mul_f32 v253, s66, v78
    v_mfma_f32_16x16x32_bf16 v[148:151], v[208:211], a[172:175], v[148:151]
    ds_write_b128 v230, v[120:123]
    v_mfma_f32_16x16x32_bf16 v[152:155], v[204:207], a[232:235], v[152:155]
    v_exp_f32_e64 v4, v4 clamp
    v_mfma_f32_16x16x32_bf16 v[152:155], v[208:211], a[236:239], v[152:155]
    s_waitcnt lgkmcnt(6)
    v_exp_f32_e64 v252, v252 clamp
    v_mfma_f32_16x16x32_bf16 v[156:159], v[212:215], a[40:43], v[156:159]
    ds_read_b64_tr_b16 v[204:205], v13 offset:50176
    v_fma_f32 v76, v76, s67, v4
    v_mfma_f32_16x16x32_bf16 v[156:159], v[216:219], a[44:47], v[156:159]
    buffer_load_dwordx4 v8, s[40:43], s73 offen offset:3072 lds
    v_mfma_f32_16x16x32_bf16 v[160:163], v[212:215], a[104:107], v[160:163]
L_pad4:
    s_cbranch_execz L_padretA
    ds_read_b64_tr_b16 v[206:207], v13 offset:50688
    v_fma_f32 v77, v77, s67, v252
    v_mfma_f32_16x16x32_bf16 v[160:163], v[216:219], a[108:111], v[160:163]
    ds_read_b64_tr_b16 v[208:209], v13 offset:52224
    v_min_f32 v78, s83, v78
    v_mfma_f32_16x16x32_bf16 v[164:167], v[212:215], a[168:171], v[164:167]
    ds_read_b64_tr_b16 v[210:211], v13 offset:52736
    v_mul_f32 v254, s66, v79
    v_mfma_f32_16x16x32_bf16 v[164:167], v[216:219], a[172:175], v[164:167]
    ds_write_b128 v231, v[128:131]
    v_mfma_f32_16x16x32_bf16 v[168:171], v[212:215], a[232:235], v[168:171]
    v_exp_f32_e64 v253, v253 clamp
    v_mfma_f32_16x16x32_bf16 v[168:171], v[216:219], a[236:239], v[168:171]
    s_waitcnt lgkmcnt(6)
    v_exp_f32_e64 v254, v254 clamp
    v_mfma_f32_16x16x32_bf16 v[172:175], v[220:223], a[40:43], v[172:175]
    v_fma_f32 v78, v78, s67, v253
    v_min_f32 v79, s83, v79
    v_mfma_f32_16x16x32_bf16 v[172:175], v[224:227], a[44:47], v[172:175]
    s_waitcnt vmcnt(8) lgkmcnt(0)
    s_barrier
    v_mfma_f32_16x16x32_bf16 v[176:179], v[220:223], a[104:107], v[176:179]
    s_add_u32 m0, s55, 49152
    ds_read_b64_tr_b16 v[212:213], v12 offset:0
    v_fma_f32 v79, v79, s67, v254
    v_mfma_f32_16x16x32_bf16 v[176:179], v[224:227], a[108:111], v[176:179]
    s_add_u32 s70, s57, 256
    ds_read_b64_tr_b16 v[214:215], v12 offset:512
    v_mul_f32 v1, s66, v80
    v_mfma_f32_16x16x32_bf16 v[180:183], v[220:223], a[168:171], v[180:183]
    buffer_load_dwordx4 v8, s[36:39], s70 offen offset:0 lds
    v_mfma_f32_16x16x32_bf16 v[180:183], v[224:227], a[172:175], v[180:183]
    s_sub_u32 s71, s57, 768
    ds_read_b64_tr_b16 v[216:217], v12 offset:2048
    ds_read_b64_tr_b16 v[218:219], v12 offset:2560
    v_mfma_f32_16x16x32_bf16 v[184:187], v[220:223], a[232:235], v[184:187]
    ds_write_b128 v232, v[136:139]
    v_mfma_f32_16x16x32_bf16 v[184:187], v[224:227], a[236:239], v[184:187]
    v_exp_f32_e64 v1, v1 clamp
    v_mfma_f32_16x16x32_bf16 v[188:191], v[204:207], a[40:43], v[188:191]
    ds_read_b64_tr_b16 v[220:221], v12 offset:1024
    v_min_f32 v80, s83, v80
    v_mfma_f32_16x16x32_bf16 v[188:191], v[208:211], a[44:47], v[188:191]
    buffer_load_dwordx4 v8, s[40:43], s71 offen offset:1024 lds
    v_mfma_f32_16x16x32_bf16 v[192:195], v[204:207], a[104:107], v[192:195]
    s_add_u32 s72, s57, 293120
    ds_read_b64_tr_b16 v[222:223], v12 offset:1536
    v_fma_f32 v80, v80, s67, v1
    v_mfma_f32_16x16x32_bf16 v[192:195], v[208:211], a[108:111], v[192:195]
    ds_read_b64_tr_b16 v[224:225], v12 offset:3072
    v_mul_f32 v2, s66, v81
    v_mfma_f32_16x16x32_bf16 v[196:199], v[204:207], a[168:171], v[196:199]
    ds_read_b64_tr_b16 v[226:227], v12 offset:3584
    v_min_f32 v81, s83, v81
    v_mfma_f32_16x16x32_bf16 v[196:199], v[208:211], a[172:175], v[196:199]
    ds_write_b128 v233, v[236:239]
    v_mfma_f32_16x16x32_bf16 v[200:203], v[204:207], a[232:235], v[200:203]
    buffer_load_dwordx4 v8, s[36:39], s72 offen offset:2048 lds
    v_mfma_f32_16x16x32_bf16 v[200:203], v[208:211], a[236:239], v[200:203]
    s_waitcnt lgkmcnt(6)
    v_exp_f32_e64 v2, v2 clamp
    v_mfma_f32_16x16x32_bf16 v[140:143], v[212:215], a[48:51], v[140:143]
    s_add_u32 s73, s57, 292096
    ds_read_b64_tr_b16 v[204:205], v13 offset:0
    v_fma_f32 v81, v81, s67, v2
    v_mfma_f32_16x16x32_bf16 v[140:143], v[216:219], a[52:55], v[140:143]
    ds_read_b64_tr_b16 v[206:207], v13 offset:512
    v_mul_f32 v3, s66, v82
    v_mfma_f32_16x16x32_bf16 v[144:147], v[212:215], a[112:115], v[144:147]
    ds_read_b64_tr_b16 v[208:209], v13 offset:2048
    v_min_f32 v82, s83, v82
    v_mfma_f32_16x16x32_bf16 v[144:147], v[216:219], a[116:119], v[144:147]
    ds_read_b64_tr_b16 v[210:211], v13 offset:2560
    v_mul_f32 v4, s66, v83
    v_mfma_f32_16x16x32_bf16 v[148:151], v[212:215], a[176:179], v[148:151]
    buffer_load_dwordx4 v8, s[40:43], s73 offen offset:3072 lds
    v_mfma_f32_16x16x32_bf16 v[148:151], v[216:219], a[180:183], v[148:151]
    s_add_u32 s11, s3, 262144
    ds_write_b128 v234, v[240:243]
    v_mfma_f32_16x16x32_bf16 v[152:155], v[212:215], a[240:243], v[152:155]
    v_exp_f32_e64 v3, v3 clamp
    v_mfma_f32_16x16x32_bf16 v[152:155], v[216:219], a[244:247], v[152:155]
    s_waitcnt lgkmcnt(6)
    v_exp_f32_e64 v4, v4 clamp
    v_mfma_f32_16x16x32_bf16 v[156:159], v[220:223], a[48:51], v[156:159]
    ds_read_b64_tr_b16 v[212:213], v13 offset:1024
    v_fma_f32 v82, v82, s67, v3
    v_mfma_f32_16x16x32_bf16 v[156:159], v[224:227], a[52:55], v[156:159]
    ds_read_b64_tr_b16 v[214:215], v13 offset:1536
    v_min_f32 v83, s83, v83
    v_mfma_f32_16x16x32_bf16 v[160:163], v[220:223], a[112:115], v[160:163]
    buffer_load_dword v11, v7, s[44:47], s11 offen
    v_mfma_f32_16x16x32_bf16 v[160:163], v[224:227], a[116:119], v[160:163]
    ds_read_b64_tr_b16 v[216:217], v13 offset:3072
    v_fma_f32 v83, v83, s67, v4
    v_mfma_f32_16x16x32_bf16 v[164:167], v[220:223], a[176:179], v[164:167]
    ds_read_b64_tr_b16 v[218:219], v13 offset:3584
    v_mul_f32 v252, s66, v84
    v_mfma_f32_16x16x32_bf16 v[164:167], v[224:227], a[180:183], v[164:167]
    ds_write_b128 v235, v[244:247]
    v_mfma_f32_16x16x32_bf16 v[168:171], v[220:223], a[240:243], v[168:171]
    v_exp_f32_e64 v252, v252 clamp
    v_mfma_f32_16x16x32_bf16 v[168:171], v[224:227], a[244:247], v[168:171]
    s_waitcnt lgkmcnt(6)
    v_min_f32 v84, s83, v84
    v_mul_f32 v253, s66, v85
    v_mfma_f32_16x16x32_bf16 v[172:175], v[204:207], a[48:51], v[172:175]
    v_exp_f32_e64 v253, v253 clamp
    v_mfma_f32_16x16x32_bf16 v[172:175], v[208:211], a[52:55], v[172:175]
    s_waitcnt vmcnt(9) lgkmcnt(0)
    s_barrier
    v_mfma_f32_16x16x32_bf16 v[176:179], v[204:207], a[112:115], v[176:179]
    s_add_u32 m0, s55, 0
    ds_read_b64_tr_b16 v[220:221], v12 offset:16384
    ds_read_b128 v[228:231], v250 offset:0
    v_mfma_f32_16x16x32_bf16 v[176:179], v[208:211], a[116:119], v[176:179]
    s_add_u32 s70, s57, 590080
    ds_read_b64_tr_b16 v[222:223], v12 offset:16896
    ds_read_b128 v[232:235], v250 offset:4096
    v_mfma_f32_16x16x32_bf16 v[180:183], v[204:207], a[176:179], v[180:183]
    buffer_load_dwordx4 v8, s[36:39], s70 offen offset:0 lds
    v_mfma_f32_16x16x32_bf16 v[180:183], v[208:211], a[180:183], v[180:183]
    s_add_u32 s71, s57, 589056
    ds_read_b64_tr_b16 v[224:225], v12 offset:18432
    ds_read_b64_tr_b16 v[226:227], v12 offset:18944
    v_mfma_f32_16x16x32_bf16 v[184:187], v[204:207], a[240:243], v[184:187]
    ds_read_b128 v[236:239], v250 offset:8192
    ds_read_b128 v[240:243], v250 offset:12288
    v_mfma_f32_16x16x32_bf16 v[184:187], v[208:211], a[244:247], v[184:187]
    v_fma_f32 v84, v84, s67, v252
    v_min_f32 v85, s83, v85
    v_mfma_f32_16x16x32_bf16 v[188:191], v[212:215], a[48:51], v[188:191]
    buffer_load_dwordx4 v8, s[40:43], s71 offen offset:1024 lds
    v_mfma_f32_16x16x32_bf16 v[188:191], v[216:219], a[52:55], v[188:191]
    s_add_u32 s72, s57, 882944
    ds_read_b64_tr_b16 v[204:205], v12 offset:17408
    s_waitcnt lgkmcnt(5)
    v_add_f32 v228, v228, v232
    v_mfma_f32_16x16x32_bf16 v[192:195], v[212:215], a[112:115], v[192:195]
    ds_read_b64_tr_b16 v[206:207], v12 offset:17920
    v_add_f32 v229, v229, v233
    v_mfma_f32_16x16x32_bf16 v[192:195], v[216:219], a[116:119], v[192:195]
    ds_read_b64_tr_b16 v[208:209], v12 offset:19456
    v_add_f32 v230, v230, v234
    v_mfma_f32_16x16x32_bf16 v[196:199], v[212:215], a[176:179], v[196:199]
    buffer_load_dwordx4 v8, s[36:39], s72 offen offset:2048 lds
    v_mfma_f32_16x16x32_bf16 v[196:199], v[216:219], a[180:183], v[196:199]
    s_add_u32 s73, s57, 881920
    ds_read_b64_tr_b16 v[210:211], v12 offset:19968
    v_add_f32 v231, v231, v235
    v_mfma_f32_16x16x32_bf16 v[200:203], v[212:215], a[240:243], v[200:203]
    s_waitcnt lgkmcnt(4)
    v_add_f32 v236, v236, v240
    v_add_f32 v237, v237, v241
    v_mfma_f32_16x16x32_bf16 v[200:203], v[216:219], a[244:247], v[200:203]
    v_add_f32 v238, v238, v242
    v_add_f32 v239, v239, v243
    v_mfma_f32_16x16x32_bf16 v[140:143], v[220:223], a[56:59], v[140:143]
    ds_read_b64_tr_b16 v[212:213], v13 offset:16384
    v_add_f32 v228, v228, v236
    v_mfma_f32_16x16x32_bf16 v[140:143], v[224:227], a[60:63], v[140:143]
    buffer_load_dwordx4 v8, s[40:43], s73 offen offset:3072 lds
    v_mfma_f32_16x16x32_bf16 v[144:147], v[220:223], a[120:123], v[144:147]
    s_add_u32 s11, s0, 384
    ds_read_b64_tr_b16 v[214:215], v13 offset:16896
    v_add_f32 v229, v229, v237
    v_mfma_f32_16x16x32_bf16 v[144:147], v[224:227], a[124:127], v[144:147]
    ds_read_b64_tr_b16 v[216:217], v13 offset:18432
    v_add_f32 v230, v230, v238
    v_mfma_f32_16x16x32_bf16 v[148:151], v[220:223], a[184:187], v[148:151]
    ds_read_b64_tr_b16 v[218:219], v13 offset:18944
    v_add_f32 v231, v231, v239
    v_mfma_f32_16x16x32_bf16 v[148:151], v[224:227], a[188:191], v[148:151]
    buffer_store_dwordx4 v[228:231], v15, s[48:51], s82 offen sc1
    v_mfma_f32_16x16x32_bf16 v[152:155], v[220:223], a[248:251], v[152:155]
    buffer_load_dword v11, v6, s[36:39], s11 offen
    v_mfma_f32_16x16x32_bf16 v[152:155], v[224:227], a[252:255], v[152:155]
    s_waitcnt lgkmcnt(4)
    v_fma_f32 v85, v85, s67, v253
    v_mul_f32 v254, s66, v86
    v_mfma_f32_16x16x32_bf16 v[156:159], v[204:207], a[56:59], v[156:159]
    ds_read_b64_tr_b16 v[220:221], v13 offset:17408
    v_min_f32 v86, s83, v86
    v_mfma_f32_16x16x32_bf16 v[156:159], v[208:211], a[60:63], v[156:159]
    ds_read_b64_tr_b16 v[222:223], v13 offset:17920
    v_mul_f32 v1, s66, v87
    v_mfma_f32_16x16x32_bf16 v[160:163], v[204:207], a[120:123], v[160:163]
    ds_read_b64_tr_b16 v[224:225], v13 offset:19456
    v_min_f32 v87, s83, v87
    v_mfma_f32_16x16x32_bf16 v[160:163], v[208:211], a[124:127], v[160:163]
    buffer_load_dword v11, v6, s[40:43], s11 offen
    v_mfma_f32_16x16x32_bf16 v[164:167], v[204:207], a[184:187], v[164:167]
    ds_read_b64_tr_b16 v[226:227], v13 offset:19968
    v_mul_f32 v2, s66, v88
    v_mfma_f32_16x16x32_bf16 v[164:167], v[208:211], a[188:191], v[164:167]
    v_exp_f32_e64 v254, v254 clamp
    v_mfma_f32_16x16x32_bf16 v[168:171], v[204:207], a[248:251], v[168:171]
    v_exp_f32_e64 v1, v1 clamp
    v_mfma_f32_16x16x32_bf16 v[168:171], v[208:211], a[252:255], v[168:171]
    s_waitcnt lgkmcnt(4)
    v_exp_f32_e64 v2, v2 clamp
    v_mfma_f32_16x16x32_bf16 v[172:175], v[212:215], a[56:59], v[172:175]
    v_fma_f32 v86, v86, s67, v254
    v_fma_f32 v87, v87, s67, v1
    v_mfma_f32_16x16x32_bf16 v[172:175], v[216:219], a[60:63], v[172:175]
    s_waitcnt vmcnt(12) lgkmcnt(0)
    s_barrier
    v_mfma_f32_16x16x32_bf16 v[176:179], v[212:215], a[120:123], v[176:179]
    s_add_u32 m0, s55, 16384
    ds_read_b64_tr_b16 v[204:205], v12 offset:32768
    v_min_f32 v88, s83, v88
    v_mfma_f32_16x16x32_bf16 v[176:179], v[216:219], a[124:127], v[176:179]
    s_add_u32 s70, s57, 1179904
    ds_read_b64_tr_b16 v[206:207], v12 offset:33280
    v_fma_f32 v88, v88, s67, v2
    v_mfma_f32_16x16x32_bf16 v[180:183], v[212:215], a[184:187], v[180:183]
    buffer_load_dwordx4 v8, s[36:39], s70 offen offset:0 lds
    v_mfma_f32_16x16x32_bf16 v[180:183], v[216:219], a[188:191], v[180:183]
    s_add_u32 s71, s57, 1178880
    ds_read_b64_tr_b16 v[208:209], v12 offset:34816
    ds_read_b64_tr_b16 v[210:211], v12 offset:35328
    v_mfma_f32_16x16x32_bf16 v[184:187], v[212:215], a[248:251], v[184:187]
    v_mul_f32 v3, s66, v89
    v_min_f32 v89, s83, v89
    v_mfma_f32_16x16x32_bf16 v[184:187], v[216:219], a[252:255], v[184:187]
    v_exp_f32_e64 v3, v3 clamp
    v_mfma_f32_16x16x32_bf16 v[188:191], v[220:223], a[56:59], v[188:191]
    ds_read_b64_tr_b16 v[212:213], v12 offset:33792
    v_fma_f32 v89, v89, s67, v3
    v_mfma_f32_16x16x32_bf16 v[188:191], v[224:227], a[60:63], v[188:191]
    ds_read_b64_tr_b16 v[214:215], v12 offset:34304
    v_mul_f32 v4, s66, v90
    v_mfma_f32_16x16x32_bf16 v[192:195], v[220:223], a[120:123], v[192:195]
    ds_read_b64_tr_b16 v[216:217], v12 offset:35840
    v_min_f32 v90, s83, v90
    v_mfma_f32_16x16x32_bf16 v[192:195], v[224:227], a[124:127], v[192:195]
    buffer_load_dwordx4 v8, s[40:43], s71 offen offset:1024 lds
    v_mfma_f32_16x16x32_bf16 v[196:199], v[220:223], a[184:187], v[196:199]
    s_add_u32 s72, s57, 1472768
    ds_read_b64_tr_b16 v[218:219], v12 offset:36352
    v_mul_f32 v252, s66, v91
    v_mfma_f32_16x16x32_bf16 v[196:199], v[224:227], a[188:191], v[196:199]
    v_exp_f32_e64 v4, v4 clamp
    v_mfma_f32_16x16x32_bf16 v[200:203], v[220:223], a[248:251], v[200:203]
    v_exp_f32_e64 v252, v252 clamp
    v_mfma_f32_16x16x32_bf16 v[200:203], v[224:227], a[252:255], v[200:203]
    s_waitcnt lgkmcnt(4)
    v_fma_f32 v90, v90, s67, v4
    v_min_f32 v91, s83, v91
    v_mfma_f32_16x16x32_bf16 v[140:143], v[204:207], v[44:47], v[140:143]
    ds_read_b64_tr_b16 v[220:221], v13 offset:32768
    v_fma_f32 v91, v91, s67, v252
    v_mfma_f32_16x16x32_bf16 v[140:143], v[208:211], v[48:51], v[140:143]
    ds_read_b64_tr_b16 v[222:223], v13 offset:33280
    v_and_b32 v32, 1, v0
    v_mfma_f32_16x16x32_bf16 v[144:147], v[204:207], v[52:55], v[144:147]
    buffer_load_dwordx4 v8, s[36:39], s72 offen offset:2048 lds
    v_mfma_f32_16x16x32_bf16 v[144:147], v[208:211], v[56:59], v[144:147]
    s_add_u32 s73, s57, 1471744
    ds_read_b64_tr_b16 v[224:225], v13 offset:34816
    v_lshlrev_b32 v32, 4, v32
    v_mfma_f32_16x16x32_bf16 v[148:151], v[204:207], v[60:63], v[148:151]
    ds_read_b64_tr_b16 v[226:227], v13 offset:35328
    v_mov_b32 v33, 0x3f80
    v_mfma_f32_16x16x32_bf16 v[148:151], v[208:211], v[64:67], v[148:151]
    v_lshlrev_b32 v32, v32, v33
    v_cvt_pk_bf16_f32 v34, v76, v77
    v_mfma_f32_16x16x32_bf16 v[152:155], v[204:207], v[68:71], v[152:155]
    v_cndmask_b32 v33, 0, v32, s[84:85]
    s_mov_b32 s84, 0x00300003
    v_mfma_f32_16x16x32_bf16 v[152:155], v[208:211], v[72:75], v[152:155]
    s_waitcnt lgkmcnt(4)
    s_mov_b32 s85, 0x30000300
    v_cvt_pk_bf16_f32 v36, v84, v85
    v_mfma_f32_16x16x32_bf16 v[156:159], v[212:215], v[44:47], v[156:159]
    ds_read_b64_tr_b16 v[204:205], v13 offset:33792
    v_cndmask_b32 v32, 0, v32, s[84:85]
    v_mfma_f32_16x16x32_bf16 v[156:159], v[216:219], v[48:51], v[156:159]
    buffer_load_dwordx4 v8, s[40:43], s73 offen offset:3072 lds
    v_mfma_f32_16x16x32_bf16 v[160:163], v[212:215], v[52:55], v[160:163]
    ds_read_b64_tr_b16 v[206:207], v13 offset:34304
    v_cvt_pk_bf16_f32 v35, v78, v79
    v_mfma_f32_16x16x32_bf16 v[160:163], v[216:219], v[56:59], v[160:163]
    ds_read_b64_tr_b16 v[208:209], v13 offset:35840
    v_cvt_pk_bf16_f32 v37, v86, v87
    v_mfma_f32_16x16x32_bf16 v[164:167], v[212:215], v[60:63], v[164:167]
    ds_read_b64_tr_b16 v[210:211], v13 offset:36352
    v_cvt_pk_bf16_f32 v40, v80, v81
    v_mfma_f32_16x16x32_bf16 v[164:167], v[216:219], v[64:67], v[164:167]
    v_mfma_f32_16x16x16_bf16 v[92:95], v[132:133], v[32:33], 0
    v_mfma_f32_16x16x32_bf16 v[168:171], v[212:215], v[68:71], v[168:171]
    v_mfma_f32_16x16x16_bf16 v[96:99], v[134:135], v[32:33], 0
    v_mfma_f32_16x16x32_bf16 v[168:171], v[216:219], v[72:75], v[168:171]
    s_waitcnt lgkmcnt(4)
    v_cvt_pk_bf16_f32 v42, v88, v89
    v_cvt_pk_bf16_f32 v41, v82, v83
    v_mfma_f32_16x16x32_bf16 v[172:175], v[220:223], v[44:47], v[172:175]
    v_cvt_pk_bf16_f32 v43, v90, v91
    v_cvt_pk_bf16_f32 v32, v92, v93
    v_mfma_f32_16x16x32_bf16 v[172:175], v[224:227], v[48:51], v[172:175]
    s_waitcnt vmcnt(12) lgkmcnt(0)
    s_barrier
    v_mfma_f32_16x16x32_bf16 v[176:179], v[220:223], v[52:55], v[176:179]
    s_add_u32 m0, s55, 32768
    ds_read_b64_tr_b16 v[212:213], v12 offset:49152
    v_cvt_pk_bf16_f32 v33, v94, v95
    v_mfma_f32_16x16x32_bf16 v[176:179], v[224:227], v[56:59], v[176:179]
    s_add_u32 s70, s57, 1769728
    ds_read_b64_tr_b16 v[214:215], v12 offset:49664
    v_cvt_pk_bf16_f32 v38, v96, v97
    v_mfma_f32_16x16x32_bf16 v[180:183], v[220:223], v[60:63], v[180:183]
    buffer_load_dwordx4 v8, s[36:39], s70 offen offset:0 lds
    v_mfma_f32_16x16x32_bf16 v[180:183], v[224:227], v[64:67], v[180:183]
    s_add_u32 s71, s57, 1768704
    ds_read_b64_tr_b16 v[216:217], v12 offset:51200
    ds_read_b64_tr_b16 v[218:219], v12 offset:51712
    v_mfma_f32_16x16x32_bf16 v[184:187], v[220:223], v[68:71], v[184:187]
    v_cvt_pk_bf16_f32 v39, v98, v99
    v_lshlrev_b32 v251, 4, v0
    v_mfma_f32_16x16x32_bf16 v[184:187], v[224:227], v[72:75], v[184:187]
    v_mfma_f32_16x16x32_bf16 v[188:191], v[204:207], v[44:47], v[188:191]
    ds_read_b64_tr_b16 v[220:221], v12 offset:50176
    v_mfma_f32_16x16x32_bf16 v[188:191], v[208:211], v[48:51], v[188:191]
    ds_read_b64_tr_b16 v[222:223], v12 offset:50688
    v_mfma_f32_16x16x32_bf16 v[192:195], v[204:207], v[52:55], v[192:195]
    ds_read_b64_tr_b16 v[224:225], v12 offset:52224
    v_mfma_f32_16x16x32_bf16 v[192:195], v[208:211], v[56:59], v[192:195]
    buffer_load_dwordx4 v8, s[40:43], s71 offen offset:1024 lds
    v_mfma_f32_16x16x32_bf16 v[196:199], v[204:207], v[60:63], v[196:199]
    s_add_u32 s72, s57, 2062592
    ds_read_b64_tr_b16 v[226:227], v12 offset:52736
    v_mfma_f32_16x16x32_bf16 v[196:199], v[208:211], v[64:67], v[196:199]
    global_load_dwordx4 v[20:23], v251, s[80:81] offset:2048
    v_mfma_f32_16x16x32_bf16 v[200:203], v[204:207], v[68:71], v[200:203]
    global_load_dwordx4 v[24:27], v251, s[80:81] offset:3072
    v_mfma_f32_16x16x32_bf16 v[200:203], v[208:211], v[72:75], v[200:203]
    s_waitcnt lgkmcnt(4)
    v_add_u32 v251, s87, v251
    v_mfma_f32_16x16x32_bf16 v[76:79], v[212:215], a[0:3], 0
    ds_read_b64_tr_b16 v[204:205], v13 offset:49152
    v_mov_b32 v255, 2
    v_mfma_f32_16x16x32_bf16 v[76:79], v[216:219], a[4:7], v[76:79]
    ds_read_b64_tr_b16 v[206:207], v13 offset:49664
    v_mfma_f32_16x16x32_bf16 v[80:83], v[212:215], a[64:67], 0
    buffer_load_dwordx4 v8, s[36:39], s72 offen offset:2048 lds
    v_fma_f32 v1, v140, v140, s64
    v_mfma_f32_16x16x32_bf16 v[80:83], v[216:219], a[68:71], v[80:83]
    s_add_u32 s73, s57, 2061568
    ds_read_b64_tr_b16 v[208:209], v13 offset:51200
    v_mul_f32 v156, v140, v156
    v_mfma_f32_16x16x32_bf16 v[84:87], v[212:215], a[128:131], 0
    ds_read_b64_tr_b16 v[210:211], v13 offset:51712
    v_mul_f32 v140, v1, v140
    v_fma_f32 v2, v141, v141, s64
    v_mfma_f32_16x16x32_bf16 v[84:87], v[216:219], a[132:135], v[84:87]
    global_load_dwordx4 v[28:31], v251, s[80:81]
    v_exp_f32 v140, v140
    v_mfma_f32_16x16x32_bf16 v[88:91], v[212:215], a[192:195], 0
    v_add_f32 v140, 1.0, v140
    v_mul_f32 v157, v141, v157
    v_mfma_f32_16x16x32_bf16 v[88:91], v[216:219], a[196:199], v[88:91]
    s_waitcnt lgkmcnt(4)
    v_rcp_f32 v140, v140
    v_mfma_f32_16x16x32_bf16 v[92:95], v[220:223], a[0:3], 0
    ds_read_b64_tr_b16 v[212:213], v13 offset:50176
    v_mul_f32 v156, v156, v140
    v_mfma_f32_16x16x32_bf16 v[92:95], v[224:227], a[4:7], v[92:95]
    buffer_load_dwordx4 v8, s[40:43], s73 offen offset:3072 lds
    v_mfma_f32_16x16x32_bf16 v[96:99], v[220:223], a[64:67], 0
    ds_read_b64_tr_b16 v[214:215], v13 offset:50688
    v_mul_f32 v141, v2, v141
    v_mfma_f32_16x16x32_bf16 v[96:99], v[224:227], a[68:71], v[96:99]
    ds_read_b64_tr_b16 v[216:217], v13 offset:52224
    v_fma_f32 v3, v142, v142, s64
    v_mfma_f32_16x16x32_bf16 v[100:103], v[220:223], a[128:131], 0
    ds_read_b64_tr_b16 v[218:219], v13 offset:52736
    v_mul_f32 v158, v142, v158
    v_mfma_f32_16x16x32_bf16 v[100:103], v[224:227], a[132:135], v[100:103]
    v_exp_f32 v141, v141
    v_mfma_f32_16x16x32_bf16 v[104:107], v[220:223], a[192:195], 0
    v_add_f32 v141, 1.0, v141
    v_mul_f32 v142, v3, v142
    v_mfma_f32_16x16x32_bf16 v[104:107], v[224:227], a[196:199], v[104:107]
    s_waitcnt lgkmcnt(4)
    v_rcp_f32 v141, v141
    v_mfma_f32_16x16x32_bf16 v[108:111], v[204:207], a[0:3], 0
    v_exp_f32 v142, v142
    v_mfma_f32_16x16x32_bf16 v[108:111], v[208:211], a[4:7], v[108:111]
    s_waitcnt vmcnt(14) lgkmcnt(0)
    s_barrier
    v_mfma_f32_16x16x32_bf16 v[112:115], v[204:207], a[64:67], 0
    s_add_u32 m0, s55, 49152
    ds_read_b64_tr_b16 v[220:221], v12 offset:0
    v_mul_f32 v157, v157, v141
    v_mfma_f32_16x16x32_bf16 v[112:115], v[208:211], a[68:71], v[112:115]
    s_add_u32 s70, s57, 2359552
    ds_read_b64_tr_b16 v[222:223], v12 offset:512
    v_add_f32 v142, 1.0, v142
    v_mfma_f32_16x16x32_bf16 v[116:119], v[204:207], a[128:131], 0
    buffer_load_dwordx4 v8, s[36:39], s70 offen offset:0 lds
    v_mfma_f32_16x16x32_bf16 v[116:119], v[208:211], a[132:135], v[116:119]
    s_add_u32 s71, s57, 2358528
    ds_read_b64_tr_b16 v[224:225], v12 offset:2048
    ds_read_b64_tr_b16 v[226:227], v12 offset:2560
    v_mfma_f32_16x16x32_bf16 v[120:123], v[204:207], a[192:195], 0
    v_rcp_f32 v142, v142
    v_mfma_f32_16x16x32_bf16 v[120:123], v[208:211], a[196:199], v[120:123]
    v_mul_f32 v158, v158, v142
    v_fma_f32 v4, v143, v143, s64
    v_mfma_f32_16x16x32_bf16 v[124:127], v[212:215], a[0:3], 0
    ds_read_b64_tr_b16 v[204:205], v12 offset:1024
    v_mul_f32 v159, v143, v159
    v_mfma_f32_16x16x32_bf16 v[124:127], v[216:219], a[4:7], v[124:127]
    buffer_load_dwordx4 v8, s[40:43], s71 offen offset:1024 lds
    v_mfma_f32_16x16x32_bf16 v[128:131], v[212:215], a[64:67], 0
    s_add_u32 s72, s57, 2652416
    ds_read_b64_tr_b16 v[206:207], v12 offset:1536
    v_mul_f32 v143, v4, v143
    v_mfma_f32_16x16x32_bf16 v[128:131], v[216:219], a[68:71], v[128:131]
    ds_read_b64_tr_b16 v[208:209], v12 offset:3072
    v_cvt_pk_bf16_f32 v140, v156, v157
    v_mfma_f32_16x16x32_bf16 v[132:135], v[212:215], a[128:131], 0
    ds_read_b64_tr_b16 v[210:211], v12 offset:3584
    v_fma_f32 v252, v172, v172, s64
    v_mfma_f32_16x16x32_bf16 v[132:135], v[216:219], a[132:135], v[132:135]
    v_exp_f32 v143, v143
    v_mfma_f32_16x16x32_bf16 v[136:139], v[212:215], a[192:195], 0
    buffer_load_dwordx4 v8, s[36:39], s72 offen offset:2048 lds
    v_mfma_f32_16x16x32_bf16 v[136:139], v[216:219], a[196:199], v[136:139]
    s_waitcnt lgkmcnt(4)
    v_add_f32 v143, 1.0, v143
    v_mul_f32 v188, v172, v188
    v_mfma_f32_16x16x32_bf16 v[76:79], v[220:223], a[8:11], v[76:79]
    s_add_u32 s73, s57, 2651392
    ds_read_b64_tr_b16 v[212:213], v13 offset:0
    v_mul_f32 v172, v252, v172
    v_mfma_f32_16x16x32_bf16 v[76:79], v[224:227], a[12:15], v[76:79]
    ds_read_b64_tr_b16 v[214:215], v13 offset:512
    v_fma_f32 v1, v173, v173, s64
    v_mfma_f32_16x16x32_bf16 v[80:83], v[220:223], a[72:75], v[80:83]
    ds_read_b64_tr_b16 v[216:217], v13 offset:2048
    v_mul_f32 v189, v173, v189
    v_mfma_f32_16x16x32_bf16 v[80:83], v[224:227], a[76:79], v[80:83]
    ds_read_b64_tr_b16 v[218:219], v13 offset:2560
    v_mul_f32 v173, v1, v173
    v_mfma_f32_16x16x32_bf16 v[84:87], v[220:223], a[136:139], v[84:87]
    buffer_load_dwordx4 v8, s[40:43], s73 offen offset:3072 lds
    v_mfma_f32_16x16x32_bf16 v[84:87], v[224:227], a[140:143], v[84:87]
    s_add_u32 s11, s3, 524288
    v_rcp_f32 v143, v143
    v_mfma_f32_16x16x32_bf16 v[88:91], v[220:223], a[200:203], v[88:91]
    v_exp_f32 v172, v172
    v_mfma_f32_16x16x32_bf16 v[88:91], v[224:227], a[204:207], v[88:91]
    s_waitcnt lgkmcnt(4)
    v_exp_f32 v173, v173
    v_mfma_f32_16x16x32_bf16 v[92:95], v[204:207], a[8:11], v[92:95]
    ds_read_b64_tr_b16 v[220:221], v13 offset:1024
    v_mul_f32 v159, v159, v143
    v_mfma_f32_16x16x32_bf16 v[92:95], v[208:211], a[12:15], v[92:95]
    ds_read_b64_tr_b16 v[222:223], v13 offset:1536
    v_cvt_pk_bf16_f32 v141, v158, v159
    v_mfma_f32_16x16x32_bf16 v[96:99], v[204:207], a[72:75], v[96:99]
    buffer_load_dword v11, v7, s[44:47], s11 offen
    v_mfma_f32_16x16x32_bf16 v[96:99], v[208:211], a[76:79], v[96:99]
    ds_read_b64_tr_b16 v[224:225], v13 offset:3072
    v_add_f32 v172, 1.0, v172
    v_mfma_f32_16x16x32_bf16 v[100:103], v[204:207], a[136:139], v[100:103]
    ds_read_b64_tr_b16 v[226:227], v13 offset:3584
    v_add_f32 v173, 1.0, v173
    v_mfma_f32_16x16x32_bf16 v[100:103], v[208:211], a[140:143], v[100:103]
    v_rcp_f32 v172, v172
    v_mfma_f32_16x16x32_bf16 v[104:107], v[204:207], a[200:203], v[104:107]
    v_rcp_f32 v173, v173
    v_mfma_f32_16x16x32_bf16 v[104:107], v[208:211], a[204:207], v[104:107]
    s_waitcnt lgkmcnt(4)
    v_mul_f32 v188, v188, v172
    v_mul_f32 v189, v189, v173
    v_mfma_f32_16x16x32_bf16 v[108:111], v[212:215], a[8:11], v[108:111]
    v_fma_f32 v2, v174, v174, s64
    v_mul_f32 v190, v174, v190
    v_mfma_f32_16x16x32_bf16 v[108:111], v[216:219], a[12:15], v[108:111]
    s_waitcnt vmcnt(12) lgkmcnt(0)
    s_barrier
    v_mfma_f32_16x16x32_bf16 v[112:115], v[212:215], a[72:75], v[112:115]
    s_add_u32 m0, s55, 0
    ds_read_b64_tr_b16 v[204:205], v12 offset:16384
    v_mul_f32 v174, v2, v174
    v_mfma_f32_16x16x32_bf16 v[112:115], v[216:219], a[76:79], v[112:115]
    s_add_u32 s70, s57, 2949376
    ds_read_b64_tr_b16 v[206:207], v12 offset:16896
    v_fma_f32 v3, v175, v175, s64
    v_mfma_f32_16x16x32_bf16 v[116:119], v[212:215], a[136:139], v[116:119]
    buffer_load_dwordx4 v8, s[36:39], s70 offen offset:0 lds
    v_mfma_f32_16x16x32_bf16 v[116:119], v[216:219], a[140:143], v[116:119]
    s_add_u32 s71, s57, 2948352
    ds_read_b64_tr_b16 v[208:209], v12 offset:18432
    ds_read_b64_tr_b16 v[210:211], v12 offset:18944
    v_mfma_f32_16x16x32_bf16 v[120:123], v[212:215], a[200:203], v[120:123]
    buffer_store_dword v248, off, s[48:51], s17 sc1
    v_mfma_f32_16x16x32_bf16 v[120:123], v[216:219], a[204:207], v[120:123]
    v_exp_f32 v174, v174
    v_mfma_f32_16x16x32_bf16 v[124:127], v[220:223], a[8:11], v[124:127]
    ds_read_b64_tr_b16 v[212:213], v12 offset:17408
    v_add_f32 v174, 1.0, v174
    v_mfma_f32_16x16x32_bf16 v[124:127], v[224:227], a[12:15], v[124:127]
    ds_read_b64_tr_b16 v[214:215], v12 offset:17920
    v_mul_f32 v191, v175, v191
    v_mfma_f32_16x16x32_bf16 v[128:131], v[220:223], a[72:75], v[128:131]
    ds_read_b64_tr_b16 v[216:217], v12 offset:19456
    v_mul_f32 v175, v3, v175
    v_mfma_f32_16x16x32_bf16 v[128:131], v[224:227], a[76:79], v[128:131]
    buffer_load_dwordx4 v8, s[40:43], s71 offen offset:1024 lds
    v_mfma_f32_16x16x32_bf16 v[132:135], v[220:223], a[136:139], v[132:135]
    s_add_u32 s72, s57, 3242240
    ds_read_b64_tr_b16 v[218:219], v12 offset:19968
    v_cvt_pk_bf16_f32 v142, v188, v189
    v_mfma_f32_16x16x32_bf16 v[132:135], v[224:227], a[140:143], v[132:135]
    v_rcp_f32 v174, v174
    v_mfma_f32_16x16x32_bf16 v[136:139], v[220:223], a[200:203], v[136:139]
    v_exp_f32 v175, v175
    v_mfma_f32_16x16x32_bf16 v[136:139], v[224:227], a[204:207], v[136:139]
    s_waitcnt lgkmcnt(4)
    v_mul_f32 v190, v190, v174
    v_add_f32 v175, 1.0, v175
    v_mfma_f32_16x16x32_bf16 v[76:79], v[204:207], a[16:19], v[76:79]
    ds_read_b64_tr_b16 v[220:221], v13 offset:16384
    v_fma_f32 v4, v144, v144, s64
    v_mfma_f32_16x16x32_bf16 v[76:79], v[208:211], a[20:23], v[76:79]
    ds_read_b64_tr_b16 v[222:223], v13 offset:16896
    v_mul_f32 v160, v144, v160
    v_mfma_f32_16x16x32_bf16 v[80:83], v[204:207], a[80:83], v[80:83]
    buffer_load_dwordx4 v8, s[36:39], s72 offen offset:2048 lds
    v_mfma_f32_16x16x32_bf16 v[80:83], v[208:211], a[84:87], v[80:83]
    s_add_u32 s73, s57, 3241216
    ds_read_b64_tr_b16 v[224:225], v13 offset:18432
    v_mul_f32 v144, v4, v144
    v_mfma_f32_16x16x32_bf16 v[84:87], v[204:207], a[144:147], v[84:87]
    ds_read_b64_tr_b16 v[226:227], v13 offset:18944
    v_fma_f32 v252, v145, v145, s64
    v_mfma_f32_16x16x32_bf16 v[84:87], v[208:211], a[148:151], v[84:87]
    v_rcp_f32 v175, v175
    v_mfma_f32_16x16x32_bf16 v[88:91], v[204:207], a[208:211], v[88:91]
    v_exp_f32 v144, v144
    v_mfma_f32_16x16x32_bf16 v[88:91], v[208:211], a[212:215], v[88:91]
    s_waitcnt lgkmcnt(4)
    v_mul_f32 v191, v191, v175
    v_add_f32 v144, 1.0, v144
    v_mfma_f32_16x16x32_bf16 v[92:95], v[212:215], a[16:19], v[92:95]
    ds_read_b64_tr_b16 v[204:205], v13 offset:17408
    v_cvt_pk_bf16_f32 v143, v190, v191
    v_mfma_f32_16x16x32_bf16 v[92:95], v[216:219], a[20:23], v[92:95]
    buffer_store_dwordx4 v[140:143], v18, s[48:51], s12 offen offset:0 sc1
    v_mfma_f32_16x16x32_bf16 v[96:99], v[212:215], a[80:83], v[96:99]
    buffer_load_dwordx4 v8, s[40:43], s73 offen offset:3072 lds
    v_mfma_f32_16x16x32_bf16 v[96:99], v[216:219], a[84:87], v[96:99]
    ds_read_b64_tr_b16 v[206:207], v13 offset:17920
    v_mul_f32 v161, v145, v161
    v_mfma_f32_16x16x32_bf16 v[100:103], v[212:215], a[144:147], v[100:103]
    ds_read_b64_tr_b16 v[208:209], v13 offset:19456
    v_mul_f32 v145, v252, v145
    v_mfma_f32_16x16x32_bf16 v[100:103], v[216:219], a[148:151], v[100:103]
    ds_read_b64_tr_b16 v[210:211], v13 offset:19968
    v_fma_f32 v1, v146, v146, s64
    v_mfma_f32_16x16x32_bf16 v[104:107], v[212:215], a[208:211], v[104:107]
    ds_write_b128 v18, v[140:143] offset:16384
    v_mfma_f32_16x16x32_bf16 v[104:107], v[216:219], a[212:215], v[104:107]
    s_waitcnt lgkmcnt(5)
    v_rcp_f32 v144, v144
    v_mfma_f32_16x16x32_bf16 v[108:111], v[220:223], a[16:19], v[108:111]
    v_exp_f32 v145, v145
    v_mfma_f32_16x16x32_bf16 v[108:111], v[224:227], a[20:23], v[108:111]
    v_mul_f32 v160, v160, v144
    v_add_f32 v145, 1.0, v145
    v_mfma_f32_16x16x32_bf16 v[112:115], v[220:223], a[80:83], v[112:115]
    s_waitcnt vmcnt(11) lgkmcnt(0)
    s_barrier
    v_mfma_f32_16x16x32_bf16 v[112:115], v[224:227], a[84:87], v[112:115]
    s_add_u32 m0, s55, 16384
    ds_read_b64_tr_b16 v[212:213], v12 offset:32768
    v_mov_b32 v248, 0
    v_mfma_f32_16x16x32_bf16 v[116:119], v[220:223], a[144:147], v[116:119]
    s_add_u32 s70, s57, 3539200
    ds_read_b64_tr_b16 v[214:215], v12 offset:33280
L_chain0:
L_pad5:
    s_cbranch_execz L_pad7
    s_and_b32 s83, s17, 4294844415
    v_mfma_f32_16x16x32_bf16 v[116:119], v[224:227], a[148:151], v[116:119]
    buffer_load_dwordx4 v8, s[36:39], s70 offen offset:0 lds
    v_mfma_f32_16x16x32_bf16 v[120:123], v[220:223], a[208:211], v[120:123]
    s_add_u32 s71, s57, 3538176
    ds_read_b64_tr_b16 v[216:217], v12 offset:34816
    ds_read_b64_tr_b16 v[218:219], v12 offset:35328
    v_mfma_f32_16x16x32_bf16 v[120:123], v[224:227], a[212:215], v[120:123]
    v_rcp_f32 v145, v145
    v_mfma_f32_16x16x32_bf16 v[124:127], v[204:207], a[16:19], v[124:127]
    s_add_u32 s85, s63, 0
    ds_read_b64_tr_b16 v[220:221], v12 offset:33792
    s_lshl_b32 s86, s52, 13
    v_mfma_f32_16x16x32_bf16 v[124:127], v[208:211], a[20:23], v[124:127]
    s_and_b32 s86, s86, 8192
    ds_read_b64_tr_b16 v[222:223], v12 offset:34304
    v_mul_f32 v161, v161, v145
    v_mfma_f32_16x16x32_bf16 v[128:131], v[204:207], a[80:83], v[128:131]
    s_sub_u32 s86, 73728, s86
    ds_read_b64_tr_b16 v[224:225], v12 offset:35840
    v_mul_f32 v162, v146, v162
    v_mfma_f32_16x16x32_bf16 v[128:131], v[208:211], a[84:87], v[128:131]
    ds_read_b64_tr_b16 v[226:227], v12 offset:36352
    v_add_u32 v5, s86, v18
    v_mfma_f32_16x16x32_bf16 v[132:135], v[204:207], a[144:147], v[132:135]
    buffer_load_dwordx4 v8, s[40:43], s71 offen offset:1024 lds
    v_mfma_f32_16x16x32_bf16 v[132:135], v[208:211], a[148:151], v[132:135]
    s_add_u32 s72, s57, 3832064
    v_mul_f32 v146, v1, v146
    v_fma_f32 v2, v147, v147, s64
    v_mfma_f32_16x16x32_bf16 v[136:139], v[204:207], a[208:211], v[136:139]
    global_load_dword v249, v248, s[20:21] sc1
    v_mfma_f32_16x16x32_bf16 v[136:139], v[208:211], a[212:215], v[136:139]
    s_waitcnt lgkmcnt(4)
    v_exp_f32 v146, v146
    v_mfma_f32_16x16x32_bf16 v[76:79], v[212:215], a[24:27], v[76:79]
    ds_read_b64_tr_b16 v[204:205], v13 offset:32768
    v_add_f32 v146, 1.0, v146
    v_mfma_f32_16x16x32_bf16 v[76:79], v[216:219], a[28:31], v[76:79]
    ds_read_b64_tr_b16 v[206:207], v13 offset:33280
    v_mul_f32 v163, v147, v163
    v_mfma_f32_16x16x32_bf16 v[80:83], v[212:215], a[88:91], v[80:83]
    ds_read_b64_tr_b16 v[208:209], v13 offset:34816
    v_mul_f32 v147, v2, v147
    v_mfma_f32_16x16x32_bf16 v[80:83], v[216:219], a[92:95], v[80:83]
    buffer_load_dwordx4 v8, s[36:39], s72 offen offset:2048 lds
    v_mfma_f32_16x16x32_bf16 v[84:87], v[212:215], a[152:155], v[84:87]
    s_add_u32 s73, s57, 3831040
    ds_read_b64_tr_b16 v[210:211], v13 offset:35328
    v_cvt_pk_bf16_f32 v144, v160, v161
    v_mfma_f32_16x16x32_bf16 v[84:87], v[216:219], a[156:159], v[84:87]
    v_rcp_f32 v146, v146
    v_mfma_f32_16x16x32_bf16 v[88:91], v[212:215], a[216:219], v[88:91]
    v_exp_f32 v147, v147
    v_mfma_f32_16x16x32_bf16 v[88:91], v[216:219], a[220:223], v[88:91]
    s_waitcnt lgkmcnt(4)
    v_mul_f32 v162, v162, v146
    v_add_f32 v147, 1.0, v147
    v_mfma_f32_16x16x32_bf16 v[92:95], v[220:223], a[24:27], v[92:95]
    ds_read_b64_tr_b16 v[212:213], v13 offset:33792
    v_fma_f32 v3, v176, v176, s64
    v_mfma_f32_16x16x32_bf16 v[92:95], v[224:227], a[28:31], v[92:95]
    ds_read_b64_tr_b16 v[214:215], v13 offset:34304
    v_mul_f32 v192, v176, v192
    v_mfma_f32_16x16x32_bf16 v[96:99], v[220:223], a[88:91], v[96:99]
    buffer_load_dwordx4 v8, s[40:43], s73 offen offset:3072 lds
    v_mfma_f32_16x16x32_bf16 v[96:99], v[224:227], a[92:95], v[96:99]
    ds_read_b64_tr_b16 v[216:217], v13 offset:35840
    v_mul_f32 v176, v3, v176
    v_mfma_f32_16x16x32_bf16 v[100:103], v[220:223], a[152:155], v[100:103]
    ds_read_b64_tr_b16 v[218:219], v13 offset:36352
    v_fma_f32 v4, v177, v177, s64
    v_mfma_f32_16x16x32_bf16 v[100:103], v[224:227], a[156:159], v[100:103]
    v_rcp_f32 v147, v147
    v_mfma_f32_16x16x32_bf16 v[104:107], v[220:223], a[216:219], v[104:107]
    v_exp_f32 v176, v176
    v_mfma_f32_16x16x32_bf16 v[104:107], v[224:227], a[220:223], v[104:107]
    s_waitcnt lgkmcnt(4)
    v_mul_f32 v163, v163, v147
    v_add_f32 v176, 1.0, v176
    v_mfma_f32_16x16x32_bf16 v[108:111], v[204:207], a[24:27], v[108:111]
    v_rcp_f32 v176, v176
    v_mfma_f32_16x16x32_bf16 v[108:111], v[208:211], a[28:31], v[108:111]
    s_waitcnt vmcnt(12) lgkmcnt(0)
    s_barrier
    v_mfma_f32_16x16x32_bf16 v[112:115], v[204:207], a[88:91], v[112:115]
    s_add_u32 m0, s55, 32768
    ds_read_b64_tr_b16 v[220:221], v12 offset:49152
    v_cvt_pk_bf16_f32 v145, v162, v163
    v_mfma_f32_16x16x32_bf16 v[112:115], v[208:211], a[92:95], v[112:115]
    s_add_u32 s70, s57, 4129024
    ds_read_b64_tr_b16 v[222:223], v12 offset:49664
    v_mul_f32 v192, v192, v176
    v_mfma_f32_16x16x32_bf16 v[116:119], v[204:207], a[152:155], v[116:119]
    buffer_load_dwordx4 v8, s[36:39], s70 offen offset:0 lds
    v_mfma_f32_16x16x32_bf16 v[116:119], v[208:211], a[156:159], v[116:119]
    s_add_u32 s71, s57, 4128000
    ds_read_b64_tr_b16 v[224:225], v12 offset:51200
    ds_read_b64_tr_b16 v[226:227], v12 offset:51712
    v_mfma_f32_16x16x32_bf16 v[120:123], v[204:207], a[216:219], v[120:123]
    v_mul_f32 v193, v177, v193
    v_mul_f32 v177, v4, v177
    v_mfma_f32_16x16x32_bf16 v[120:123], v[208:211], a[220:223], v[120:123]
    v_exp_f32 v177, v177
    v_mfma_f32_16x16x32_bf16 v[124:127], v[212:215], a[24:27], v[124:127]
    ds_read_b64_tr_b16 v[204:205], v12 offset:50176
    v_add_f32 v177, 1.0, v177
    v_mfma_f32_16x16x32_bf16 v[124:127], v[216:219], a[28:31], v[124:127]
    ds_read_b64_tr_b16 v[206:207], v12 offset:50688
    v_fma_f32 v252, v178, v178, s64
    v_mfma_f32_16x16x32_bf16 v[128:131], v[212:215], a[88:91], v[128:131]
    ds_read_b64_tr_b16 v[208:209], v12 offset:52224
    v_mul_f32 v194, v178, v194
    v_mfma_f32_16x16x32_bf16 v[128:131], v[216:219], a[92:95], v[128:131]
    buffer_load_dwordx4 v8, s[40:43], s71 offen offset:1024 lds
    v_mfma_f32_16x16x32_bf16 v[132:135], v[212:215], a[152:155], v[132:135]
    s_add_u32 s72, s57, 4421888
    ds_read_b64_tr_b16 v[210:211], v12 offset:52736
    v_mul_f32 v178, v252, v178
    v_mfma_f32_16x16x32_bf16 v[132:135], v[216:219], a[156:159], v[132:135]
    v_rcp_f32 v177, v177
    v_mfma_f32_16x16x32_bf16 v[136:139], v[212:215], a[216:219], v[136:139]
    v_exp_f32 v178, v178
    v_mfma_f32_16x16x32_bf16 v[136:139], v[216:219], a[220:223], v[136:139]
    s_waitcnt lgkmcnt(4)
    v_mul_f32 v193, v193, v177
    v_add_f32 v178, 1.0, v178
    v_mfma_f32_16x16x32_bf16 v[76:79], v[220:223], a[32:35], v[76:79]
    ds_read_b64_tr_b16 v[212:213], v13 offset:49152
    v_fma_f32 v1, v179, v179, s64
    v_mfma_f32_16x16x32_bf16 v[76:79], v[224:227], a[36:39], v[76:79]
    ds_read_b64_tr_b16 v[214:215], v13 offset:49664
    v_mul_f32 v195, v179, v195
    v_mfma_f32_16x16x32_bf16 v[80:83], v[220:223], a[96:99], v[80:83]
    buffer_load_dwordx4 v8, s[36:39], s72 offen offset:2048 lds
    v_mfma_f32_16x16x32_bf16 v[80:83], v[224:227], a[100:103], v[80:83]
    s_add_u32 s73, s57, 4420864
    ds_read_b64_tr_b16 v[216:217], v13 offset:51200
    v_mul_f32 v179, v1, v179
    v_mfma_f32_16x16x32_bf16 v[84:87], v[220:223], a[160:163], v[84:87]
    ds_read_b64_tr_b16 v[218:219], v13 offset:51712
    v_cvt_pk_bf16_f32 v146, v192, v193
    v_mfma_f32_16x16x32_bf16 v[84:87], v[224:227], a[164:167], v[84:87]
    v_rcp_f32 v178, v178
    v_mfma_f32_16x16x32_bf16 v[88:91], v[220:223], a[224:227], v[88:91]
    v_exp_f32 v179, v179
    v_mfma_f32_16x16x32_bf16 v[88:91], v[224:227], a[228:231], v[88:91]
    s_waitcnt lgkmcnt(4)
    v_mul_f32 v194, v194, v178
    v_add_f32 v179, 1.0, v179
    v_mfma_f32_16x16x32_bf16 v[92:95], v[204:207], a[32:35], v[92:95]
    ds_read_b64_tr_b16 v[220:221], v13 offset:50176
    v_fma_f32 v2, v148, v148, s64
    v_mfma_f32_16x16x32_bf16 v[92:95], v[208:211], a[36:39], v[92:95]
    buffer_load_dwordx4 v8, s[40:43], s73 offen offset:3072 lds
    v_mfma_f32_16x16x32_bf16 v[96:99], v[204:207], a[96:99], v[96:99]
    ds_read_b64_tr_b16 v[222:223], v13 offset:50688
    v_mul_f32 v164, v148, v164
    v_mfma_f32_16x16x32_bf16 v[96:99], v[208:211], a[100:103], v[96:99]
    ds_read_b64_tr_b16 v[224:225], v13 offset:52224
    v_mul_f32 v148, v2, v148
    v_mfma_f32_16x16x32_bf16 v[100:103], v[204:207], a[160:163], v[100:103]
    ds_read_b64_tr_b16 v[226:227], v13 offset:52736
    v_fma_f32 v3, v149, v149, s64
    v_mfma_f32_16x16x32_bf16 v[100:103], v[208:211], a[164:167], v[100:103]
    v_rcp_f32 v179, v179
    v_mfma_f32_16x16x32_bf16 v[104:107], v[204:207], a[224:227], v[104:107]
    v_exp_f32 v148, v148
    v_mfma_f32_16x16x32_bf16 v[104:107], v[208:211], a[228:231], v[104:107]
    s_waitcnt lgkmcnt(4)
    v_mul_f32 v195, v195, v179
    v_add_f32 v148, 1.0, v148
    v_mfma_f32_16x16x32_bf16 v[108:111], v[212:215], a[32:35], v[108:111]
    s_waitcnt vmcnt(6)
    v_cmp_gt_u32 vcc, 256, v249
    s_nop 0
    s_cbranch_vccnz L_sp_init
L_bk_init:
    v_mfma_f32_16x16x32_bf16 v[108:111], v[216:219], a[36:39], v[108:111]
    s_waitcnt lgkmcnt(0)
    s_barrier
    v_mfma_f32_16x16x32_bf16 v[112:115], v[212:215], a[96:99], v[112:115]
    s_add_u32 m0, s55, 49152
    ds_read_b64_tr_b16 v[204:205], v12 offset:0
    v_and_b32 v248, 15, v0
    v_mfma_f32_16x16x32_bf16 v[112:115], v[216:219], a[100:103], v[112:115]
    s_add_u32 s70, s57, 4718848
    ds_read_b64_tr_b16 v[206:207], v12 offset:512
    v_lshlrev_b32 v248, 13, v248
    v_mfma_f32_16x16x32_bf16 v[116:119], v[212:215], a[160:163], v[116:119]
    buffer_load_dwordx4 v8, s[36:39], s70 offen offset:0 lds
    v_mfma_f32_16x16x32_bf16 v[116:119], v[216:219], a[164:167], v[116:119]
    s_add_u32 s71, s57, 4717824
    ds_read_b64_tr_b16 v[208:209], v12 offset:2048
    ds_read_b64_tr_b16 v[210:211], v12 offset:2560
    v_mfma_f32_16x16x32_bf16 v[120:123], v[212:215], a[224:227], v[120:123]
    buffer_load_dword v249, v248, s[48:51], s83 offen sc1
    v_mfma_f32_16x16x32_bf16 v[120:123], v[216:219], a[228:231], v[120:123]
    v_rcp_f32 v148, v148
    v_mfma_f32_16x16x32_bf16 v[124:127], v[220:223], a[32:35], v[124:127]
    ds_read_b64_tr_b16 v[212:213], v12 offset:1024
    v_cvt_pk_bf16_f32 v147, v194, v195
    v_mfma_f32_16x16x32_bf16 v[124:127], v[224:227], a[36:39], v[124:127]
    buffer_store_dwordx4 v[144:147], v18, s[48:51], s12 offen offset:1024 sc1
    v_mfma_f32_16x16x32_bf16 v[128:131], v[220:223], a[96:99], v[128:131]
    ds_read_b64_tr_b16 v[214:215], v12 offset:1536
    v_mul_f32 v164, v164, v148
    v_mfma_f32_16x16x32_bf16 v[128:131], v[224:227], a[100:103], v[128:131]
    buffer_load_dwordx4 v8, s[40:43], s71 offen offset:1024 lds
    v_mfma_f32_16x16x32_bf16 v[132:135], v[220:223], a[160:163], v[132:135]
    s_add_u32 s72, s57, 5011712
    ds_read_b64_tr_b16 v[216:217], v12 offset:3072
    v_mul_f32 v165, v149, v165
    v_mfma_f32_16x16x32_bf16 v[132:135], v[224:227], a[164:167], v[132:135]
    ds_read_b64_tr_b16 v[218:219], v12 offset:3584
    v_mul_f32 v149, v3, v149
    v_mfma_f32_16x16x32_bf16 v[136:139], v[220:223], a[224:227], v[136:139]
    ds_write_b128 v18, v[144:147] offset:17408
    v_mfma_f32_16x16x32_bf16 v[136:139], v[224:227], a[228:231], v[136:139]
    s_waitcnt lgkmcnt(5)
    v_exp_f32 v149, v149
    v_mfma_f32_16x16x32_bf16 v[76:79], v[204:207], a[40:43], v[76:79]
    ds_read_b64_tr_b16 v[220:221], v13 offset:0
    v_add_f32 v149, 1.0, v149
    v_mfma_f32_16x16x32_bf16 v[76:79], v[208:211], a[44:47], v[76:79]
    ds_read_b64_tr_b16 v[222:223], v13 offset:512
    v_fma_f32 v4, v150, v150, s64
    v_mfma_f32_16x16x32_bf16 v[80:83], v[204:207], a[104:107], v[80:83]
    buffer_load_dwordx4 v8, s[36:39], s72 offen offset:2048 lds
    v_mfma_f32_16x16x32_bf16 v[80:83], v[208:211], a[108:111], v[80:83]
    s_add_u32 s73, s57, 5010688
    ds_read_b64_tr_b16 v[224:225], v13 offset:2048
    v_mul_f32 v166, v150, v166
    v_mfma_f32_16x16x32_bf16 v[84:87], v[204:207], a[168:171], v[84:87]
    ds_read_b64_tr_b16 v[226:227], v13 offset:2560
    v_mul_f32 v150, v4, v150
    v_mfma_f32_16x16x32_bf16 v[84:87], v[208:211], a[172:175], v[84:87]
    v_rcp_f32 v149, v149
    v_mfma_f32_16x16x32_bf16 v[88:91], v[204:207], a[232:235], v[88:91]
    v_exp_f32 v150, v150
    v_mfma_f32_16x16x32_bf16 v[88:91], v[208:211], a[236:239], v[88:91]
    s_waitcnt lgkmcnt(5)
    v_mul_f32 v165, v165, v149
    v_add_f32 v150, 1.0, v150
    v_mfma_f32_16x16x32_bf16 v[92:95], v[212:215], a[40:43], v[92:95]
    ds_read_b64_tr_b16 v[204:205], v13 offset:1024
    v_fma_f32 v252, v151, v151, s64
    v_mfma_f32_16x16x32_bf16 v[92:95], v[216:219], a[44:47], v[92:95]
    buffer_load_dwordx4 v8, s[40:43], s73 offen offset:3072 lds
    v_mfma_f32_16x16x32_bf16 v[96:99], v[212:215], a[104:107], v[96:99]
    ds_read_b64_tr_b16 v[206:207], v13 offset:1536
    v_mul_f32 v167, v151, v167
    v_mfma_f32_16x16x32_bf16 v[96:99], v[216:219], a[108:111], v[96:99]
    ds_read_b64_tr_b16 v[208:209], v13 offset:3072
    v_mul_f32 v151, v252, v151
    v_mfma_f32_16x16x32_bf16 v[100:103], v[212:215], a[168:171], v[100:103]
    ds_read_b64_tr_b16 v[210:211], v13 offset:3584
    v_cvt_pk_bf16_f32 v148, v164, v165
    v_mfma_f32_16x16x32_bf16 v[100:103], v[216:219], a[172:175], v[100:103]
    v_rcp_f32 v150, v150
    v_mfma_f32_16x16x32_bf16 v[104:107], v[212:215], a[232:235], v[104:107]
    v_exp_f32 v151, v151
    v_mfma_f32_16x16x32_bf16 v[104:107], v[216:219], a[236:239], v[104:107]
    s_waitcnt lgkmcnt(4)
    v_mul_f32 v166, v166, v150
    v_add_f32 v151, 1.0, v151
    v_mfma_f32_16x16x32_bf16 v[108:111], v[220:223], a[40:43], v[108:111]
    v_rcp_f32 v151, v151
    v_mfma_f32_16x16x32_bf16 v[108:111], v[224:227], a[44:47], v[108:111]
    s_waitcnt vmcnt(10) lgkmcnt(0)
    s_barrier
    v_mfma_f32_16x16x32_bf16 v[112:115], v[220:223], a[104:107], v[112:115]
    s_add_u32 m0, s55, 0
    ds_read_b64_tr_b16 v[212:213], v12 offset:16384
    v_mul_f32 v167, v167, v151
    v_mfma_f32_16x16x32_bf16 v[112:115], v[224:227], a[108:111], v[112:115]
    s_add_u32 s70, s57, 384
    ds_read_b64_tr_b16 v[214:215], v12 offset:16896
    v_cvt_pk_bf16_f32 v149, v166, v167
    v_mfma_f32_16x16x32_bf16 v[116:119], v[220:223], a[168:171], v[116:119]
    buffer_load_dwordx4 v8, s[36:39], s70 offen offset:0 lds
    v_mfma_f32_16x16x32_bf16 v[116:119], v[224:227], a[172:175], v[116:119]
    s_sub_u32 s71, s57, 640
    ds_read_b64_tr_b16 v[216:217], v12 offset:18432
    ds_read_b64_tr_b16 v[218:219], v12 offset:18944
    v_mfma_f32_16x16x32_bf16 v[120:123], v[220:223], a[232:235], v[120:123]
    v_fma_f32 v1, v180, v180, s64
    v_mul_f32 v196, v180, v196
    v_mfma_f32_16x16x32_bf16 v[120:123], v[224:227], a[236:239], v[120:123]
    v_mul_f32 v180, v1, v180
    v_fma_f32 v2, v181, v181, s64
    v_mfma_f32_16x16x32_bf16 v[124:127], v[204:207], a[40:43], v[124:127]
    ds_read_b64_tr_b16 v[220:221], v12 offset:17408
    v_mul_f32 v197, v181, v197
    v_mfma_f32_16x16x32_bf16 v[124:127], v[208:211], a[44:47], v[124:127]
    ds_read_b64_tr_b16 v[222:223], v12 offset:17920
    v_mul_f32 v181, v2, v181
    v_mfma_f32_16x16x32_bf16 v[128:131], v[204:207], a[104:107], v[128:131]
    ds_read_b64_tr_b16 v[224:225], v12 offset:19456
    v_fma_f32 v3, v182, v182, s64
    v_mfma_f32_16x16x32_bf16 v[128:131], v[208:211], a[108:111], v[128:131]
    buffer_load_dwordx4 v8, s[40:43], s71 offen offset:1024 lds
    v_mfma_f32_16x16x32_bf16 v[132:135], v[204:207], a[168:171], v[132:135]
    s_add_u32 s72, s57, 293248
    ds_read_b64_tr_b16 v[226:227], v12 offset:19968
    v_mul_f32 v198, v182, v198
    v_mfma_f32_16x16x32_bf16 v[132:135], v[208:211], a[172:175], v[132:135]
    v_exp_f32 v180, v180
    v_mfma_f32_16x16x32_bf16 v[136:139], v[204:207], a[232:235], v[136:139]
    v_exp_f32 v181, v181
    v_mfma_f32_16x16x32_bf16 v[136:139], v[208:211], a[236:239], v[136:139]
    s_waitcnt lgkmcnt(4)
    v_add_f32 v180, 1.0, v180
    v_add_f32 v181, 1.0, v181
    v_mfma_f32_16x16x32_bf16 v[76:79], v[212:215], a[48:51], v[76:79]
    ds_read_b64_tr_b16 v[204:205], v13 offset:16384
    v_mul_f32 v182, v3, v182
    v_mfma_f32_16x16x32_bf16 v[76:79], v[216:219], a[52:55], v[76:79]
    ds_read_b64_tr_b16 v[206:207], v13 offset:16896
    v_fma_f32 v4, v183, v183, s64
    v_mfma_f32_16x16x32_bf16 v[80:83], v[212:215], a[112:115], v[80:83]
    buffer_load_dwordx4 v8, s[36:39], s72 offen offset:2048 lds
    v_mfma_f32_16x16x32_bf16 v[80:83], v[216:219], a[116:119], v[80:83]
    s_add_u32 s73, s57, 292224
    ds_read_b64_tr_b16 v[208:209], v13 offset:18432
    v_mul_f32 v199, v183, v199
    v_mfma_f32_16x16x32_bf16 v[84:87], v[212:215], a[176:179], v[84:87]
    ds_read_b64_tr_b16 v[210:211], v13 offset:18944
    v_mul_f32 v183, v4, v183
    v_mfma_f32_16x16x32_bf16 v[84:87], v[216:219], a[180:183], v[84:87]
    v_rcp_f32 v180, v180
    v_mfma_f32_16x16x32_bf16 v[88:91], v[212:215], a[240:243], v[88:91]
    v_rcp_f32 v181, v181
    v_mfma_f32_16x16x32_bf16 v[88:91], v[216:219], a[244:247], v[88:91]
    s_waitcnt lgkmcnt(4)
    v_exp_f32 v182, v182
    v_mfma_f32_16x16x32_bf16 v[92:95], v[220:223], a[48:51], v[92:95]
    ds_read_b64_tr_b16 v[212:213], v13 offset:17408
    v_mul_f32 v196, v196, v180
    v_mfma_f32_16x16x32_bf16 v[92:95], v[224:227], a[52:55], v[92:95]
    buffer_load_dwordx4 v8, s[40:43], s73 offen offset:3072 lds
    v_mfma_f32_16x16x32_bf16 v[96:99], v[220:223], a[112:115], v[96:99]
    ds_read_b64_tr_b16 v[214:215], v13 offset:17920
    v_mul_f32 v197, v197, v181
    v_mfma_f32_16x16x32_bf16 v[96:99], v[224:227], a[116:119], v[96:99]
    ds_read_b64_tr_b16 v[216:217], v13 offset:19456
    v_add_f32 v182, 1.0, v182
    v_mfma_f32_16x16x32_bf16 v[100:103], v[220:223], a[176:179], v[100:103]
    ds_read_b64_tr_b16 v[218:219], v13 offset:19968
    v_cvt_pk_bf16_f32 v150, v196, v197
    v_mfma_f32_16x16x32_bf16 v[100:103], v[224:227], a[180:183], v[100:103]
    s_waitcnt vmcnt(8)
    v_cmp_gt_u32 vcc, 1, v249
    s_nop 0
    s_cbranch_vccnz L_sp_kv
L_bk_kv:
    v_mfma_f32_16x16x32_bf16 v[104:107], v[220:223], a[240:243], v[104:107]
    buffer_load_dwordx4 v[228:231], v15, s[48:51], s85 offen sc1
    v_mfma_f32_16x16x32_bf16 v[104:107], v[224:227], a[244:247], v[104:107]
    s_waitcnt lgkmcnt(4)
    v_rcp_f32 v182, v182
    v_mfma_f32_16x16x32_bf16 v[108:111], v[204:207], a[48:51], v[108:111]
    s_add_u32 s85, s63, 3072
    v_exp_f32 v183, v183
    v_mfma_f32_16x16x32_bf16 v[108:111], v[208:211], a[52:55], v[108:111]
    s_waitcnt lgkmcnt(0)
    s_barrier
    v_mfma_f32_16x16x32_bf16 v[112:115], v[204:207], a[112:115], v[112:115]
    s_add_u32 m0, s55, 16384
    ds_read_b64_tr_b16 v[220:221], v12 offset:32768
    v_min_u32 v248, 3040, v15
    v_mfma_f32_16x16x32_bf16 v[112:115], v[208:211], a[116:119], v[112:115]
    s_add_u32 s70, s57, 590208
    ds_read_b64_tr_b16 v[222:223], v12 offset:33280
    v_add_u32 v248, 155648, v248
    v_mfma_f32_16x16x32_bf16 v[116:119], v[204:207], a[176:179], v[116:119]
    buffer_load_dwordx4 v8, s[36:39], s70 offen offset:0 lds
    v_mfma_f32_16x16x32_bf16 v[116:119], v[208:211], a[180:183], v[116:119]
    s_add_u32 s71, s57, 589184
    ds_read_b64_tr_b16 v[224:225], v12 offset:34816
    ds_read_b64_tr_b16 v[226:227], v12 offset:35328
    v_mfma_f32_16x16x32_bf16 v[120:123], v[204:207], a[240:243], v[120:123]
    buffer_load_dwordx4 v[232:235], v15, s[48:51], s85 offen sc1
    v_mfma_f32_16x16x32_bf16 v[120:123], v[208:211], a[244:247], v[120:123]
    s_add_u32 s85, s63, 6144
    v_mul_f32 v198, v198, v182
    v_mfma_f32_16x16x32_bf16 v[124:127], v[212:215], a[48:51], v[124:127]
    buffer_load_dwordx4 v8, s[40:43], s71 offen offset:1024 lds
    v_mfma_f32_16x16x32_bf16 v[124:127], v[216:219], a[52:55], v[124:127]
    s_add_u32 s72, s57, 883072
    ds_read_b64_tr_b16 v[204:205], v12 offset:33792
    v_add_f32 v183, 1.0, v183
    v_mfma_f32_16x16x32_bf16 v[128:131], v[212:215], a[112:115], v[128:131]
    ds_read_b64_tr_b16 v[206:207], v12 offset:34304
    v_fma_f32 v252, v152, v152, s64
    v_mfma_f32_16x16x32_bf16 v[128:131], v[216:219], a[116:119], v[128:131]
    ds_read_b64_tr_b16 v[208:209], v12 offset:35840
    v_mul_f32 v168, v152, v168
    v_mfma_f32_16x16x32_bf16 v[132:135], v[212:215], a[176:179], v[132:135]
    buffer_load_dwordx4 v8, s[36:39], s72 offen offset:2048 lds
    v_mfma_f32_16x16x32_bf16 v[132:135], v[216:219], a[180:183], v[132:135]
    s_add_u32 s73, s57, 882048
    ds_read_b64_tr_b16 v[210:211], v12 offset:36352
    v_rcp_f32 v183, v183
    v_mfma_f32_16x16x32_bf16 v[136:139], v[212:215], a[240:243], v[136:139]
    buffer_load_dwordx4 v[236:239], v15, s[48:51], s85 offen sc1
    v_mfma_f32_16x16x32_bf16 v[136:139], v[216:219], a[244:247], v[136:139]
    s_waitcnt lgkmcnt(4)
    s_add_u32 s85, s63, 9216
    v_mul_f32 v199, v199, v183
    v_mfma_f32_16x16x32_bf16 v[76:79], v[220:223], a[56:59], v[76:79]
    ds_read_b64_tr_b16 v[212:213], v13 offset:32768
    v_cvt_pk_bf16_f32 v151, v198, v199
    v_mfma_f32_16x16x32_bf16 v[76:79], v[224:227], a[60:63], v[76:79]
    buffer_store_dwordx4 v[148:151], v19, s[48:51], s12 offen offset:0 sc1
    v_mul_f32 v152, v252, v152
    v_mfma_f32_16x16x32_bf16 v[80:83], v[220:223], a[120:123], v[80:83]
    buffer_load_dwordx4 v8, s[40:43], s73 offen offset:3072 lds
    v_exp_f32 v152, v152
    v_mfma_f32_16x16x32_bf16 v[80:83], v[224:227], a[124:127], v[80:83]
    s_mov_b32 s11, s1
    ds_read_b64_tr_b16 v[214:215], v13 offset:33280
    v_add_f32 v152, 1.0, v152
    v_mfma_f32_16x16x32_bf16 v[84:87], v[220:223], a[184:187], v[84:87]
    ds_read_b64_tr_b16 v[216:217], v13 offset:34816
    ds_write_b128 v19, v[148:151] offset:16384
    v_mfma_f32_16x16x32_bf16 v[84:87], v[224:227], a[188:191], v[84:87]
    ds_read_b64_tr_b16 v[218:219], v13 offset:35328
    v_fma_f32 v1, v153, v153, s64
    v_mfma_f32_16x16x32_bf16 v[88:91], v[220:223], a[248:251], v[88:91]
    buffer_load_dword v11, v6, s[36:39], s11 offen
    v_mfma_f32_16x16x32_bf16 v[88:91], v[224:227], a[252:255], v[88:91]
    s_waitcnt lgkmcnt(5)
    v_rcp_f32 v152, v152
    v_mfma_f32_16x16x32_bf16 v[92:95], v[204:207], a[56:59], v[92:95]
    ds_read_b64_tr_b16 v[220:221], v13 offset:33792
    v_mul_f32 v168, v168, v152
    v_mfma_f32_16x16x32_bf16 v[92:95], v[208:211], a[60:63], v[92:95]
    ds_read_b64_tr_b16 v[222:223], v13 offset:34304
    v_mul_f32 v169, v153, v169
    v_mfma_f32_16x16x32_bf16 v[96:99], v[204:207], a[120:123], v[96:99]
    ds_read_b64_tr_b16 v[224:225], v13 offset:35840
    v_mul_f32 v153, v1, v153
    v_mfma_f32_16x16x32_bf16 v[96:99], v[208:211], a[124:127], v[96:99]
    buffer_load_dword v11, v6, s[40:43], s11 offen
    v_exp_f32 v153, v153
    v_mfma_f32_16x16x32_bf16 v[100:103], v[204:207], a[184:187], v[100:103]
    ds_read_b64_tr_b16 v[226:227], v13 offset:36352
    v_add_f32 v153, 1.0, v153
    v_mfma_f32_16x16x32_bf16 v[100:103], v[208:211], a[188:191], v[100:103]
    buffer_load_dwordx4 v[240:243], v15, s[48:51], s85 offen sc1
    v_mfma_f32_16x16x32_bf16 v[104:107], v[204:207], a[248:251], v[104:107]
    s_add_u32 s85, s63, 12288
    v_rcp_f32 v153, v153
    v_mfma_f32_16x16x32_bf16 v[104:107], v[208:211], a[252:255], v[104:107]
    s_waitcnt lgkmcnt(4)
    v_mul_f32 v169, v169, v153
    v_fma_f32 v2, v154, v154, s64
    v_mfma_f32_16x16x32_bf16 v[108:111], v[212:215], a[56:59], v[108:111]
    v_mul_f32 v170, v154, v170
    v_mul_f32 v154, v2, v154
    v_mfma_f32_16x16x32_bf16 v[108:111], v[216:219], a[60:63], v[108:111]
    s_waitcnt vmcnt(15) lgkmcnt(0)
    s_barrier
    v_mfma_f32_16x16x32_bf16 v[112:115], v[212:215], a[120:123], v[112:115]
    s_add_u32 m0, s55, 32768
    ds_read_b64_tr_b16 v[204:205], v12 offset:49152
    v_fma_f32 v3, v155, v155, s64
    v_mfma_f32_16x16x32_bf16 v[112:115], v[216:219], a[124:127], v[112:115]
    s_add_u32 s70, s57, 1180032
    ds_read_b64_tr_b16 v[206:207], v12 offset:49664
    v_mul_f32 v171, v155, v171
    v_mfma_f32_16x16x32_bf16 v[116:119], v[212:215], a[184:187], v[116:119]
    buffer_load_dwordx4 v8, s[36:39], s70 offen offset:0 lds
    v_mfma_f32_16x16x32_bf16 v[116:119], v[216:219], a[188:191], v[116:119]
    s_add_u32 s71, s57, 1179008
    ds_read_b64_tr_b16 v[208:209], v12 offset:51200
    ds_read_b64_tr_b16 v[210:211], v12 offset:51712
    v_exp_f32 v154, v154
    v_mfma_f32_16x16x32_bf16 v[120:123], v[212:215], a[248:251], v[120:123]
    v_add_f32 v154, 1.0, v154
    v_mul_f32 v155, v3, v155
    v_mfma_f32_16x16x32_bf16 v[120:123], v[216:219], a[252:255], v[120:123]
    v_rcp_f32 v154, v154
    v_mfma_f32_16x16x32_bf16 v[124:127], v[220:223], a[56:59], v[124:127]
    ds_read_b64_tr_b16 v[212:213], v12 offset:50176
    v_mul_f32 v170, v170, v154
    v_mfma_f32_16x16x32_bf16 v[124:127], v[224:227], a[60:63], v[124:127]
    ds_read_b64_tr_b16 v[214:215], v12 offset:50688
    v_cvt_pk_bf16_f32 v152, v168, v169
    v_mfma_f32_16x16x32_bf16 v[128:131], v[220:223], a[120:123], v[128:131]
    ds_read_b64_tr_b16 v[216:217], v12 offset:52224
    v_fma_f32 v4, v184, v184, s64
    v_mfma_f32_16x16x32_bf16 v[128:131], v[224:227], a[124:127], v[128:131]
    buffer_load_dwordx4 v8, s[40:43], s71 offen offset:1024 lds
    v_exp_f32 v155, v155
    v_mfma_f32_16x16x32_bf16 v[132:135], v[220:223], a[184:187], v[132:135]
    s_add_u32 s72, s57, 1472896
    ds_read_b64_tr_b16 v[218:219], v12 offset:52736
    v_add_f32 v155, 1.0, v155
    v_mfma_f32_16x16x32_bf16 v[132:135], v[224:227], a[188:191], v[132:135]
    v_rcp_f32 v155, v155
    v_mfma_f32_16x16x32_bf16 v[136:139], v[220:223], a[248:251], v[136:139]
    v_mul_f32 v171, v171, v155
    v_mul_f32 v200, v184, v200
    v_mfma_f32_16x16x32_bf16 v[136:139], v[224:227], a[252:255], v[136:139]
    s_waitcnt lgkmcnt(4)
    v_cvt_pk_bf16_f32 v153, v170, v171
    v_mul_f32 v184, v4, v184
    v_mfma_f32_16x16x32_bf16 v[76:79], v[204:207], v[44:47], v[76:79]
    ds_read_b64_tr_b16 v[220:221], v13 offset:49152
    v_fma_f32 v252, v185, v185, s64
    v_mfma_f32_16x16x32_bf16 v[76:79], v[208:211], v[48:51], v[76:79]
    ds_read_b64_tr_b16 v[222:223], v13 offset:49664
    v_mul_f32 v201, v185, v201
    v_mfma_f32_16x16x32_bf16 v[80:83], v[204:207], v[52:55], v[80:83]
    buffer_load_dwordx4 v8, s[36:39], s72 offen offset:2048 lds
    v_mfma_f32_16x16x32_bf16 v[80:83], v[208:211], v[56:59], v[80:83]
    s_add_u32 s73, s57, 1471872
    ds_read_b64_tr_b16 v[224:225], v13 offset:51200
    v_mul_f32 v185, v252, v185
    v_mfma_f32_16x16x32_bf16 v[84:87], v[204:207], v[60:63], v[84:87]
    ds_read_b64_tr_b16 v[226:227], v13 offset:51712
    v_fma_f32 v1, v186, v186, s64
    v_mfma_f32_16x16x32_bf16 v[84:87], v[208:211], v[64:67], v[84:87]
    v_exp_f32 v184, v184
    v_mfma_f32_16x16x32_bf16 v[88:91], v[204:207], v[68:71], v[88:91]
    v_exp_f32 v185, v185
    v_mfma_f32_16x16x32_bf16 v[88:91], v[208:211], v[72:75], v[88:91]
    s_waitcnt lgkmcnt(4)
    s_waitcnt vmcnt(11)
    v_add_f32 v228, v228, v232
    v_add_f32 v229, v229, v233
    v_mfma_f32_16x16x32_bf16 v[92:95], v[212:215], v[44:47], v[92:95]
    ds_read_b64_tr_b16 v[204:205], v13 offset:50176
    v_add_f32 v230, v230, v234
    v_mfma_f32_16x16x32_bf16 v[92:95], v[216:219], v[48:51], v[92:95]
    buffer_load_dwordx4 v8, s[40:43], s73 offen offset:3072 lds
    v_mfma_f32_16x16x32_bf16 v[96:99], v[212:215], v[52:55], v[96:99]
    ds_read_b64_tr_b16 v[206:207], v13 offset:50688
    v_add_f32 v184, 1.0, v184
    v_mfma_f32_16x16x32_bf16 v[96:99], v[216:219], v[56:59], v[96:99]
    ds_read_b64_tr_b16 v[208:209], v13 offset:52224
    v_rcp_f32 v184, v184
    v_mfma_f32_16x16x32_bf16 v[100:103], v[212:215], v[60:63], v[100:103]
    ds_read_b64_tr_b16 v[210:211], v13 offset:52736
    v_mul_f32 v200, v200, v184
    v_mfma_f32_16x16x32_bf16 v[100:103], v[216:219], v[64:67], v[100:103]
    v_add_f32 v185, 1.0, v185
    v_add_f32 v231, v231, v235
    v_mfma_f32_16x16x32_bf16 v[104:107], v[212:215], v[68:71], v[104:107]
    v_rcp_f32 v185, v185
    v_mfma_f32_16x16x32_bf16 v[104:107], v[216:219], v[72:75], v[104:107]
    s_waitcnt lgkmcnt(4)
    v_mul_f32 v201, v201, v185
    v_mul_f32 v202, v186, v202
    v_mfma_f32_16x16x32_bf16 v[108:111], v[220:223], v[44:47], v[108:111]
    v_mul_f32 v186, v1, v186
    v_fma_f32 v2, v187, v187, s64
    v_mfma_f32_16x16x32_bf16 v[108:111], v[224:227], v[48:51], v[108:111]
    s_waitcnt lgkmcnt(0)
    s_barrier
    v_mfma_f32_16x16x32_bf16 v[112:115], v[220:223], v[52:55], v[112:115]
    s_add_u32 m0, s55, 49152
    ds_read_b64_tr_b16 v[212:213], v12 offset:0
    v_exp_f32 v186, v186
    v_mfma_f32_16x16x32_bf16 v[112:115], v[224:227], v[56:59], v[112:115]
    s_add_u32 s70, s57, 1769856
    ds_read_b64_tr_b16 v[214:215], v12 offset:512
    v_add_f32 v186, 1.0, v186
    v_mfma_f32_16x16x32_bf16 v[116:119], v[220:223], v[60:63], v[116:119]
    buffer_load_dwordx4 v8, s[36:39], s70 offen offset:0 lds
    v_rcp_f32 v186, v186
    v_mfma_f32_16x16x32_bf16 v[116:119], v[224:227], v[64:67], v[116:119]
    s_add_u32 s71, s57, 1768832
    ds_read_b64_tr_b16 v[216:217], v12 offset:2048
    ds_read_b64_tr_b16 v[218:219], v12 offset:2560
    v_mfma_f32_16x16x32_bf16 v[120:123], v[220:223], v[68:71], v[120:123]
    v_mul_f32 v202, v202, v186
    v_mul_f32 v203, v187, v203
    v_mfma_f32_16x16x32_bf16 v[120:123], v[224:227], v[72:75], v[120:123]
    v_mul_f32 v187, v2, v187
    v_cvt_pk_bf16_f32 v154, v200, v201
    v_mfma_f32_16x16x32_bf16 v[124:127], v[204:207], v[44:47], v[124:127]
    ds_read_b64_tr_b16 v[220:221], v12 offset:1024
    v_exp_f32 v187, v187
    v_mfma_f32_16x16x32_bf16 v[124:127], v[208:211], v[48:51], v[124:127]
    ds_read_b64_tr_b16 v[222:223], v12 offset:1536
    v_add_f32 v187, 1.0, v187
    v_mfma_f32_16x16x32_bf16 v[128:131], v[204:207], v[52:55], v[128:131]
    ds_read_b64_tr_b16 v[224:225], v12 offset:3072
    v_rcp_f32 v187, v187
    v_mfma_f32_16x16x32_bf16 v[128:131], v[208:211], v[56:59], v[128:131]
    buffer_load_dwordx4 v8, s[40:43], s71 offen offset:1024 lds
    v_mul_f32 v203, v203, v187
    v_mfma_f32_16x16x32_bf16 v[132:135], v[204:207], v[60:63], v[132:135]
    s_add_u32 s72, s57, 2062720
    ds_read_b64_tr_b16 v[226:227], v12 offset:3584
    v_cvt_pk_bf16_f32 v155, v202, v203
    v_mfma_f32_16x16x32_bf16 v[132:135], v[208:211], v[64:67], v[132:135]
    buffer_store_dwordx4 v[152:155], v19, s[48:51], s12 offen offset:1024 sc1
    v_mfma_f32_16x16x32_bf16 v[136:139], v[204:207], v[68:71], v[136:139]
    s_add_u32 s12, s12, 16384
    ds_write_b128 v19, v[152:155] offset:17408
    v_mfma_f32_16x16x32_bf16 v[136:139], v[208:211], v[72:75], v[136:139]
L_chain1:
L_pad6:
    s_cbranch_execz L_pad8
    s_waitcnt lgkmcnt(5)
    s_waitcnt vmcnt(7)
    v_add_f32 v236, v236, v240
    v_add_f32 v237, v237, v241
    v_mfma_f32_16x16x32_bf16 v[140:143], v[212:215], a[0:3], 0
    ds_read_b64_tr_b16 v[204:205], v13 offset:0
    v_add_f32 v238, v238, v242
    v_mfma_f32_16x16x32_bf16 v[140:143], v[216:219], a[4:7], v[140:143]
    ds_read_b64_tr_b16 v[206:207], v13 offset:512
    v_add_f32 v239, v239, v243
    v_mfma_f32_16x16x32_bf16 v[144:147], v[212:215], a[64:67], 0
    buffer_load_dwordx4 v8, s[36:39], s72 offen offset:2048 lds
    v_mfma_f32_16x16x32_bf16 v[144:147], v[216:219], a[68:71], v[144:147]
    s_add_u32 s73, s57, 2061696
    ds_read_b64_tr_b16 v[208:209], v13 offset:2048
    v_add_f32 v244, v228, v236
    v_mfma_f32_16x16x32_bf16 v[148:151], v[212:215], a[128:131], 0
    ds_read_b64_tr_b16 v[210:211], v13 offset:2560
    v_add_f32 v245, v229, v237
    v_mfma_f32_16x16x32_bf16 v[148:151], v[216:219], a[132:135], v[148:151]
    v_add_f32 v246, v230, v238
    v_add_f32 v247, v231, v239
    v_mfma_f32_16x16x32_bf16 v[152:155], v[212:215], a[192:195], 0
    buffer_load_dwordx4 v[228:231], v15, s[48:51], s85 offen sc1
    v_mfma_f32_16x16x32_bf16 v[152:155], v[216:219], a[196:199], v[152:155]
    s_waitcnt lgkmcnt(5)
    s_add_u32 s85, s63, 15360
    v_fma_f32 v1, v76, v76, s64
    v_mfma_f32_16x16x32_bf16 v[156:159], v[220:223], a[0:3], 0
    ds_read_b64_tr_b16 v[212:213], v13 offset:1024
    v_mul_f32 v92, v76, v92
    v_mfma_f32_16x16x32_bf16 v[156:159], v[224:227], a[4:7], v[156:159]
    buffer_load_dwordx4 v8, s[40:43], s73 offen offset:3072 lds
    v_mfma_f32_16x16x32_bf16 v[160:163], v[220:223], a[64:67], 0
    ds_read_b64_tr_b16 v[214:215], v13 offset:1536
    v_mul_f32 v76, v1, v76
    v_mfma_f32_16x16x32_bf16 v[160:163], v[224:227], a[68:71], v[160:163]
    ds_read_b64_tr_b16 v[216:217], v13 offset:3072
    v_fma_f32 v2, v77, v77, s64
    v_mfma_f32_16x16x32_bf16 v[164:167], v[220:223], a[128:131], 0
    ds_read_b64_tr_b16 v[218:219], v13 offset:3584
    v_mul_f32 v93, v77, v93
    v_mfma_f32_16x16x32_bf16 v[164:167], v[224:227], a[132:135], v[164:167]
    buffer_load_dwordx4 v[232:235], v15, s[48:51], s85 offen sc1
    v_mfma_f32_16x16x32_bf16 v[168:171], v[220:223], a[192:195], 0
    s_add_u32 s85, s63, 18432
    v_exp_f32 v76, v76
    v_mfma_f32_16x16x32_bf16 v[168:171], v[224:227], a[196:199], v[168:171]
    s_waitcnt lgkmcnt(4)
    v_add_f32 v76, 1.0, v76
    v_mul_f32 v77, v2, v77
    v_mfma_f32_16x16x32_bf16 v[172:175], v[204:207], a[0:3], 0
    buffer_load_dwordx4 v[236:239], v15, s[48:51], s85 offen sc1
    v_mfma_f32_16x16x32_bf16 v[172:175], v[208:211], a[4:7], v[172:175]
    s_waitcnt lgkmcnt(0)
    s_barrier
    v_mfma_f32_16x16x32_bf16 v[176:179], v[204:207], a[64:67], 0
    s_add_u32 m0, s55, 0
    ds_read_b64_tr_b16 v[220:221], v12 offset:16384
    s_add_u32 s85, s63, 21504
    v_mfma_f32_16x16x32_bf16 v[176:179], v[208:211], a[68:71], v[176:179]
    s_add_u32 s70, s57, 2359680
    ds_read_b64_tr_b16 v[222:223], v12 offset:16896
    v_fma_f32 v3, v78, v78, s64
    v_mfma_f32_16x16x32_bf16 v[180:183], v[204:207], a[128:131], 0
    buffer_load_dwordx4 v8, s[36:39], s70 offen offset:0 lds
    v_mfma_f32_16x16x32_bf16 v[180:183], v[208:211], a[132:135], v[180:183]
    s_add_u32 s71, s57, 2358656
    ds_read_b64_tr_b16 v[224:225], v12 offset:18432
    ds_read_b64_tr_b16 v[226:227], v12 offset:18944
    v_mfma_f32_16x16x32_bf16 v[184:187], v[204:207], a[192:195], 0
    buffer_load_dwordx4 v[240:243], v15, s[48:51], s85 offen sc1
    v_mfma_f32_16x16x32_bf16 v[184:187], v[208:211], a[196:199], v[184:187]
    v_rcp_f32 v76, v76
    v_mfma_f32_16x16x32_bf16 v[188:191], v[212:215], a[0:3], 0
    s_add_u32 s85, s63, 24576
    ds_read_b64_tr_b16 v[204:205], v12 offset:17408
    v_mul_f32 v92, v92, v76
    v_mfma_f32_16x16x32_bf16 v[188:191], v[216:219], a[4:7], v[188:191]
    ds_read_b64_tr_b16 v[206:207], v12 offset:17920
    v_mul_f32 v94, v78, v94
    v_mfma_f32_16x16x32_bf16 v[192:195], v[212:215], a[64:67], 0
    ds_read_b64_tr_b16 v[208:209], v12 offset:19456
    v_mul_f32 v78, v3, v78
    v_mfma_f32_16x16x32_bf16 v[192:195], v[216:219], a[68:71], v[192:195]
    buffer_load_dwordx4 v8, s[40:43], s71 offen offset:1024 lds
    v_mfma_f32_16x16x32_bf16 v[196:199], v[212:215], a[128:131], 0
    s_add_u32 s72, s57, 2652544
    ds_read_b64_tr_b16 v[210:211], v12 offset:19968
    v_exp_f32 v77, v77
    v_mfma_f32_16x16x32_bf16 v[196:199], v[216:219], a[132:135], v[196:199]
    v_exp_f32 v78, v78
    v_mfma_f32_16x16x32_bf16 v[200:203], v[212:215], a[192:195], 0
    v_add_f32 v77, 1.0, v77
    v_add_f32 v78, 1.0, v78
    v_mfma_f32_16x16x32_bf16 v[200:203], v[216:219], a[196:199], v[200:203]
    s_waitcnt lgkmcnt(4)
    v_rcp_f32 v77, v77
    v_mfma_f32_16x16x32_bf16 v[140:143], v[220:223], a[8:11], v[140:143]
    ds_read_b64_tr_b16 v[212:213], v13 offset:16384
    v_mul_f32 v93, v93, v77
    v_mfma_f32_16x16x32_bf16 v[140:143], v[224:227], a[12:15], v[140:143]
    ds_read_b64_tr_b16 v[214:215], v13 offset:16896
    v_fma_f32 v4, v79, v79, s64
    v_mfma_f32_16x16x32_bf16 v[144:147], v[220:223], a[72:75], v[144:147]
    buffer_load_dwordx4 v8, s[36:39], s72 offen offset:2048 lds
    v_mfma_f32_16x16x32_bf16 v[144:147], v[224:227], a[76:79], v[144:147]
    s_add_u32 s73, s57, 2651520
    ds_read_b64_tr_b16 v[216:217], v13 offset:18432
    s_waitcnt vmcnt(9)
    v_mfma_f32_16x16x32_bf16 v[148:151], v[220:223], a[136:139], v[148:151]
    buffer_store_dword v255, off, s[48:51], s17 sc1
    v_mov_b32 v255, 3
    v_rcp_f32 v78, v78
    v_mfma_f32_16x16x32_bf16 v[148:151], v[224:227], a[140:143], v[148:151]
    ds_read_b64_tr_b16 v[218:219], v13 offset:18944
    v_mul_f32 v94, v94, v78
    v_mfma_f32_16x16x32_bf16 v[152:155], v[220:223], a[200:203], v[152:155]
    v_mul_f32 v95, v79, v95
    v_mul_f32 v79, v4, v79
    v_mfma_f32_16x16x32_bf16 v[152:155], v[224:227], a[204:207], v[152:155]
    s_waitcnt lgkmcnt(4)
    v_exp_f32 v79, v79
    v_mfma_f32_16x16x32_bf16 v[156:159], v[204:207], a[8:11], v[156:159]
    ds_read_b64_tr_b16 v[220:221], v13 offset:17408
    v_add_f32 v79, 1.0, v79
    v_mfma_f32_16x16x32_bf16 v[156:159], v[208:211], a[12:15], v[156:159]
    buffer_load_dwordx4 v8, s[40:43], s73 offen offset:3072 lds
    v_mfma_f32_16x16x32_bf16 v[160:163], v[204:207], a[72:75], v[160:163]
    ds_read_b64_tr_b16 v[222:223], v13 offset:17920
    v_cvt_pk_bf16_f32 v76, v92, v93
    v_mfma_f32_16x16x32_bf16 v[160:163], v[208:211], a[76:79], v[160:163]
    ds_read_b64_tr_b16 v[224:225], v13 offset:19456
    v_fma_f32 v252, v108, v108, s64
    v_mfma_f32_16x16x32_bf16 v[164:167], v[204:207], a[136:139], v[164:167]
    ds_read_b64_tr_b16 v[226:227], v13 offset:19968
    v_mul_f32 v124, v108, v124
    v_mfma_f32_16x16x32_bf16 v[164:167], v[208:211], a[140:143], v[164:167]
    v_rcp_f32 v79, v79
    v_mfma_f32_16x16x32_bf16 v[168:171], v[204:207], a[200:203], v[168:171]
    v_mul_f32 v95, v95, v79
    v_mul_f32 v108, v252, v108
    v_mfma_f32_16x16x32_bf16 v[168:171], v[208:211], a[204:207], v[168:171]
    s_waitcnt lgkmcnt(4)
    v_exp_f32 v108, v108
    v_mfma_f32_16x16x32_bf16 v[172:175], v[212:215], a[8:11], v[172:175]
    v_cvt_pk_bf16_f32 v77, v94, v95
    v_add_f32 v108, 1.0, v108
    v_mfma_f32_16x16x32_bf16 v[172:175], v[216:219], a[12:15], v[172:175]
    s_waitcnt lgkmcnt(0)
    s_barrier
    v_mfma_f32_16x16x32_bf16 v[176:179], v[212:215], a[72:75], v[176:179]
    s_add_u32 m0, s55, 16384
    ds_read_b64_tr_b16 v[204:205], v12 offset:32768
    v_fma_f32 v1, v109, v109, s64
    v_mfma_f32_16x16x32_bf16 v[176:179], v[216:219], a[76:79], v[176:179]
    s_add_u32 s70, s57, 2949504
    ds_read_b64_tr_b16 v[206:207], v12 offset:33280
    v_mul_f32 v125, v109, v125
    v_mfma_f32_16x16x32_bf16 v[180:183], v[212:215], a[136:139], v[180:183]
    buffer_load_dwordx4 v8, s[36:39], s70 offen offset:0 lds
    v_mfma_f32_16x16x32_bf16 v[180:183], v[216:219], a[140:143], v[180:183]
    s_add_u32 s71, s57, 2948480
    ds_read_b64_tr_b16 v[208:209], v12 offset:34816
    ds_read_b64_tr_b16 v[210:211], v12 offset:35328
    v_mfma_f32_16x16x32_bf16 v[184:187], v[212:215], a[200:203], v[184:187]
    v_rcp_f32 v108, v108
    v_mfma_f32_16x16x32_bf16 v[184:187], v[216:219], a[204:207], v[184:187]
    v_mul_f32 v124, v124, v108
    v_mul_f32 v109, v1, v109
    v_mfma_f32_16x16x32_bf16 v[188:191], v[220:223], a[8:11], v[188:191]
    ds_read_b64_tr_b16 v[212:213], v12 offset:33792
    v_fma_f32 v2, v110, v110, s64
    v_mfma_f32_16x16x32_bf16 v[188:191], v[224:227], a[12:15], v[188:191]
    ds_read_b64_tr_b16 v[214:215], v12 offset:34304
    v_mul_f32 v126, v110, v126
    v_mfma_f32_16x16x32_bf16 v[192:195], v[220:223], a[72:75], v[192:195]
    ds_read_b64_tr_b16 v[216:217], v12 offset:35840
    v_mul_f32 v110, v2, v110
    v_mfma_f32_16x16x32_bf16 v[192:195], v[224:227], a[76:79], v[192:195]
    buffer_load_dwordx4 v8, s[40:43], s71 offen offset:1024 lds
    v_mfma_f32_16x16x32_bf16 v[196:199], v[220:223], a[136:139], v[196:199]
    s_add_u32 s72, s57, 3242368
    ds_read_b64_tr_b16 v[218:219], v12 offset:36352
    v_exp_f32 v109, v109
    v_mfma_f32_16x16x32_bf16 v[196:199], v[224:227], a[140:143], v[196:199]
    v_exp_f32 v110, v110
    v_mfma_f32_16x16x32_bf16 v[200:203], v[220:223], a[200:203], v[200:203]
    s_waitcnt vmcnt(9)
    v_add_f32 v228, v228, v232
    v_add_f32 v229, v229, v233
    v_mfma_f32_16x16x32_bf16 v[200:203], v[224:227], a[204:207], v[200:203]
    s_waitcnt lgkmcnt(4)
    v_add_f32 v230, v230, v234
    v_add_f32 v231, v231, v235
    v_mfma_f32_16x16x32_bf16 v[140:143], v[204:207], a[16:19], v[140:143]
    ds_read_b64_tr_b16 v[220:221], v13 offset:32768
    v_add_f32 v109, 1.0, v109
    v_mfma_f32_16x16x32_bf16 v[140:143], v[208:211], a[20:23], v[140:143]
    ds_read_b64_tr_b16 v[222:223], v13 offset:33280
    v_add_f32 v110, 1.0, v110
    v_mfma_f32_16x16x32_bf16 v[144:147], v[204:207], a[80:83], v[144:147]
    buffer_load_dwordx4 v8, s[36:39], s72 offen offset:2048 lds
    v_mfma_f32_16x16x32_bf16 v[144:147], v[208:211], a[84:87], v[144:147]
    s_add_u32 s73, s57, 3241344
    ds_read_b64_tr_b16 v[224:225], v13 offset:34816
    v_fma_f32 v3, v111, v111, s64
    v_mfma_f32_16x16x32_bf16 v[148:151], v[204:207], a[144:147], v[148:151]
    ds_read_b64_tr_b16 v[226:227], v13 offset:35328
    v_mul_f32 v127, v111, v127
    v_mfma_f32_16x16x32_bf16 v[148:151], v[208:211], a[148:151], v[148:151]
    v_rcp_f32 v109, v109
    v_mfma_f32_16x16x32_bf16 v[152:155], v[204:207], a[208:211], v[152:155]
    v_rcp_f32 v110, v110
    v_mfma_f32_16x16x32_bf16 v[152:155], v[208:211], a[212:215], v[152:155]
    s_waitcnt lgkmcnt(4)
    s_waitcnt vmcnt(7)
    v_add_f32 v236, v236, v240
    v_add_f32 v237, v237, v241
    v_mfma_f32_16x16x32_bf16 v[156:159], v[212:215], a[16:19], v[156:159]
    ds_read_b64_tr_b16 v[204:205], v13 offset:33792
    v_add_f32 v238, v238, v242
    v_mfma_f32_16x16x32_bf16 v[156:159], v[216:219], a[20:23], v[156:159]
    buffer_load_dwordx4 v8, s[40:43], s73 offen offset:3072 lds
    v_mfma_f32_16x16x32_bf16 v[160:163], v[212:215], a[80:83], v[160:163]
    ds_read_b64_tr_b16 v[206:207], v13 offset:34304
    v_add_f32 v239, v239, v243
    v_mfma_f32_16x16x32_bf16 v[160:163], v[216:219], a[84:87], v[160:163]
    ds_read_b64_tr_b16 v[208:209], v13 offset:35840
    v_add_f32 v228, v228, v236
    v_mfma_f32_16x16x32_bf16 v[164:167], v[212:215], a[144:147], v[164:167]
    ds_read_b64_tr_b16 v[210:211], v13 offset:36352
    v_add_f32 v244, v244, v228
    v_mfma_f32_16x16x32_bf16 v[164:167], v[216:219], a[148:151], v[164:167]
    v_add_f32 v229, v229, v237
    v_add_f32 v230, v230, v238
    v_mfma_f32_16x16x32_bf16 v[168:171], v[212:215], a[208:211], v[168:171]
    v_add_f32 v245, v245, v229
    v_add_f32 v246, v246, v230
    v_mfma_f32_16x16x32_bf16 v[168:171], v[216:219], a[212:215], v[168:171]
    s_waitcnt lgkmcnt(4)
    v_add_f32 v231, v231, v239
    v_mul_f32 v125, v125, v109
    v_mfma_f32_16x16x32_bf16 v[172:175], v[220:223], a[16:19], v[172:175]
    v_add_f32 v247, v247, v231
    v_mul_f32 v126, v126, v110
    v_mfma_f32_16x16x32_bf16 v[172:175], v[224:227], a[20:23], v[172:175]
    s_waitcnt lgkmcnt(0)
    s_barrier
    v_mfma_f32_16x16x32_bf16 v[176:179], v[220:223], a[80:83], v[176:179]
    s_add_u32 m0, s55, 32768
    ds_read_b64_tr_b16 v[212:213], v12 offset:49152
    v_mul_f32 v111, v3, v111
    v_mfma_f32_16x16x32_bf16 v[176:179], v[224:227], a[84:87], v[176:179]
    s_add_u32 s70, s57, 3539328
    ds_read_b64_tr_b16 v[214:215], v12 offset:49664
    v_cvt_pk_bf16_f32 v78, v124, v125
    v_mfma_f32_16x16x32_bf16 v[180:183], v[220:223], a[144:147], v[180:183]
    buffer_load_dwordx4 v8, s[36:39], s70 offen offset:0 lds
    v_mfma_f32_16x16x32_bf16 v[180:183], v[224:227], a[148:151], v[180:183]
    s_add_u32 s71, s57, 3538304
    ds_read_b64_tr_b16 v[216:217], v12 offset:51200
    ds_read_b64_tr_b16 v[218:219], v12 offset:51712
    v_mfma_f32_16x16x32_bf16 v[184:187], v[220:223], a[208:211], v[184:187]
    buffer_load_dwordx4 v[228:231], v15, s[48:51], s85 offen sc1
    v_mfma_f32_16x16x32_bf16 v[184:187], v[224:227], a[212:215], v[184:187]
    v_exp_f32 v111, v111
    v_mfma_f32_16x16x32_bf16 v[188:191], v[204:207], a[16:19], v[188:191]
    s_add_u32 s85, s63, 27648
    ds_read_b64_tr_b16 v[220:221], v12 offset:50176
    v_add_f32 v111, 1.0, v111
    v_mfma_f32_16x16x32_bf16 v[188:191], v[208:211], a[20:23], v[188:191]
    ds_read_b64_tr_b16 v[222:223], v12 offset:50688
    v_fma_f32 v4, v80, v80, s64
    v_mfma_f32_16x16x32_bf16 v[192:195], v[204:207], a[80:83], v[192:195]
    ds_read_b64_tr_b16 v[224:225], v12 offset:52224
    v_mul_f32 v96, v80, v96
    v_mfma_f32_16x16x32_bf16 v[192:195], v[208:211], a[84:87], v[192:195]
    buffer_load_dwordx4 v8, s[40:43], s71 offen offset:1024 lds
    v_mfma_f32_16x16x32_bf16 v[196:199], v[204:207], a[144:147], v[196:199]
    s_add_u32 s72, s57, 3832192
    ds_read_b64_tr_b16 v[226:227], v12 offset:52736
    v_rcp_f32 v111, v111
    v_mfma_f32_16x16x32_bf16 v[196:199], v[208:211], a[148:151], v[196:199]
    buffer_load_dwordx4 v[232:235], v15, s[48:51], s85 offen sc1
    v_mfma_f32_16x16x32_bf16 v[200:203], v[204:207], a[208:211], v[200:203]
    s_add_u32 s85, s63, 30720
    v_mul_f32 v127, v127, v111
    v_mul_f32 v80, v4, v80
    v_mfma_f32_16x16x32_bf16 v[200:203], v[208:211], a[212:215], v[200:203]
    s_waitcnt lgkmcnt(4)
    v_exp_f32 v80, v80
    v_mfma_f32_16x16x32_bf16 v[140:143], v[212:215], a[24:27], v[140:143]
    ds_read_b64_tr_b16 v[204:205], v13 offset:49152
    v_cvt_pk_bf16_f32 v79, v126, v127
    v_mfma_f32_16x16x32_bf16 v[140:143], v[216:219], a[28:31], v[140:143]
    buffer_store_dwordx4 v[76:79], v18, s[48:51], s12 offen offset:0 sc1
    v_mfma_f32_16x16x32_bf16 v[144:147], v[212:215], a[88:91], v[144:147]
    buffer_load_dwordx4 v8, s[36:39], s72 offen offset:2048 lds
    v_mfma_f32_16x16x32_bf16 v[144:147], v[216:219], a[92:95], v[144:147]
    s_add_u32 s73, s57, 3831168
    ds_read_b64_tr_b16 v[206:207], v13 offset:49664
    ds_write_b128 v18, v[76:79] offset:32768
    v_mfma_f32_16x16x32_bf16 v[148:151], v[212:215], a[152:155], v[148:151]
    ds_read_b64_tr_b16 v[208:209], v13 offset:51200
    v_add_f32 v80, 1.0, v80
    v_mfma_f32_16x16x32_bf16 v[148:151], v[216:219], a[156:159], v[148:151]
    ds_read_b64_tr_b16 v[210:211], v13 offset:51712
    v_fma_f32 v252, v81, v81, s64
    v_mfma_f32_16x16x32_bf16 v[152:155], v[212:215], a[216:219], v[152:155]
    buffer_load_dwordx4 v[236:239], v15, s[48:51], s85 offen sc1
    v_mfma_f32_16x16x32_bf16 v[152:155], v[216:219], a[220:223], v[152:155]
    s_waitcnt lgkmcnt(5)
    v_rcp_f32 v80, v80
    v_mfma_f32_16x16x32_bf16 v[156:159], v[220:223], a[24:27], v[156:159]
    s_add_u32 s85, s63, 33792
    ds_read_b64_tr_b16 v[212:213], v13 offset:50176
    v_mul_f32 v96, v96, v80
    v_mfma_f32_16x16x32_bf16 v[156:159], v[224:227], a[28:31], v[156:159]
    buffer_load_dwordx4 v8, s[40:43], s73 offen offset:3072 lds
    v_mfma_f32_16x16x32_bf16 v[160:163], v[220:223], a[88:91], v[160:163]
    ds_read_b64_tr_b16 v[214:215], v13 offset:50688
    v_mul_f32 v97, v81, v97
    v_mfma_f32_16x16x32_bf16 v[160:163], v[224:227], a[92:95], v[160:163]
    ds_read_b64_tr_b16 v[216:217], v13 offset:52224
    v_mul_f32 v81, v252, v81
    v_mfma_f32_16x16x32_bf16 v[164:167], v[220:223], a[152:155], v[164:167]
    ds_read_b64_tr_b16 v[218:219], v13 offset:52736
    v_exp_f32 v81, v81
    v_mfma_f32_16x16x32_bf16 v[164:167], v[224:227], a[156:159], v[164:167]
    buffer_load_dwordx4 v[240:243], v15, s[48:51], s85 offen sc1
    v_mfma_f32_16x16x32_bf16 v[168:171], v[220:223], a[216:219], v[168:171]
    s_add_u32 s85, s63, 36864
    v_add_f32 v81, 1.0, v81
    v_fma_f32 v1, v82, v82, s64
    v_mfma_f32_16x16x32_bf16 v[168:171], v[224:227], a[220:223], v[168:171]
    s_waitcnt lgkmcnt(4)
    v_rcp_f32 v81, v81
    v_mfma_f32_16x16x32_bf16 v[172:175], v[204:207], a[24:27], v[172:175]
    v_mul_f32 v97, v97, v81
    v_mul_f32 v98, v82, v98
    v_mfma_f32_16x16x32_bf16 v[172:175], v[208:211], a[28:31], v[172:175]
    s_waitcnt vmcnt(13) lgkmcnt(0)
    s_barrier
    v_mfma_f32_16x16x32_bf16 v[176:179], v[204:207], a[88:91], v[176:179]
    s_add_u32 m0, s55, 49152
    ds_read_b64_tr_b16 v[220:221], v12 offset:0
    v_mul_f32 v82, v1, v82
    v_mfma_f32_16x16x32_bf16 v[176:179], v[208:211], a[92:95], v[176:179]
    s_add_u32 s70, s57, 4129152
    ds_read_b64_tr_b16 v[222:223], v12 offset:512
    v_fma_f32 v2, v83, v83, s64
    v_mfma_f32_16x16x32_bf16 v[180:183], v[204:207], a[152:155], v[180:183]
    buffer_load_dwordx4 v8, s[36:39], s70 offen offset:0 lds
    v_mfma_f32_16x16x32_bf16 v[180:183], v[208:211], a[156:159], v[180:183]
    s_add_u32 s71, s57, 4128128
    ds_read_b64_tr_b16 v[224:225], v12 offset:2048
    ds_read_b64_tr_b16 v[226:227], v12 offset:2560
    v_mfma_f32_16x16x32_bf16 v[184:187], v[204:207], a[216:219], v[184:187]
    v_exp_f32 v82, v82
    v_mfma_f32_16x16x32_bf16 v[184:187], v[208:211], a[220:223], v[184:187]
    v_add_f32 v82, 1.0, v82
    v_mul_f32 v99, v83, v99
    v_mfma_f32_16x16x32_bf16 v[188:191], v[212:215], a[24:27], v[188:191]
    ds_read_b64_tr_b16 v[204:205], v12 offset:1024
    v_mul_f32 v83, v2, v83
    v_mfma_f32_16x16x32_bf16 v[188:191], v[216:219], a[28:31], v[188:191]
    buffer_load_dwordx4 v8, s[40:43], s71 offen offset:1024 lds
    v_rcp_f32 v82, v82
    v_mfma_f32_16x16x32_bf16 v[192:195], v[212:215], a[88:91], v[192:195]
    s_add_u32 s72, s57, 4422016
    ds_read_b64_tr_b16 v[206:207], v12 offset:1536
    v_mul_f32 v98, v98, v82
    v_mfma_f32_16x16x32_bf16 v[192:195], v[216:219], a[92:95], v[192:195]
    ds_read_b64_tr_b16 v[208:209], v12 offset:3072
    v_cvt_pk_bf16_f32 v80, v96, v97
    v_mfma_f32_16x16x32_bf16 v[196:199], v[212:215], a[152:155], v[196:199]
    ds_read_b64_tr_b16 v[210:211], v12 offset:3584
    v_fma_f32 v3, v112, v112, s64
    v_mfma_f32_16x16x32_bf16 v[196:199], v[216:219], a[156:159], v[196:199]
    v_exp_f32 v83, v83
    v_mfma_f32_16x16x32_bf16 v[200:203], v[212:215], a[216:219], v[200:203]
    buffer_load_dwordx4 v8, s[36:39], s72 offen offset:2048 lds
    v_mfma_f32_16x16x32_bf16 v[200:203], v[216:219], a[220:223], v[200:203]
    s_waitcnt lgkmcnt(4)
    v_add_f32 v83, 1.0, v83
    v_mul_f32 v128, v112, v128
    v_mfma_f32_16x16x32_bf16 v[140:143], v[220:223], a[32:35], v[140:143]
    s_add_u32 s73, s57, 4420992
    ds_read_b64_tr_b16 v[212:213], v13 offset:0
    v_rcp_f32 v83, v83
    v_mfma_f32_16x16x32_bf16 v[140:143], v[224:227], a[36:39], v[140:143]
    ds_read_b64_tr_b16 v[214:215], v13 offset:512
    v_mul_f32 v99, v99, v83
    v_mfma_f32_16x16x32_bf16 v[144:147], v[220:223], a[96:99], v[144:147]
    ds_read_b64_tr_b16 v[216:217], v13 offset:2048
    v_cvt_pk_bf16_f32 v81, v98, v99
    v_mfma_f32_16x16x32_bf16 v[144:147], v[224:227], a[100:103], v[144:147]
    ds_read_b64_tr_b16 v[218:219], v13 offset:2560
    v_mul_f32 v112, v3, v112
    v_mfma_f32_16x16x32_bf16 v[148:151], v[220:223], a[160:163], v[148:151]
    buffer_load_dwordx4 v8, s[40:43], s73 offen offset:3072 lds
    v_exp_f32 v112, v112
    v_mfma_f32_16x16x32_bf16 v[148:151], v[224:227], a[164:167], v[148:151]
    s_and_b32 s11, s53, 7
    s_lshl_b32 s10, s54, 3
    v_add_f32 v112, 1.0, v112
    v_mfma_f32_16x16x32_bf16 v[152:155], v[220:223], a[224:227], v[152:155]
    s_add_u32 s11, s11, s10
    s_lshl_b32 s11, s11, 2
    v_fma_f32 v4, v113, v113, s64
    v_mfma_f32_16x16x32_bf16 v[152:155], v[224:227], a[228:231], v[152:155]
    s_waitcnt lgkmcnt(4)
    v_rcp_f32 v112, v112
    v_mfma_f32_16x16x32_bf16 v[156:159], v[204:207], a[32:35], v[156:159]
    s_add_u32 s11, s11, s52
    ds_read_b64_tr_b16 v[220:221], v13 offset:1024
    v_mul_f32 v128, v128, v112
    v_mfma_f32_16x16x32_bf16 v[156:159], v[208:211], a[36:39], v[156:159]
    s_mul_i32 s11, s11, 4608
    ds_read_b64_tr_b16 v[222:223], v13 offset:1536
    v_mul_f32 v129, v113, v129
    v_mfma_f32_16x16x32_bf16 v[160:163], v[204:207], a[96:99], v[160:163]
    ds_read_b64_tr_b16 v[224:225], v13 offset:3072
    v_mul_f32 v113, v4, v113
    v_mfma_f32_16x16x32_bf16 v[160:163], v[208:211], a[100:103], v[160:163]
    ds_read_b64_tr_b16 v[226:227], v13 offset:3584
    v_exp_f32 v113, v113
    v_mfma_f32_16x16x32_bf16 v[164:167], v[204:207], a[160:163], v[164:167]
    v_min_u32 v7, 35, v0
    v_add_f32 v113, 1.0, v113
    v_mfma_f32_16x16x32_bf16 v[164:167], v[208:211], a[164:167], v[164:167]
    v_lshlrev_b32 v7, 7, v7
    s_waitcnt vmcnt(9)
    v_add_f32 v228, v228, v232
    v_mfma_f32_16x16x32_bf16 v[168:171], v[204:207], a[224:227], v[168:171]
    buffer_load_dword v11, v7, s[24:27], s11 offen
    v_rcp_f32 v113, v113
    v_mfma_f32_16x16x32_bf16 v[168:171], v[208:211], a[228:231], v[168:171]
    s_waitcnt lgkmcnt(4)
    v_add_f32 v229, v229, v233
    v_add_f32 v230, v230, v234
    v_mfma_f32_16x16x32_bf16 v[172:175], v[212:215], a[32:35], v[172:175]
    s_waitcnt lgkmcnt(0)
    s_barrier
    s_and_b32 s3, s53, 1
    s_mul_i32 s56, s3, 640
    s_sub_u32 s11, 512, s56
    s_add_u32 s59, s59, s56
    s_add_u32 s60, s60, s56
    s_add_u32 s61, s61, s56
    s_lshl_b32 s56, s56, 7
    s_add_u32 s62, s62, s56
    s_lshl_b32 s3, s3, 1
    s_sub_u32 s3, 1, s3
    s_mul_i32 s0, s3, 368640
    s_add_u32 s0, s0, s59
    s_mul_i32 s1, s3, 36864
    s_add_u32 s1, s1, s60
    s_mul_i32 s10, s3, 41472
    s_add_u32 s10, s10, s61
    v_mfma_f32_16x16x32_bf16 v[172:175], v[216:219], a[36:39], v[172:175]
    s_add_u32 m0, s55, 0
    ds_read_b64_tr_b16 v[204:205], v12 offset:16384
    v_and_b32 v253, 1, v0
    v_mfma_f32_16x16x32_bf16 v[176:179], v[212:215], a[96:99], v[176:179]
    s_add_u32 s70, s57, 4718976
    ds_read_b64_tr_b16 v[206:207], v12 offset:16896
    v_lshlrev_b32 v253, 7, v253
    v_mul_f32 v129, v129, v113
    v_fma_f32 v252, v114, v114, s64
    v_mfma_f32_16x16x32_bf16 v[176:179], v[216:219], a[100:103], v[176:179]
    buffer_load_dword v254, v253, s[48:51], s15 offen sc1
    v_mul_f32 v130, v114, v130
    v_mfma_f32_16x16x32_bf16 v[180:183], v[212:215], a[160:163], v[180:183]
    buffer_load_dwordx4 v8, s[36:39], s70 offen offset:0 lds
    v_mul_f32 v114, v252, v114
    v_mfma_f32_16x16x32_bf16 v[180:183], v[216:219], a[164:167], v[180:183]
    s_add_u32 s71, s57, 4717952
    ds_read_b64_tr_b16 v[208:209], v12 offset:18432
    ds_read_b64_tr_b16 v[210:211], v12 offset:18944
    v_exp_f32 v114, v114
    v_mfma_f32_16x16x32_bf16 v[184:187], v[212:215], a[224:227], v[184:187]
    v_add_f32 v114, 1.0, v114
    v_add_f32 v231, v231, v235
    v_mfma_f32_16x16x32_bf16 v[184:187], v[216:219], a[228:231], v[184:187]
    v_rcp_f32 v114, v114
    v_mfma_f32_16x16x32_bf16 v[188:191], v[220:223], a[32:35], v[188:191]
    ds_read_b64_tr_b16 v[212:213], v12 offset:17408
    v_mul_f32 v130, v130, v114
    v_mfma_f32_16x16x32_bf16 v[188:191], v[224:227], a[36:39], v[188:191]
    ds_read_b64_tr_b16 v[214:215], v12 offset:17920
    v_fma_f32 v1, v115, v115, s64
    v_mfma_f32_16x16x32_bf16 v[192:195], v[220:223], a[96:99], v[192:195]
    buffer_load_dwordx4 v8, s[40:43], s71 offen offset:1024 lds
    v_mfma_f32_16x16x32_bf16 v[192:195], v[224:227], a[100:103], v[192:195]
    s_add_u32 s72, s57, 5011840
    ds_read_b64_tr_b16 v[216:217], v12 offset:19456
    v_mul_f32 v131, v115, v131
    v_mul_f32 v115, v1, v115
    v_mfma_f32_16x16x32_bf16 v[196:199], v[220:223], a[160:163], v[196:199]
    ds_read_b64_tr_b16 v[218:219], v12 offset:19968
    v_exp_f32 v115, v115
    v_mfma_f32_16x16x32_bf16 v[196:199], v[224:227], a[164:167], v[196:199]
    s_waitcnt vmcnt(8)
    v_add_f32 v236, v236, v240
    v_add_f32 v237, v237, v241
    v_mfma_f32_16x16x32_bf16 v[200:203], v[220:223], a[224:227], v[200:203]
    v_add_f32 v238, v238, v242
    v_add_f32 v239, v239, v243
    v_mfma_f32_16x16x32_bf16 v[200:203], v[224:227], a[228:231], v[200:203]
    s_waitcnt lgkmcnt(4)
    v_add_f32 v228, v228, v236
    v_add_f32 v229, v229, v237
    v_mfma_f32_16x16x32_bf16 v[140:143], v[204:207], a[40:43], v[140:143]
    ds_read_b64_tr_b16 v[220:221], v13 offset:16384
    v_add_f32 v244, v244, v228
    v_mfma_f32_16x16x32_bf16 v[140:143], v[208:211], a[44:47], v[140:143]
    buffer_load_dwordx4 v8, s[36:39], s72 offen offset:2048 lds
    v_mfma_f32_16x16x32_bf16 v[144:147], v[204:207], a[104:107], v[144:147]
    s_add_u32 s73, s57, 5010816
    ds_read_b64_tr_b16 v[222:223], v13 offset:16896
    v_add_f32 v245, v245, v229
    v_mfma_f32_16x16x32_bf16 v[144:147], v[208:211], a[108:111], v[144:147]
    ds_read_b64_tr_b16 v[224:225], v13 offset:18432
    v_add_f32 v230, v230, v238
    v_mfma_f32_16x16x32_bf16 v[148:151], v[204:207], a[168:171], v[148:151]
    ds_read_b64_tr_b16 v[226:227], v13 offset:18944
    v_add_f32 v115, 1.0, v115
    v_mfma_f32_16x16x32_bf16 v[148:151], v[208:211], a[172:175], v[148:151]
    v_rcp_f32 v115, v115
    v_mfma_f32_16x16x32_bf16 v[152:155], v[204:207], a[232:235], v[152:155]
    v_add_f32 v246, v246, v230
    v_add_f32 v231, v231, v239
    v_mfma_f32_16x16x32_bf16 v[152:155], v[208:211], a[236:239], v[152:155]
    s_waitcnt lgkmcnt(4)
    v_add_f32 v247, v247, v231
    v_mul_f32 v131, v131, v115
    v_mfma_f32_16x16x32_bf16 v[156:159], v[212:215], a[40:43], v[156:159]
    buffer_load_dwordx4 v8, s[40:43], s73 offen offset:3072 lds
    v_mfma_f32_16x16x32_bf16 v[156:159], v[216:219], a[44:47], v[156:159]
    ds_read_b64_tr_b16 v[204:205], v13 offset:17408
    v_cvt_pk_bf16_f32 v82, v128, v129
    v_mfma_f32_16x16x32_bf16 v[160:163], v[212:215], a[104:107], v[160:163]
    ds_read_b64_tr_b16 v[206:207], v13 offset:17920
    v_cvt_pk_bf16_f32 v83, v130, v131
    v_mfma_f32_16x16x32_bf16 v[160:163], v[216:219], a[108:111], v[160:163]
    buffer_store_dwordx4 v[80:83], v18, s[48:51], s12 offen offset:1024 sc1
    v_fma_f32 v2, v84, v84, s64
    v_mfma_f32_16x16x32_bf16 v[164:167], v[212:215], a[168:171], v[164:167]
    ds_read_b64_tr_b16 v[208:209], v13 offset:19456
    ds_write_b128 v18, v[80:83] offset:33792
    v_mfma_f32_16x16x32_bf16 v[164:167], v[216:219], a[172:175], v[164:167]
    ds_read_b64_tr_b16 v[210:211], v13 offset:19968
    v_mul_f32 v100, v84, v100
    v_mfma_f32_16x16x32_bf16 v[168:171], v[212:215], a[232:235], v[168:171]
    buffer_load_dwordx4 v[228:231], v15, s[48:51], s85 offen sc1
    v_mfma_f32_16x16x32_bf16 v[168:171], v[216:219], a[236:239], v[168:171]
    s_waitcnt lgkmcnt(5)
    v_mul_f32 v84, v2, v84
    s_add_u32 s85, s63, 39936
    v_mfma_f32_16x16x32_bf16 v[172:175], v[220:223], a[40:43], v[172:175]
    buffer_load_dwordx4 v[232:235], v15, s[48:51], s85 offen sc1
    v_mfma_f32_16x16x32_bf16 v[172:175], v[224:227], a[44:47], v[172:175]
    s_add_u32 s85, s63, 43008
    v_exp_f32 v84, v84
    v_mfma_f32_16x16x32_bf16 v[176:179], v[220:223], a[104:107], v[176:179]
    s_waitcnt lgkmcnt(0)
    s_barrier
    v_mfma_f32_16x16x32_bf16 v[176:179], v[224:227], a[108:111], v[176:179]
    s_add_u32 m0, s55, 16384
    ds_read_b64_tr_b16 v[212:213], v12 offset:32768
    v_add_f32 v84, 1.0, v84
    v_fma_f32 v3, v85, v85, s64
    v_mfma_f32_16x16x32_bf16 v[180:183], v[220:223], a[168:171], v[180:183]
    s_add_u32 s70, s58, 0
    ds_read_b64_tr_b16 v[214:215], v12 offset:33280
    v_rcp_f32 v84, v84
    v_mfma_f32_16x16x32_bf16 v[180:183], v[224:227], a[172:175], v[180:183]
    buffer_load_dwordx4 v9, s[36:39], s70 offen offset:0 lds
    v_mfma_f32_16x16x32_bf16 v[184:187], v[220:223], a[232:235], v[184:187]
    s_sub_u32 s71, s58, 1024
    ds_read_b64_tr_b16 v[216:217], v12 offset:34816
    ds_read_b64_tr_b16 v[218:219], v12 offset:35328
    v_mul_f32 v100, v100, v84
    v_mul_f32 v101, v85, v101
    v_mfma_f32_16x16x32_bf16 v[184:187], v[224:227], a[236:239], v[184:187]
    s_waitcnt vmcnt(8)
    v_cmp_gt_u32 vcc, 2, v254
    s_nop 0
    s_cbranch_vccnz L_sp_ha
L_bk_ha:
    v_mul_f32 v85, v3, v85
    v_mfma_f32_16x16x32_bf16 v[188:191], v[204:207], a[40:43], v[188:191]
    ds_read_b64_tr_b16 v[220:221], v12 offset:33792
    v_exp_f32 v85, v85
    v_mfma_f32_16x16x32_bf16 v[188:191], v[208:211], a[44:47], v[188:191]
    ds_read_b64_tr_b16 v[222:223], v12 offset:34304
    v_add_f32 v85, 1.0, v85
    v_mfma_f32_16x16x32_bf16 v[192:195], v[204:207], a[104:107], v[192:195]
    ds_read_b64_tr_b16 v[224:225], v12 offset:35840
    v_rcp_f32 v85, v85
    v_mfma_f32_16x16x32_bf16 v[192:195], v[208:211], a[108:111], v[192:195]
    ds_read_b64_tr_b16 v[226:227], v12 offset:36352
    v_mul_f32 v101, v101, v85
    v_mfma_f32_16x16x32_bf16 v[196:199], v[204:207], a[168:171], v[196:199]
    buffer_load_dwordx4 v9, s[40:43], s71 offen offset:1024 lds
    v_fma_f32 v4, v86, v86, s64
    v_mul_f32 v102, v86, v102
    v_mfma_f32_16x16x32_bf16 v[196:199], v[208:211], a[172:175], v[196:199]
    s_add_u32 s72, s58, 587776
    v_mul_f32 v86, v4, v86
    v_fma_f32 v252, v87, v87, s64
    v_mfma_f32_16x16x32_bf16 v[200:203], v[204:207], a[232:235], v[200:203]
    buffer_load_dwordx4 v[236:239], v15, s[48:51], s85 offen sc1
    v_mfma_f32_16x16x32_bf16 v[200:203], v[208:211], a[236:239], v[200:203]
    s_waitcnt lgkmcnt(4)
    v_exp_f32 v86, v86
    v_mfma_f32_16x16x32_bf16 v[140:143], v[212:215], a[48:51], v[140:143]
    s_add_u32 s85, s63, 46080
L_pad7:
    s_cbranch_execz L_pad9
    ds_read_b64_tr_b16 v[204:205], v13 offset:32768
    v_add_f32 v86, 1.0, v86
    v_mfma_f32_16x16x32_bf16 v[140:143], v[216:219], a[52:55], v[140:143]
    ds_read_b64_tr_b16 v[206:207], v13 offset:33280
    v_mul_f32 v103, v87, v103
    v_mfma_f32_16x16x32_bf16 v[144:147], v[212:215], a[112:115], v[144:147]
    ds_read_b64_tr_b16 v[208:209], v13 offset:34816
    v_mul_f32 v87, v252, v87
    v_mfma_f32_16x16x32_bf16 v[144:147], v[216:219], a[116:119], v[144:147]
    buffer_load_dwordx4 v9, s[36:39], s72 offen offset:2048 lds
    v_rcp_f32 v86, v86
    v_mfma_f32_16x16x32_bf16 v[148:151], v[212:215], a[176:179], v[148:151]
    s_add_u32 s73, s58, 586752
    ds_read_b64_tr_b16 v[210:211], v13 offset:35328
    v_mul_f32 v102, v102, v86
    v_mfma_f32_16x16x32_bf16 v[148:151], v[216:219], a[180:183], v[148:151]
    buffer_load_dwordx4 v[240:243], v15, s[48:51], s85 offen sc1
    v_mfma_f32_16x16x32_bf16 v[152:155], v[212:215], a[240:243], v[152:155]
    v_exp_f32 v87, v87
    v_mfma_f32_16x16x32_bf16 v[152:155], v[216:219], a[244:247], v[152:155]
    s_waitcnt lgkmcnt(4)
    v_add_f32 v87, 1.0, v87
    v_cvt_pk_bf16_f32 v84, v100, v101
    v_mfma_f32_16x16x32_bf16 v[156:159], v[220:223], a[48:51], v[156:159]
    ds_read_b64_tr_b16 v[212:213], v13 offset:33792
    v_fma_f32 v1, v116, v116, s64
    v_mfma_f32_16x16x32_bf16 v[156:159], v[224:227], a[52:55], v[156:159]
    ds_read_b64_tr_b16 v[214:215], v13 offset:34304
    v_mul_f32 v132, v116, v132
    v_mfma_f32_16x16x32_bf16 v[160:163], v[220:223], a[112:115], v[160:163]
    buffer_load_dwordx4 v9, s[40:43], s73 offen offset:3072 lds
    v_mfma_f32_16x16x32_bf16 v[160:163], v[224:227], a[116:119], v[160:163]
    ds_read_b64_tr_b16 v[216:217], v13 offset:35840
    v_rcp_f32 v87, v87
    v_mfma_f32_16x16x32_bf16 v[164:167], v[220:223], a[176:179], v[164:167]
    ds_read_b64_tr_b16 v[218:219], v13 offset:36352
    v_mul_f32 v103, v103, v87
    v_mfma_f32_16x16x32_bf16 v[164:167], v[224:227], a[180:183], v[164:167]
    v_cvt_pk_bf16_f32 v85, v102, v103
    v_mul_f32 v116, v1, v116
    v_mfma_f32_16x16x32_bf16 v[168:171], v[220:223], a[240:243], v[168:171]
    v_exp_f32 v116, v116
    v_mfma_f32_16x16x32_bf16 v[168:171], v[224:227], a[244:247], v[168:171]
    s_waitcnt lgkmcnt(4)
    v_add_f32 v116, 1.0, v116
    v_fma_f32 v2, v117, v117, s64
    v_mfma_f32_16x16x32_bf16 v[172:175], v[204:207], a[48:51], v[172:175]
    v_rcp_f32 v116, v116
    v_mfma_f32_16x16x32_bf16 v[172:175], v[208:211], a[52:55], v[172:175]
    s_waitcnt lgkmcnt(0)
    s_barrier
    v_mfma_f32_16x16x32_bf16 v[176:179], v[204:207], a[112:115], v[176:179]
    s_add_u32 m0, s55, 32768
    ds_read_b64_tr_b16 v[220:221], v12 offset:49152
    v_mul_f32 v132, v132, v116
    v_mfma_f32_16x16x32_bf16 v[176:179], v[208:211], a[116:119], v[176:179]
    s_add_u32 s70, s58, 1179648
    ds_read_b64_tr_b16 v[222:223], v12 offset:49664
    v_mul_f32 v133, v117, v133
    v_mfma_f32_16x16x32_bf16 v[180:183], v[204:207], a[176:179], v[180:183]
    buffer_load_dwordx4 v9, s[36:39], s70 offen offset:0 lds
    v_mul_f32 v117, v2, v117
    v_mfma_f32_16x16x32_bf16 v[180:183], v[208:211], a[180:183], v[180:183]
    s_add_u32 s71, s58, 1178624
    ds_read_b64_tr_b16 v[224:225], v12 offset:51200
    ds_read_b64_tr_b16 v[226:227], v12 offset:51712
    v_exp_f32 v117, v117
    v_mfma_f32_16x16x32_bf16 v[184:187], v[204:207], a[240:243], v[184:187]
    v_add_f32 v117, 1.0, v117
    v_fma_f32 v3, v118, v118, s64
    v_mfma_f32_16x16x32_bf16 v[184:187], v[208:211], a[244:247], v[184:187]
    v_rcp_f32 v117, v117
    v_mfma_f32_16x16x32_bf16 v[188:191], v[212:215], a[48:51], v[188:191]
    ds_read_b64_tr_b16 v[204:205], v12 offset:50176
    v_mul_f32 v133, v133, v117
    v_mfma_f32_16x16x32_bf16 v[188:191], v[216:219], a[52:55], v[188:191]
    ds_read_b64_tr_b16 v[206:207], v12 offset:50688
    v_mul_f32 v134, v118, v134
    v_mfma_f32_16x16x32_bf16 v[192:195], v[212:215], a[112:115], v[192:195]
    ds_read_b64_tr_b16 v[208:209], v12 offset:52224
    v_mul_f32 v118, v3, v118
    v_mfma_f32_16x16x32_bf16 v[192:195], v[216:219], a[116:119], v[192:195]
    buffer_load_dwordx4 v9, s[40:43], s71 offen offset:1024 lds
    v_exp_f32 v118, v118
    v_mfma_f32_16x16x32_bf16 v[196:199], v[212:215], a[176:179], v[196:199]
    s_add_u32 s72, s58, 1767424
    ds_read_b64_tr_b16 v[210:211], v12 offset:52736
    v_add_f32 v118, 1.0, v118
    v_mfma_f32_16x16x32_bf16 v[196:199], v[216:219], a[180:183], v[196:199]
    v_rcp_f32 v118, v118
    v_mfma_f32_16x16x32_bf16 v[200:203], v[212:215], a[240:243], v[200:203]
    v_mul_f32 v134, v134, v118
    s_waitcnt vmcnt(8)
    v_add_f32 v228, v228, v232
    v_mfma_f32_16x16x32_bf16 v[200:203], v[216:219], a[244:247], v[200:203]
    s_waitcnt lgkmcnt(4)
    v_fma_f32 v4, v119, v119, s64
    v_add_f32 v229, v229, v233
    v_mfma_f32_16x16x32_bf16 v[140:143], v[220:223], a[56:59], v[140:143]
    ds_read_b64_tr_b16 v[212:213], v13 offset:49152
    v_add_f32 v230, v230, v234
    v_mfma_f32_16x16x32_bf16 v[140:143], v[224:227], a[60:63], v[140:143]
    ds_read_b64_tr_b16 v[214:215], v13 offset:49664
    v_mul_f32 v135, v119, v135
    v_mfma_f32_16x16x32_bf16 v[144:147], v[220:223], a[120:123], v[144:147]
    buffer_load_dwordx4 v9, s[36:39], s72 offen offset:2048 lds
    v_mul_f32 v119, v4, v119
    v_mfma_f32_16x16x32_bf16 v[144:147], v[224:227], a[124:127], v[144:147]
    s_add_u32 s73, s58, 1766400
    ds_read_b64_tr_b16 v[216:217], v13 offset:51200
    v_exp_f32 v119, v119
    v_mfma_f32_16x16x32_bf16 v[148:151], v[220:223], a[184:187], v[148:151]
    ds_read_b64_tr_b16 v[218:219], v13 offset:51712
    v_add_f32 v119, 1.0, v119
    v_mfma_f32_16x16x32_bf16 v[148:151], v[224:227], a[188:191], v[148:151]
    v_rcp_f32 v119, v119
    v_mfma_f32_16x16x32_bf16 v[152:155], v[220:223], a[248:251], v[152:155]
    v_mul_f32 v135, v135, v119
    v_add_f32 v231, v231, v235
    v_mfma_f32_16x16x32_bf16 v[152:155], v[224:227], a[252:255], v[152:155]
    s_waitcnt lgkmcnt(4)
    v_cvt_pk_bf16_f32 v86, v132, v133
    v_cvt_pk_bf16_f32 v87, v134, v135
    v_mfma_f32_16x16x32_bf16 v[156:159], v[204:207], a[56:59], v[156:159]
    buffer_store_dwordx4 v[84:87], v19, s[48:51], s12 offen offset:0 sc1
    v_mfma_f32_16x16x32_bf16 v[156:159], v[208:211], a[60:63], v[156:159]
    buffer_load_dwordx4 v9, s[40:43], s73 offen offset:3072 lds
    v_fma_f32 v252, v88, v88, s64
    v_mul_f32 v104, v88, v104
    v_mfma_f32_16x16x32_bf16 v[160:163], v[204:207], a[120:123], v[160:163]
    ds_read_b64_tr_b16 v[220:221], v13 offset:50176
    ds_write_b128 v19, v[84:87] offset:32768
    v_mfma_f32_16x16x32_bf16 v[160:163], v[208:211], a[124:127], v[160:163]
    ds_read_b64_tr_b16 v[222:223], v13 offset:50688
    v_mul_f32 v88, v252, v88
    v_mfma_f32_16x16x32_bf16 v[164:167], v[204:207], a[184:187], v[164:167]
    ds_read_b64_tr_b16 v[224:225], v13 offset:52224
    v_exp_f32 v88, v88
    v_mfma_f32_16x16x32_bf16 v[164:167], v[208:211], a[188:191], v[164:167]
    ds_read_b64_tr_b16 v[226:227], v13 offset:52736
    v_add_f32 v88, 1.0, v88
    v_mfma_f32_16x16x32_bf16 v[168:171], v[204:207], a[248:251], v[168:171]
    v_rcp_f32 v88, v88
    v_mfma_f32_16x16x32_bf16 v[168:171], v[208:211], a[252:255], v[168:171]
    s_waitcnt lgkmcnt(5)
    v_mul_f32 v104, v104, v88
    v_fma_f32 v1, v89, v89, s64
    v_mfma_f32_16x16x32_bf16 v[172:175], v[212:215], a[56:59], v[172:175]
    v_mul_f32 v105, v89, v105
    v_mul_f32 v89, v1, v89
    v_mfma_f32_16x16x32_bf16 v[172:175], v[216:219], a[60:63], v[172:175]
    v_exp_f32 v89, v89
    v_mfma_f32_16x16x32_bf16 v[176:179], v[212:215], a[120:123], v[176:179]
    s_waitcnt lgkmcnt(0)
    s_barrier
    v_mfma_f32_16x16x32_bf16 v[176:179], v[216:219], a[124:127], v[176:179]
    s_add_u32 m0, s55, 49152
    ds_read_b64_tr_b16 v[204:205], v12 offset:0
    v_add_f32 v89, 1.0, v89
    v_mfma_f32_16x16x32_bf16 v[180:183], v[212:215], a[184:187], v[180:183]
    s_add_u32 s70, s58, 2359296
    ds_read_b64_tr_b16 v[206:207], v12 offset:512
    v_rcp_f32 v89, v89
    v_mfma_f32_16x16x32_bf16 v[180:183], v[216:219], a[188:191], v[180:183]
    buffer_load_dwordx4 v9, s[36:39], s70 offen offset:0 lds
    v_mul_f32 v105, v105, v89
    v_mfma_f32_16x16x32_bf16 v[184:187], v[212:215], a[248:251], v[184:187]
    s_add_u32 s71, s58, 2358272
    ds_read_b64_tr_b16 v[208:209], v12 offset:2048
    ds_read_b64_tr_b16 v[210:211], v12 offset:2560
    v_fma_f32 v2, v90, v90, s64
    v_mfma_f32_16x16x32_bf16 v[184:187], v[216:219], a[252:255], v[184:187]
    v_mul_f32 v106, v90, v106
    v_mul_f32 v90, v2, v90
    v_mfma_f32_16x16x32_bf16 v[188:191], v[220:223], a[56:59], v[188:191]
    ds_read_b64_tr_b16 v[212:213], v12 offset:1024
    v_exp_f32 v90, v90
    v_mfma_f32_16x16x32_bf16 v[188:191], v[224:227], a[60:63], v[188:191]
    ds_read_b64_tr_b16 v[214:215], v12 offset:1536
    v_add_f32 v90, 1.0, v90
    v_mfma_f32_16x16x32_bf16 v[192:195], v[220:223], a[120:123], v[192:195]
    ds_read_b64_tr_b16 v[216:217], v12 offset:3072
    v_rcp_f32 v90, v90
    v_mfma_f32_16x16x32_bf16 v[192:195], v[224:227], a[124:127], v[192:195]
    ds_read_b64_tr_b16 v[218:219], v12 offset:3584
    v_mul_f32 v106, v106, v90
    v_mfma_f32_16x16x32_bf16 v[196:199], v[220:223], a[184:187], v[196:199]
    buffer_load_dwordx4 v9, s[40:43], s71 offen offset:1024 lds
    v_fma_f32 v3, v91, v91, s64
    v_mfma_f32_16x16x32_bf16 v[196:199], v[224:227], a[188:191], v[196:199]
    s_add_u32 s72, s58, 2947072
    v_mul_f32 v107, v91, v107
    v_mul_f32 v91, v3, v91
    v_mfma_f32_16x16x32_bf16 v[200:203], v[220:223], a[248:251], v[200:203]
    v_exp_f32 v91, v91
    v_mfma_f32_16x16x32_bf16 v[200:203], v[224:227], a[252:255], v[200:203]
    s_waitcnt lgkmcnt(4)
    v_add_f32 v91, 1.0, v91
    s_waitcnt vmcnt(8)
    v_add_f32 v236, v236, v240
    v_mfma_f32_16x16x32_bf16 v[140:143], v[204:207], v[44:47], v[140:143]
    ds_read_b64_tr_b16 v[220:221], v13 offset:0
    v_add_f32 v237, v237, v241
    v_mfma_f32_16x16x32_bf16 v[140:143], v[208:211], v[48:51], v[140:143]
    ds_read_b64_tr_b16 v[222:223], v13 offset:512
    v_rcp_f32 v91, v91
    v_mfma_f32_16x16x32_bf16 v[144:147], v[204:207], v[52:55], v[144:147]
    ds_read_b64_tr_b16 v[224:225], v13 offset:2048
    v_mul_f32 v107, v107, v91
    v_mfma_f32_16x16x32_bf16 v[144:147], v[208:211], v[56:59], v[144:147]
    buffer_load_dwordx4 v9, s[36:39], s72 offen offset:2048 lds
    v_cvt_pk_bf16_f32 v88, v104, v105
    v_mfma_f32_16x16x32_bf16 v[148:151], v[204:207], v[60:63], v[148:151]
    s_add_u32 s73, s58, 2946048
    ds_read_b64_tr_b16 v[226:227], v13 offset:2560
    v_cvt_pk_bf16_f32 v89, v106, v107
    v_fma_f32 v4, v120, v120, s64
    v_mfma_f32_16x16x32_bf16 v[148:151], v[208:211], v[64:67], v[148:151]
    v_mul_f32 v136, v120, v136
    v_add_f32 v238, v238, v242
    v_mfma_f32_16x16x32_bf16 v[152:155], v[204:207], v[68:71], v[152:155]
    v_mul_f32 v120, v4, v120
    v_add_f32 v239, v239, v243
    v_mfma_f32_16x16x32_bf16 v[152:155], v[208:211], v[72:75], v[152:155]
    s_waitcnt lgkmcnt(4)
    v_exp_f32 v120, v120
    v_mfma_f32_16x16x32_bf16 v[156:159], v[212:215], v[44:47], v[156:159]
    ds_read_b64_tr_b16 v[204:205], v13 offset:1024
    v_add_f32 v228, v228, v236
    v_mfma_f32_16x16x32_bf16 v[156:159], v[216:219], v[48:51], v[156:159]
    ds_read_b64_tr_b16 v[206:207], v13 offset:1536
    v_add_f32 v120, 1.0, v120
    v_mfma_f32_16x16x32_bf16 v[160:163], v[212:215], v[52:55], v[160:163]
    buffer_load_dwordx4 v9, s[40:43], s73 offen offset:3072 lds
    v_rcp_f32 v120, v120
    v_mfma_f32_16x16x32_bf16 v[160:163], v[216:219], v[56:59], v[160:163]
    ds_read_b64_tr_b16 v[208:209], v13 offset:3072
    v_mul_f32 v136, v136, v120
    v_mfma_f32_16x16x32_bf16 v[164:167], v[212:215], v[60:63], v[164:167]
    ds_read_b64_tr_b16 v[210:211], v13 offset:3584
    v_fma_f32 v252, v121, v121, s64
    v_mul_f32 v137, v121, v137
    v_mfma_f32_16x16x32_bf16 v[164:167], v[216:219], v[64:67], v[164:167]
    v_mul_f32 v121, v252, v121
    v_fma_f32 v1, v122, v122, s64
    v_mfma_f32_16x16x32_bf16 v[168:171], v[212:215], v[68:71], v[168:171]
    v_exp_f32 v121, v121
    v_mfma_f32_16x16x32_bf16 v[168:171], v[216:219], v[72:75], v[168:171]
    s_waitcnt lgkmcnt(4)
    v_add_f32 v121, 1.0, v121
    v_add_f32 v244, v244, v228
    v_mfma_f32_16x16x32_bf16 v[172:175], v[220:223], v[44:47], v[172:175]
    v_rcp_f32 v121, v121
    v_mfma_f32_16x16x32_bf16 v[172:175], v[224:227], v[48:51], v[172:175]
    s_waitcnt vmcnt(9) lgkmcnt(0)
    s_barrier
    v_mul_f32 v137, v137, v121
    v_mfma_f32_16x16x32_bf16 v[176:179], v[220:223], v[52:55], v[176:179]
    s_add_u32 m0, s55, 0
    ds_read_b64_tr_b16 v[212:213], v14 offset:16384
    v_mul_f32 v138, v122, v138
    v_mfma_f32_16x16x32_bf16 v[176:179], v[224:227], v[56:59], v[176:179]
    s_add_u32 s70, s58, 3538944
    ds_read_b64_tr_b16 v[214:215], v14 offset:16640
    v_mul_f32 v122, v1, v122
    v_fma_f32 v2, v123, v123, s64
    v_mfma_f32_16x16x32_bf16 v[180:183], v[220:223], v[60:63], v[180:183]
    buffer_load_dwordx4 v9, s[36:39], s70 offen offset:0 lds
    v_exp_f32 v122, v122
    v_mfma_f32_16x16x32_bf16 v[180:183], v[224:227], v[64:67], v[180:183]
    s_add_u32 s71, s58, 3537920
    ds_read_b64_tr_b16 v[216:217], v14 offset:24576
    ds_read_b64_tr_b16 v[218:219], v14 offset:24832
    v_add_f32 v122, 1.0, v122
    v_mul_f32 v139, v123, v139
    v_mfma_f32_16x16x32_bf16 v[184:187], v[220:223], v[68:71], v[184:187]
    v_rcp_f32 v122, v122
    v_mfma_f32_16x16x32_bf16 v[184:187], v[224:227], v[72:75], v[184:187]
    v_mul_f32 v138, v138, v122
    v_add_f32 v229, v229, v237
    v_mfma_f32_16x16x32_bf16 v[188:191], v[204:207], v[44:47], v[188:191]
    ds_read_b64_tr_b16 v[220:221], v14 offset:17408
    v_mul_f32 v123, v2, v123
    v_mfma_f32_16x16x32_bf16 v[188:191], v[208:211], v[48:51], v[188:191]
    ds_read_b64_tr_b16 v[222:223], v14 offset:17664
    v_exp_f32 v123, v123
    v_mfma_f32_16x16x32_bf16 v[192:195], v[204:207], v[52:55], v[192:195]
    ds_read_b64_tr_b16 v[224:225], v14 offset:25600
    v_add_f32 v123, 1.0, v123
    v_cvt_pk_bf16_f32 v90, v136, v137
    v_mfma_f32_16x16x32_bf16 v[192:195], v[208:211], v[56:59], v[192:195]
    buffer_load_dwordx4 v9, s[40:43], s71 offen offset:1024 lds
    v_rcp_f32 v123, v123
    v_mfma_f32_16x16x32_bf16 v[196:199], v[204:207], v[60:63], v[196:199]
    s_add_u32 s72, s58, 4126720
    ds_read_b64_tr_b16 v[226:227], v14 offset:25856
    v_mul_f32 v139, v139, v123
    v_mfma_f32_16x16x32_bf16 v[196:199], v[208:211], v[64:67], v[196:199]
    v_cvt_pk_bf16_f32 v91, v138, v139
    v_add_f32 v245, v245, v229
    v_mfma_f32_16x16x32_bf16 v[200:203], v[204:207], v[68:71], v[200:203]
    buffer_store_dwordx4 v[88:91], v19, s[48:51], s12 offen offset:1024 sc1
    v_mfma_f32_16x16x32_bf16 v[200:203], v[208:211], v[72:75], v[200:203]
    s_waitcnt lgkmcnt(4)
    ds_write_b128 v19, v[88:91] offset:33792
    s_and_b32 s3, s52, 1
    s_lshl_b32 s56, s3, 13
    s_lshl_b32 s3, s3, 3
    v_subrev_u32 v12, s56, v18
    v_add_u32 v6, 65536, v12
    v_add_u32 v8, s3, v6
    v_subrev_u32 v13, s56, v19
    v_add_u32 v7, 65536, v13
    v_add_u32 v11, s3, v7
    v_mfma_f32_16x16x32_bf16 v[76:79], v[212:215], a[0:3], 0
    ds_read_b64_tr_b16 v[204:205], v14 offset:18432
    v_add_f32 v230, v230, v238
    v_mfma_f32_16x16x32_bf16 v[76:79], v[216:219], a[4:7], v[76:79]
    s_add_u32 s12, s12, 16384
    ds_read_b64_tr_b16 v[206:207], v14 offset:18688
    v_add_f32 v246, v246, v230
    v_mfma_f32_16x16x32_bf16 v[80:83], v[212:215], a[64:67], 0
    buffer_load_dwordx4 v9, s[36:39], s72 offen offset:2048 lds
    v_add_f32 v231, v231, v239
    v_and_b32 v244, v244, v30
    v_mfma_f32_16x16x32_bf16 v[80:83], v[216:219], a[68:71], v[80:83]
    s_add_u32 s73, s58, 4125696
    ds_read_b64_tr_b16 v[208:209], v14 offset:26624
    v_add_f32 v247, v247, v231
    v_and_b32 v245, v245, v30
    v_mfma_f32_16x16x32_bf16 v[84:87], v[212:215], a[128:131], 0
    ds_read_b64_tr_b16 v[210:211], v14 offset:26880
    v_and_b32 v246, v246, v31
    v_and_b32 v247, v247, v31
    v_mfma_f32_16x16x32_bf16 v[84:87], v[216:219], a[132:135], v[84:87]
    ds_write_b128 v248, v[244:247]
    v_mfma_f32_16x16x32_bf16 v[88:91], v[212:215], a[192:195], 0
    v_fma_f32 v1, v140, v140, s64
    v_mul_f32 v156, v140, v156
    v_mfma_f32_16x16x32_bf16 v[88:91], v[216:219], a[196:199], v[88:91]
    s_waitcnt lgkmcnt(6)
    v_mul_f32 v140, v1, v140
    v_fma_f32 v2, v141, v141, s64
    v_mfma_f32_16x16x32_bf16 v[92:95], v[220:223], a[0:3], 0
    ds_read_b64_tr_b16 v[212:213], v14 offset:19456
    v_exp_f32 v140, v140
    v_mfma_f32_16x16x32_bf16 v[92:95], v[224:227], a[4:7], v[92:95]
    buffer_load_dwordx4 v9, s[40:43], s73 offen offset:3072 lds
    v_add_f32 v140, 1.0, v140
    v_mfma_f32_16x16x32_bf16 v[96:99], v[220:223], a[64:67], 0
    ds_read_b64_tr_b16 v[214:215], v14 offset:19712
    v_rcp_f32 v140, v140
    v_mfma_f32_16x16x32_bf16 v[96:99], v[224:227], a[68:71], v[96:99]
    ds_read_b64_tr_b16 v[216:217], v14 offset:27648
    v_mul_f32 v156, v156, v140
    v_mfma_f32_16x16x32_bf16 v[100:103], v[220:223], a[128:131], 0
    ds_read_b64_tr_b16 v[218:219], v14 offset:27904
    v_mul_f32 v157, v141, v157
    v_mul_f32 v141, v2, v141
    v_mfma_f32_16x16x32_bf16 v[100:103], v[224:227], a[132:135], v[100:103]
    v_exp_f32 v141, v141
    v_mfma_f32_16x16x32_bf16 v[104:107], v[220:223], a[192:195], 0
    v_add_f32 v141, 1.0, v141
    v_fma_f32 v3, v142, v142, s64
    v_mfma_f32_16x16x32_bf16 v[104:107], v[224:227], a[196:199], v[104:107]
    s_waitcnt lgkmcnt(5)
    v_rcp_f32 v141, v141
    v_mfma_f32_16x16x32_bf16 v[76:79], v[204:207], a[8:11], v[76:79]
    v_mul_f32 v157, v157, v141
    v_mul_f32 v158, v142, v158
    v_mfma_f32_16x16x32_bf16 v[76:79], v[208:211], a[12:15], v[76:79]
    s_waitcnt vmcnt(9) lgkmcnt(0)
    s_barrier
    v_mul_f32 v142, v3, v142
    v_mfma_f32_16x16x32_bf16 v[80:83], v[204:207], a[72:75], v[80:83]
    s_add_u32 m0, s55, 16384
    ds_read_b64_tr_b16 v[220:221], v14 offset:32768
    ds_read_b128 v[228:231], v20
    v_mfma_f32_16x16x32_bf16 v[80:83], v[208:211], a[76:79], v[80:83]
    s_add_u32 s70, s58, 4718592
    ds_read_b64_tr_b16 v[222:223], v14 offset:33024
    ds_read_b128 v[232:235], v21
    ds_read_b128 v[236:239], v22
    v_mfma_f32_16x16x32_bf16 v[84:87], v[204:207], a[136:139], v[84:87]
    buffer_load_dwordx4 v9, s[36:39], s70 offen offset:0 lds
    v_exp_f32 v142, v142
    v_mfma_f32_16x16x32_bf16 v[84:87], v[208:211], a[140:143], v[84:87]
    s_add_u32 s71, s58, 4717568
    ds_read_b64_tr_b16 v[224:225], v14 offset:40960
    ds_read_b64_tr_b16 v[226:227], v14 offset:41216
    v_add_f32 v142, 1.0, v142
    v_fma_f32 v4, v143, v143, s64
    v_mfma_f32_16x16x32_bf16 v[88:91], v[204:207], a[200:203], v[88:91]
    v_rcp_f32 v142, v142
    v_mfma_f32_16x16x32_bf16 v[88:91], v[208:211], a[204:207], v[88:91]
    s_waitcnt lgkmcnt(5)
    v_cvt_pk_bf16_f32 v228, v228, v229
    v_cvt_pk_bf16_f32 v229, v230, v231
    v_mfma_f32_16x16x32_bf16 v[92:95], v[212:215], a[8:11], v[92:95]
    ds_read_b64_tr_b16 v[204:205], v14 offset:33792
    s_waitcnt lgkmcnt(4)
    v_cvt_pk_bf16_f32 v230, v232, v233
    v_mfma_f32_16x16x32_bf16 v[92:95], v[216:219], a[12:15], v[92:95]
    ds_read_b64_tr_b16 v[206:207], v14 offset:34048
    v_cvt_pk_bf16_f32 v231, v234, v235
    s_waitcnt lgkmcnt(4)
    v_cvt_pk_bf16_f32 v236, v236, v237
    v_mfma_f32_16x16x32_bf16 v[96:99], v[212:215], a[72:75], v[96:99]
    ds_read_b64_tr_b16 v[208:209], v14 offset:41984
    v_cvt_pk_bf16_f32 v237, v238, v239
    v_mfma_f32_16x16x32_bf16 v[96:99], v[216:219], a[76:79], v[96:99]
    buffer_load_dwordx4 v9, s[40:43], s71 offen offset:1024 lds
    v_mfma_f32_16x16x32_bf16 v[240:243], v[228:231], v[34:37], 0
    v_mfma_f32_16x16x32_bf16 v[100:103], v[212:215], a[136:139], v[100:103]
    ds_read_b64_tr_b16 v[210:211], v14 offset:42240
    v_mfma_f32_16x16x32_bf16 v[244:247], v[228:231], v[40:43], 0
    v_mfma_f32_16x16x32_bf16 v[100:103], v[216:219], a[140:143], v[100:103]
    s_nop 1
    v_mfma_f32_16x16x16_bf16 v[240:243], v[236:237], v[32:33], v[240:243]
    v_mfma_f32_16x16x32_bf16 v[104:107], v[212:215], a[200:203], v[104:107]
    s_nop 0
    v_mfma_f32_16x16x16_bf16 v[244:247], v[236:237], v[38:39], v[244:247]
    v_mfma_f32_16x16x32_bf16 v[104:107], v[216:219], a[204:207], v[104:107]
    s_waitcnt lgkmcnt(4)
    ds_read_b128 v[228:231], v23
    ds_read_b128 v[232:235], v24
    v_mfma_f32_16x16x32_bf16 v[76:79], v[220:223], a[16:19], v[76:79]
    s_waitcnt vmcnt(4)
    ds_read_b64_tr_b16 v[212:213], v14 offset:34816
    ds_read_b128 a[0:3], v12 offset:0
    ds_read_b128 a[64:67], v12 offset:1024
    ds_read_b128 a[128:131], v13 offset:0
    ds_read_b128 a[192:195], v13 offset:1024
    ds_read_b128 a[4:7], v12 offset:8192
    v_mfma_f32_16x16x32_bf16 v[76:79], v[224:227], a[20:23], v[76:79]
    buffer_store_dword v255, off, s[48:51], s17 sc1
    v_add_f32 v248, s68, v240
    v_add_f32 v249, s68, v241
    v_rcp_f32 v248, v248
    v_mfma_f32_16x16x32_bf16 v[80:83], v[220:223], a[80:83], v[80:83]
    ds_read_b64_tr_b16 v[214:215], v14 offset:35072
    ds_read_b128 a[68:71], v12 offset:9216
    v_mfma_f32_16x16x32_bf16 v[80:83], v[224:227], a[84:87], v[80:83]
    ds_read_b64_tr_b16 v[216:217], v14 offset:43008
    ds_read_b128 a[132:135], v13 offset:8192
    ds_read_b128 a[196:199], v13 offset:9216
    ds_read_b128 a[8:11], v12 offset:16384
    ds_read_b128 a[72:75], v12 offset:17408
    ds_read_b128 a[136:139], v13 offset:16384
    v_mfma_f32_16x16x32_bf16 v[84:87], v[220:223], a[144:147], v[84:87]
    ds_read_b64_tr_b16 v[218:219], v14 offset:43264
    ds_read_b128 a[200:203], v13 offset:17408
    ds_read_b128 a[12:15], v12 offset:24576
    ds_read_b128 a[76:79], v12 offset:25600
    ds_read_b128 a[140:143], v13 offset:24576
    ds_read_b128 a[204:207], v13 offset:25600
    v_mfma_f32_16x16x32_bf16 v[84:87], v[224:227], a[148:151], v[84:87]
    v_rcp_f32 v249, v249
    v_mul_f32 v248, s69, v248
    v_mul_f32 v249, s69, v249
    v_mfma_f32_16x16x32_bf16 v[88:91], v[220:223], a[208:211], v[88:91]
    v_add_f32 v250, s68, v244
    v_add_f32 v251, s68, v245
    v_mfma_f32_16x16x32_bf16 v[88:91], v[224:227], a[212:215], v[88:91]
    s_waitcnt lgkmcnt(15)
    v_rcp_f32 v250, v250
    v_mfma_f32_16x16x32_bf16 v[92:95], v[204:207], a[16:19], v[92:95]
    ds_read_b64_tr_b16 v[220:221], v14 offset:35840
    v_mul_f32 v250, s69, v250
    v_mfma_f32_16x16x32_bf16 v[92:95], v[208:211], a[20:23], v[92:95]
    ds_read_b64_tr_b16 v[222:223], v14 offset:36096
    v_rcp_f32 v251, v251
    v_mfma_f32_16x16x32_bf16 v[96:99], v[204:207], a[80:83], v[96:99]
    ds_read_b64_tr_b16 v[224:225], v14 offset:44032
    v_mul_f32 v251, s69, v251
    v_mfma_f32_16x16x32_bf16 v[96:99], v[208:211], a[84:87], v[96:99]
    ds_read_b64_tr_b16 v[226:227], v14 offset:44288
    v_cvt_pk_bf16_f32 v228, v228, v229
    v_cvt_pk_bf16_f32 v229, v230, v231
    v_mfma_f32_16x16x32_bf16 v[100:103], v[204:207], a[144:147], v[100:103]
    v_cvt_pk_bf16_f32 v230, v232, v233
    v_cvt_pk_bf16_f32 v231, v234, v235
    v_mfma_f32_16x16x32_bf16 v[100:103], v[208:211], a[148:151], v[100:103]
    s_nop 0
    v_mfma_f32_16x16x32_bf16 v[240:243], v[228:231], v[34:37], 0
    v_mfma_f32_16x16x32_bf16 v[104:107], v[204:207], a[208:211], v[104:107]
    v_mfma_f32_16x16x32_bf16 v[244:247], v[228:231], v[40:43], 0
    v_mfma_f32_16x16x32_bf16 v[104:107], v[208:211], a[212:215], v[104:107]
    s_waitcnt lgkmcnt(9)
    v_mul_f32 v158, v158, v142
    s_nop 2
    v_mul_f32 v240, v240, v248
    v_mfma_f32_16x16x32_bf16 v[76:79], v[212:215], a[24:27], v[76:79]
    s_waitcnt lgkmcnt(0)
    s_barrier
    v_mul_f32 v241, v241, v248
    v_mfma_f32_16x16x32_bf16 v[76:79], v[216:219], a[28:31], v[76:79]
    s_lshl_b32 s3, s52, 11
    ds_read_b64_tr_b16 v[204:205], v14 offset:49152
    v_mul_f32 v242, v242, v248
    v_mul_f32 v243, v243, v248
    v_mfma_f32_16x16x32_bf16 v[80:83], v[212:215], a[88:91], v[80:83]
    s_add_u32 s56, s3, 65536
    ds_read_b64_tr_b16 v[206:207], v14 offset:49408
    v_cvt_pk_bf16_f32 v240, v240, v241
    v_mfma_f32_16x16x32_bf16 v[80:83], v[216:219], a[92:95], v[80:83]
    s_add_u32 s3, s14, 0
    ds_read_b64_tr_b16 v[208:209], v14 offset:57344
    v_cvt_pk_bf16_f32 v241, v242, v243
    v_mul_f32 v244, v244, v250
    v_mfma_f32_16x16x32_bf16 v[84:87], v[212:215], a[152:155], v[84:87]
    s_mov_b32 m0, s56
    ds_read_b64_tr_b16 v[210:211], v14 offset:57600
    ds_write_b64 v5, v[240:241] offset:0
    v_mfma_f32_16x16x32_bf16 v[84:87], v[216:219], a[156:159], v[84:87]
    buffer_load_dwordx4 v12, s[48:51], s3 offen offset:0 sc1 lds
    v_mul_f32 v245, v245, v250
    v_mul_f32 v246, v246, v250
    v_mfma_f32_16x16x32_bf16 v[88:91], v[212:215], a[216:219], v[88:91]
    v_mul_f32 v247, v247, v250
    v_cvt_pk_bf16_f32 v244, v244, v245
    v_mfma_f32_16x16x32_bf16 v[88:91], v[216:219], a[220:223], v[88:91]
    v_cvt_pk_bf16_f32 v245, v246, v247
    v_mul_f32 v159, v143, v159
    v_mfma_f32_16x16x32_bf16 v[92:95], v[220:223], a[24:27], v[92:95]
    ds_read_b64_tr_b16 v[212:213], v14 offset:50176
    ds_write_b64 v5, v[244:245] offset:1024
    v_mfma_f32_16x16x32_bf16 v[92:95], v[224:227], a[28:31], v[92:95]
    buffer_load_dwordx4 v12, s[48:51], s3 offen offset:1024 sc1 lds
    v_mul_f32 v143, v4, v143
    v_mfma_f32_16x16x32_bf16 v[96:99], v[220:223], a[88:91], v[96:99]
    s_add_u32 m0, s55, 32768
    ds_read_b64_tr_b16 v[214:215], v14 offset:50432
    ds_read_b128 v[228:231], v25
    ds_read_b128 v[232:235], v26
    v_mfma_f32_16x16x32_bf16 v[96:99], v[224:227], a[92:95], v[96:99]
    s_add_u32 s70, s59, 0
    ds_read_b64_tr_b16 v[216:217], v14 offset:58368
    ds_read_b128 v[236:239], v27
    v_mfma_f32_16x16x32_bf16 v[100:103], v[220:223], a[152:155], v[100:103]
    s_add_u32 s70, s70, s11
    ds_read_b64_tr_b16 v[218:219], v14 offset:58624
    v_exp_f32 v143, v143
    v_mfma_f32_16x16x32_bf16 v[100:103], v[224:227], a[156:159], v[100:103]
    buffer_load_dword v254, v253, s[48:51], s15 offen sc1
    v_add_f32 v143, 1.0, v143
    v_cvt_pk_bf16_f32 v140, v156, v157
    v_mfma_f32_16x16x32_bf16 v[104:107], v[220:223], a[216:219], v[104:107]
    buffer_load_dwordx4 v10, s[44:47], s70 offen offset:0 lds
    v_rcp_f32 v143, v143
    v_mfma_f32_16x16x32_bf16 v[104:107], v[224:227], a[220:223], v[104:107]
    s_waitcnt lgkmcnt(9)
    s_waitcnt lgkmcnt(4)
    v_cvt_pk_bf16_f32 v228, v228, v229
    v_cvt_pk_bf16_f32 v229, v230, v231
    v_mfma_f32_16x16x32_bf16 v[76:79], v[204:207], a[32:35], v[76:79]
    s_add_u32 s71, s59, 35840
    ds_read_b64_tr_b16 v[220:221], v14 offset:51200
    ds_read_b128 a[16:19], v12 offset:32768
    ds_read_b128 a[80:83], v12 offset:33792
    ds_read_b128 a[144:147], v13 offset:32768
    ds_read_b128 a[208:211], v13 offset:33792
    ds_read_b128 a[20:23], v12 offset:40960
    v_mfma_f32_16x16x32_bf16 v[76:79], v[208:211], a[36:39], v[76:79]
    s_add_u32 s71, s71, s11
    ds_read_b64_tr_b16 v[222:223], v14 offset:51456
    ds_read_b128 a[84:87], v12 offset:41984
    ds_read_b128 a[148:151], v13 offset:40960
    ds_read_b128 a[212:215], v13 offset:41984
    s_waitcnt lgkmcnt(13)
    v_cvt_pk_bf16_f32 v230, v232, v233
    v_cvt_pk_bf16_f32 v231, v234, v235
    v_mfma_f32_16x16x32_bf16 v[80:83], v[204:207], a[96:99], v[80:83]
    buffer_load_dwordx4 v10, s[44:47], s71 offen offset:1024 lds
    s_waitcnt lgkmcnt(11)
    v_cvt_pk_bf16_f32 v236, v236, v237
    v_cvt_pk_bf16_f32 v237, v238, v239
    v_mfma_f32_16x16x32_bf16 v[240:243], v[228:231], v[34:37], 0
    v_mfma_f32_16x16x32_bf16 v[80:83], v[208:211], a[100:103], v[80:83]
    s_add_u32 s72, s59, 71680
    ds_read_b64_tr_b16 v[224:225], v14 offset:59392
    v_mfma_f32_16x16x32_bf16 v[244:247], v[228:231], v[40:43], 0
    v_mfma_f32_16x16x32_bf16 v[84:87], v[204:207], a[160:163], v[84:87]
    s_add_u32 s72, s72, s11
    ds_read_b64_tr_b16 v[226:227], v14 offset:59648
    v_cndmask_b32 v238, v249, v248, s[78:79]
    v_mfma_f32_16x16x32_bf16 v[84:87], v[208:211], a[164:167], v[84:87]
    v_mfma_f32_16x16x16_bf16 v[240:243], v[236:237], v[32:33], v[240:243]
    v_mfma_f32_16x16x32_bf16 v[88:91], v[204:207], a[224:227], v[88:91]
    buffer_load_dwordx4 v10, s[44:47], s72 offen offset:2048 lds
    v_mfma_f32_16x16x16_bf16 v[244:247], v[236:237], v[38:39], v[244:247]
    v_mfma_f32_16x16x32_bf16 v[88:91], v[208:211], a[228:231], v[88:91]
    s_waitcnt lgkmcnt(12)
    s_nop 2
    v_mul_f32 v240, v240, v238
    v_mul_f32 v241, v241, v238
    v_mfma_f32_16x16x32_bf16 v[92:95], v[212:215], a[32:35], v[92:95]
    s_add_u32 s73, s59, 107520
    ds_read_b64_tr_b16 v[204:205], v14 offset:52224
    v_mul_f32 v242, v242, v249
    v_mfma_f32_16x16x32_bf16 v[92:95], v[216:219], a[36:39], v[92:95]
    s_add_u32 s73, s73, s11
    ds_read_b64_tr_b16 v[206:207], v14 offset:52480
    v_mul_f32 v159, v159, v143
    v_mfma_f32_16x16x32_bf16 v[96:99], v[212:215], a[96:99], v[96:99]
    buffer_load_dwordx4 v10, s[44:47], s73 offen offset:3072 lds
    v_cvt_pk_bf16_f32 v141, v158, v159
    v_fma_f32 v252, v172, v172, s64
    v_mfma_f32_16x16x32_bf16 v[96:99], v[216:219], a[100:103], v[96:99]
    s_lshl_b32 s3, s52, 11
    ds_read_b64_tr_b16 v[208:209], v14 offset:60416
    v_mul_f32 v188, v172, v188
    v_mul_f32 v172, v252, v172
    v_mfma_f32_16x16x32_bf16 v[100:103], v[212:215], a[160:163], v[100:103]
    s_add_u32 s56, s3, 73728
L_pad8:
    s_cbranch_execz L_pad10
    ds_read_b64_tr_b16 v[210:211], v14 offset:60672
    v_exp_f32 v172, v172
    v_mfma_f32_16x16x32_bf16 v[100:103], v[216:219], a[164:167], v[100:103]
    s_add_u32 s3, s14, 8192
    v_add_f32 v172, 1.0, v172
    v_mul_f32 v243, v243, v249
    v_mfma_f32_16x16x32_bf16 v[104:107], v[212:215], a[224:227], v[104:107]
    s_mov_b32 m0, s56
    v_rcp_f32 v172, v172
    v_mfma_f32_16x16x32_bf16 v[104:107], v[216:219], a[228:231], v[104:107]
    s_waitcnt lgkmcnt(4)
    v_mul_f32 v188, v188, v172
    v_cvt_pk_bf16_f32 v240, v240, v241
    v_mfma_f32_16x16x32_bf16 v[76:79], v[220:223], a[40:43], v[76:79]
    buffer_load_dwordx4 v12, s[48:51], s3 offen offset:0 sc1 lds
    v_fma_f32 v1, v173, v173, s64
    v_mfma_f32_16x16x32_bf16 v[76:79], v[224:227], a[44:47], v[76:79]
    s_waitcnt vmcnt(11) lgkmcnt(0)
    s_barrier
    v_mul_f32 v189, v173, v189
    v_mfma_f32_16x16x32_bf16 v[80:83], v[220:223], a[104:107], v[80:83]
    ds_read_b64_tr_b16 v[212:213], v14 offset:0
    v_mul_f32 v173, v1, v173
    v_fma_f32 v2, v174, v174, s64
    v_mfma_f32_16x16x32_bf16 v[80:83], v[224:227], a[108:111], v[80:83]
    ds_read_b64_tr_b16 v[214:215], v14 offset:256
    v_exp_f32 v173, v173
    v_mfma_f32_16x16x32_bf16 v[84:87], v[220:223], a[168:171], v[84:87]
    ds_read_b64_tr_b16 v[216:217], v14 offset:8192
    v_add_f32 v173, 1.0, v173
    v_mul_f32 v190, v174, v190
    v_mfma_f32_16x16x32_bf16 v[84:87], v[224:227], a[172:175], v[84:87]
    buffer_load_dwordx4 v12, s[48:51], s3 offen offset:1024 sc1 lds
    v_rcp_f32 v173, v173
    v_mfma_f32_16x16x32_bf16 v[88:91], v[220:223], a[232:235], v[88:91]
    s_add_u32 m0, s55, 49152
    ds_read_b64_tr_b16 v[218:219], v14 offset:8448
    v_mul_f32 v189, v189, v173
    v_mfma_f32_16x16x32_bf16 v[88:91], v[224:227], a[236:239], v[88:91]
    v_mul_f32 v174, v2, v174
    v_fma_f32 v3, v175, v175, s64
    v_mfma_f32_16x16x32_bf16 v[92:95], v[204:207], a[40:43], v[92:95]
    s_add_u32 s70, s59, 147456
    ds_read_b64_tr_b16 v[220:221], v14 offset:1024
    v_exp_f32 v174, v174
    v_mfma_f32_16x16x32_bf16 v[92:95], v[208:211], a[44:47], v[92:95]
    s_add_u32 s70, s70, s11
    ds_read_b64_tr_b16 v[222:223], v14 offset:1280
    v_add_f32 v174, 1.0, v174
    v_mul_f32 v191, v175, v191
    v_mfma_f32_16x16x32_bf16 v[96:99], v[204:207], a[104:107], v[96:99]
    buffer_load_dwordx4 v10, s[44:47], s70 offen offset:0 lds
    v_rcp_f32 v174, v174
    v_mfma_f32_16x16x32_bf16 v[96:99], v[208:211], a[108:111], v[96:99]
    s_add_u32 s71, s59, 183296
    ds_read_b64_tr_b16 v[224:225], v14 offset:9216
    v_mul_f32 v190, v190, v174
    v_mfma_f32_16x16x32_bf16 v[100:103], v[204:207], a[168:171], v[100:103]
    s_add_u32 s71, s71, s11
    ds_read_b64_tr_b16 v[226:227], v14 offset:9472
    v_mul_f32 v175, v3, v175
    v_cvt_pk_bf16_f32 v142, v188, v189
    v_mfma_f32_16x16x32_bf16 v[100:103], v[208:211], a[172:175], v[100:103]
    s_waitcnt vmcnt(7)
    v_cmp_gt_u32 vcc, 3, v254
    s_nop 0
    s_cbranch_vccnz L_sp_ha2
L_bk_ha2:
    v_exp_f32 v175, v175
    v_mfma_f32_16x16x32_bf16 v[104:107], v[204:207], a[232:235], v[104:107]
    v_add_f32 v175, 1.0, v175
    v_fma_f32 v4, v144, v144, s64
    v_mfma_f32_16x16x32_bf16 v[104:107], v[208:211], a[236:239], v[104:107]
    s_waitcnt lgkmcnt(4)
    v_rcp_f32 v175, v175
    v_mfma_f32_16x16x32_bf16 v[76:79], v[212:215], a[48:51], v[76:79]
    buffer_load_dwordx4 v10, s[44:47], s71 offen offset:1024 lds
    v_mov_b32 v15, 0x7ff00000
    v_mov_b32 v255, 4
    v_cndmask_b32 v15, v15, v12, s[78:79]
    v_mul_f32 v191, v191, v175
    v_mfma_f32_16x16x32_bf16 v[76:79], v[216:219], a[52:55], v[76:79]
    s_sub_u32 s72, s59, 2048
    ds_read_b64_tr_b16 v[204:205], v14 offset:2048
    v_cvt_pk_bf16_f32 v143, v190, v191
    v_mul_f32 v160, v144, v160
    v_mfma_f32_16x16x32_bf16 v[80:83], v[212:215], a[112:115], v[80:83]
    buffer_store_dwordx4 v[140:143], v18, s[48:51], s12 offen offset:0 sc1
    v_mul_f32 v144, v4, v144
    v_fma_f32 v252, v145, v145, s64
    v_mfma_f32_16x16x32_bf16 v[80:83], v[216:219], a[116:119], v[80:83]
    ds_read_b64_tr_b16 v[206:207], v14 offset:2304
    ds_write_b128 v18, v[140:143] offset:49152
    v_mfma_f32_16x16x32_bf16 v[84:87], v[212:215], a[176:179], v[84:87]
    ds_read_b64_tr_b16 v[208:209], v14 offset:10240
    v_exp_f32 v144, v144
    v_mfma_f32_16x16x32_bf16 v[84:87], v[216:219], a[180:183], v[84:87]
    buffer_load_dwordx4 v10, s[44:47], s72 offen offset:2048 lds
    v_add_f32 v144, 1.0, v144
    v_mfma_f32_16x16x32_bf16 v[88:91], v[212:215], a[240:243], v[88:91]
    s_add_u32 s73, s59, 33792
    ds_read_b64_tr_b16 v[210:211], v14 offset:10496
    v_rcp_f32 v144, v144
    v_mfma_f32_16x16x32_bf16 v[88:91], v[216:219], a[244:247], v[88:91]
    s_waitcnt lgkmcnt(5)
    v_mul_f32 v160, v160, v144
    v_mul_f32 v161, v145, v161
    v_mfma_f32_16x16x32_bf16 v[92:95], v[220:223], a[48:51], v[92:95]
    ds_read_b64_tr_b16 v[212:213], v14 offset:3072
    v_mul_f32 v145, v252, v145
    v_fma_f32 v1, v146, v146, s64
    v_mfma_f32_16x16x32_bf16 v[92:95], v[224:227], a[52:55], v[92:95]
    ds_read_b64_tr_b16 v[214:215], v14 offset:3328
    v_exp_f32 v145, v145
    v_mfma_f32_16x16x32_bf16 v[96:99], v[220:223], a[112:115], v[96:99]
    buffer_load_dwordx4 v10, s[44:47], s73 offen offset:3072 lds
    v_add_f32 v145, 1.0, v145
    v_mfma_f32_16x16x32_bf16 v[96:99], v[224:227], a[116:119], v[96:99]
    s_lshl_b32 s3, s52, 11
    ds_read_b64_tr_b16 v[216:217], v14 offset:11264
    v_rcp_f32 v145, v145
    v_mfma_f32_16x16x32_bf16 v[100:103], v[220:223], a[176:179], v[100:103]
    s_add_u32 s56, s3, 81920
    ds_read_b64_tr_b16 v[218:219], v14 offset:11520
    v_mul_f32 v161, v161, v145
    v_mul_f32 v162, v146, v162
    v_mfma_f32_16x16x32_bf16 v[100:103], v[224:227], a[180:183], v[100:103]
    s_add_u32 s3, s14, 16384
    v_mul_f32 v146, v1, v146
    v_fma_f32 v2, v147, v147, s64
    v_mfma_f32_16x16x32_bf16 v[104:107], v[220:223], a[240:243], v[104:107]
    s_mov_b32 m0, s56
    v_exp_f32 v146, v146
    v_mfma_f32_16x16x32_bf16 v[104:107], v[224:227], a[244:247], v[104:107]
    s_waitcnt lgkmcnt(4)
    v_add_f32 v146, 1.0, v146
    v_cvt_pk_bf16_f32 v241, v242, v243
    v_mfma_f32_16x16x32_bf16 v[76:79], v[204:207], a[56:59], v[76:79]
    buffer_load_dwordx4 v12, s[48:51], s3 offen offset:0 sc1 lds
    v_rcp_f32 v146, v146
    v_mfma_f32_16x16x32_bf16 v[76:79], v[208:211], a[60:63], v[76:79]
    s_waitcnt lgkmcnt(0)
    s_barrier
    v_mul_f32 v162, v162, v146
    v_mfma_f32_16x16x32_bf16 v[80:83], v[204:207], a[120:123], v[80:83]
    ds_read_b64_tr_b16 v[220:221], v14 offset:16384
    v_mul_f32 v163, v147, v163
    v_mul_f32 v147, v2, v147
    v_mfma_f32_16x16x32_bf16 v[80:83], v[208:211], a[124:127], v[80:83]
    ds_read_b64_tr_b16 v[222:223], v14 offset:16640
    v_exp_f32 v147, v147
    v_mfma_f32_16x16x32_bf16 v[84:87], v[204:207], a[184:187], v[84:87]
    ds_read_b64_tr_b16 v[224:225], v14 offset:24576
    v_add_f32 v147, 1.0, v147
    v_mfma_f32_16x16x32_bf16 v[84:87], v[208:211], a[188:191], v[84:87]
    buffer_load_dwordx4 v12, s[48:51], s3 offen offset:1024 sc1 lds
    v_rcp_f32 v147, v147
    v_mfma_f32_16x16x32_bf16 v[88:91], v[204:207], a[248:251], v[88:91]
    s_add_u32 m0, s55, 0
    ds_read_b64_tr_b16 v[226:227], v14 offset:24832
    v_mul_f32 v163, v163, v147
    v_cvt_pk_bf16_f32 v144, v160, v161
    v_mfma_f32_16x16x32_bf16 v[88:91], v[208:211], a[252:255], v[88:91]
    ds_write_b64 v5, v[240:241] offset:8
    v_mfma_f32_16x16x32_bf16 v[92:95], v[212:215], a[56:59], v[92:95]
    s_add_u32 s70, s59, 73728
    ds_read_b64_tr_b16 v[204:205], v14 offset:17408
    v_cvt_pk_bf16_f32 v145, v162, v163
    v_fma_f32 v3, v176, v176, s64
    v_mfma_f32_16x16x32_bf16 v[92:95], v[216:219], a[60:63], v[92:95]
    ds_read_b64_tr_b16 v[206:207], v14 offset:17664
    v_mul_f32 v192, v176, v192
    v_mfma_f32_16x16x32_bf16 v[96:99], v[212:215], a[120:123], v[96:99]
    buffer_load_dwordx4 v10, s[44:47], s70 offen offset:0 lds
    v_mul_f32 v176, v3, v176
    v_fma_f32 v4, v177, v177, s64
    v_mfma_f32_16x16x32_bf16 v[96:99], v[216:219], a[124:127], v[96:99]
    s_add_u32 s71, s59, 109568
    ds_read_b64_tr_b16 v[208:209], v14 offset:25600
    v_exp_f32 v176, v176
    v_mfma_f32_16x16x32_bf16 v[100:103], v[212:215], a[184:187], v[100:103]
    ds_read_b64_tr_b16 v[210:211], v14 offset:25856
    v_add_f32 v176, 1.0, v176
    v_mul_f32 v193, v177, v193
    v_mfma_f32_16x16x32_bf16 v[100:103], v[216:219], a[188:191], v[100:103]
    v_rcp_f32 v176, v176
    v_mfma_f32_16x16x32_bf16 v[104:107], v[212:215], a[248:251], v[104:107]
    v_mul_f32 v192, v192, v176
    v_mul_f32 v177, v4, v177
    v_mfma_f32_16x16x32_bf16 v[104:107], v[216:219], a[252:255], v[104:107]
    s_waitcnt lgkmcnt(5)
    v_exp_f32 v177, v177
    v_mfma_f32_16x16x32_bf16 v[76:79], v[220:223], v[44:47], v[76:79]
    buffer_load_dwordx4 v10, s[44:47], s71 offen offset:1024 lds
    v_add_f32 v177, 1.0, v177
    v_mfma_f32_16x16x32_bf16 v[76:79], v[224:227], v[48:51], v[76:79]
    s_waitcnt vmcnt(9) lgkmcnt(0)
    s_barrier
    v_rcp_f32 v177, v177
    v_mfma_f32_16x16x32_bf16 v[80:83], v[220:223], v[52:55], v[80:83]
    s_add_u32 s72, s59, 145408
    ds_read_b64_tr_b16 v[212:213], v16 offset:32768
    ds_read_b128 a[44:47], v12 offset:0
    ds_read_b128 a[108:111], v12 offset:1024
    ds_read_b128 a[172:175], v13 offset:0
    ds_read_b128 a[236:239], v13 offset:1024
    ds_read_b128 a[48:51], v12 offset:8192
    v_mfma_f32_16x16x32_bf16 v[80:83], v[224:227], v[56:59], v[80:83]
    ds_read_b64_tr_b16 v[214:215], v16 offset:40960
    ds_read_b128 a[112:115], v12 offset:9216
    ds_read_b128 a[176:179], v13 offset:8192
    ds_read_b128 a[240:243], v13 offset:9216
    v_mul_f32 v193, v193, v177
    v_fma_f32 v252, v178, v178, s64
    v_mfma_f32_16x16x32_bf16 v[84:87], v[220:223], v[60:63], v[84:87]
    buffer_load_dwordx4 v10, s[44:47], s72 offen offset:2048 lds
    v_mul_f32 v194, v178, v194
    v_mul_f32 v178, v252, v178
    v_fma_f32 v1, v179, v179, s64
    v_mfma_f32_16x16x32_bf16 v[84:87], v[224:227], v[64:67], v[84:87]
    s_add_u32 s73, s59, 181248
    ds_read_b64_tr_b16 v[216:217], v16 offset:33792
    ds_read_b64_tr_b16 v[218:219], v16 offset:41984
    v_exp_f32 v178, v178
    v_mfma_f32_16x16x32_bf16 v[88:91], v[220:223], v[68:71], v[88:91]
    v_add_f32 v178, 1.0, v178
    v_mul_f32 v195, v179, v195
    v_mfma_f32_16x16x32_bf16 v[88:91], v[224:227], v[72:75], v[88:91]
    v_rcp_f32 v178, v178
    v_mfma_f32_16x16x32_bf16 v[92:95], v[204:207], v[44:47], v[92:95]
    buffer_load_dwordx4 v10, s[44:47], s73 offen offset:3072 lds
    v_mul_f32 v194, v194, v178
    v_mul_f32 v179, v1, v179
    v_mfma_f32_16x16x32_bf16 v[92:95], v[208:211], v[48:51], v[92:95]
    s_lshl_b32 s3, s52, 11
    ds_read_b64_tr_b16 v[220:221], v17 offset:32768
    v_exp_f32 v179, v179
    v_mfma_f32_16x16x32_bf16 v[96:99], v[204:207], v[52:55], v[96:99]
    s_add_u32 s56, s3, 90112
    ds_read_b64_tr_b16 v[222:223], v17 offset:40960
    v_add_f32 v179, 1.0, v179
    v_mfma_f32_16x16x32_bf16 v[96:99], v[208:211], v[56:59], v[96:99]
    s_add_u32 s3, s14, 24576
    ds_read_b64_tr_b16 v[224:225], v17 offset:33792
    v_rcp_f32 v179, v179
    v_mfma_f32_16x16x32_bf16 v[100:103], v[204:207], v[60:63], v[100:103]
    s_mov_b32 m0, s56
    ds_read_b64_tr_b16 v[226:227], v17 offset:41984
    v_mul_f32 v195, v195, v179
    v_cvt_pk_bf16_f32 v146, v192, v193
    v_mfma_f32_16x16x32_bf16 v[100:103], v[208:211], v[64:67], v[100:103]
    buffer_load_dwordx4 v12, s[48:51], s3 offen offset:0 sc1 lds
    v_cvt_pk_bf16_f32 v147, v194, v195
    v_fma_f32 v2, v148, v148, s64
    v_mfma_f32_16x16x32_bf16 v[104:107], v[204:207], v[68:71], v[104:107]
    buffer_store_dwordx4 v[144:147], v18, s[48:51], s12 offen offset:1024 sc1
    v_mul_f32 v164, v148, v164
    v_mul_f32 v148, v2, v148
    v_mfma_f32_16x16x32_bf16 v[104:107], v[208:211], v[72:75], v[104:107]
    s_waitcnt lgkmcnt(4)
    ds_write_b128 v18, v[144:147] offset:50176
    v_bfe_u32 v9, v0, 2, 2
    v_mul_u32_u24 v9, 640, v9
    v_and_b32 v14, 3, v0
    v_lshl_add_u32 v9, v14, 3, v9
    s_and_b32 s75, s52, 1
    s_lshl_b32 s75, s75, 6
    s_add_u32 s75, s75, 158720
    s_and_b32 s74, s53, 1
    s_lshl_b32 s74, s74, 7
    s_add_u32 s75, s75, s74
    s_add_u32 s75, s75, s11
    v_add_u32 v9, s75, v9
    v_mfma_f32_16x16x32_bf16 v[108:111], v[212:215], a[0:3], 0
    buffer_load_dwordx4 v12, s[48:51], s3 offen offset:1024 sc1 lds
    v_cndmask_b32 v239, v251, v250, s[78:79]
    v_mul_f32 v246, v246, v251
    v_mul_f32 v244, v244, v239
    v_mfma_f32_16x16x32_bf16 v[108:111], v[216:219], a[4:7], v[108:111]
    s_add_u32 m0, s55, 16384
    ds_read_b64_tr_b16 v[204:205], v16 offset:34816
    v_mul_f32 v245, v245, v239
    v_mul_f32 v247, v247, v251
    v_cvt_pk_bf16_f32 v244, v244, v245
    v_mfma_f32_16x16x32_bf16 v[116:119], v[212:215], a[64:67], 0
    s_add_u32 s70, s0, 0
    ds_read_b64_tr_b16 v[206:207], v16 offset:43008
    v_cvt_pk_bf16_f32 v245, v246, v247
    v_mov_b32 v228, 0
    v_mov_b32 v229, 0
    v_mfma_f32_16x16x32_bf16 v[116:119], v[216:219], a[68:71], v[116:119]
    buffer_load_dwordx4 v10, s[44:47], s70 offen offset:0 lds
    v_exp_f32 v148, v148
    v_fma_f32 v3, v149, v149, s64
    v_mfma_f32_16x16x32_bf16 v[124:127], v[212:215], a[128:131], 0
    s_add_u32 s71, s0, 35840
    ds_read_b64_tr_b16 v[208:209], v16 offset:35840
    ds_write_b64 v5, v[244:245] offset:1032
    v_add_f32 v148, 1.0, v148
    v_mfma_f32_16x16x32_bf16 v[124:127], v[216:219], a[132:135], v[124:127]
    ds_read_b64_tr_b16 v[210:211], v16 offset:44032
    ds_read_b128 v[232:235], v28
    ds_read_b128 v[236:239], v29
    v_rcp_f32 v148, v148
    v_mfma_f32_16x16x32_bf16 v[132:135], v[212:215], a[192:195], 0
    buffer_load_dwordx4 v10, s[44:47], s71 offen offset:1024 lds
    v_mul_f32 v164, v164, v148
    v_mul_f32 v165, v149, v165
    v_mfma_f32_16x16x32_bf16 v[132:135], v[216:219], a[196:199], v[132:135]
    s_waitcnt lgkmcnt(8)
    v_mul_f32 v149, v3, v149
    v_fma_f32 v4, v150, v150, s64
    v_exp_f32 v149, v149
    v_mfma_f32_16x16x32_bf16 v[112:115], v[220:223], a[0:3], 0
    s_add_u32 s72, s0, 71680
    ds_read_b64_tr_b16 v[212:213], v17 offset:34816
    v_add_f32 v149, 1.0, v149
    v_mul_f32 v166, v150, v166
    v_mfma_f32_16x16x32_bf16 v[112:115], v[224:227], a[4:7], v[112:115]
    buffer_load_dwordx4 v10, s[44:47], s72 offen offset:2048 lds
    s_waitcnt lgkmcnt(2)
    v_cvt_pk_bf16_f32 v230, v232, v233
    v_cvt_pk_bf16_f32 v231, v234, v235
    s_waitcnt lgkmcnt(1)
    v_cvt_pk_bf16_f32 v236, v236, v237
    v_mfma_f32_16x16x32_bf16 v[120:123], v[220:223], a[64:67], 0
    s_add_u32 s73, s0, 107520
    ds_read_b64_tr_b16 v[214:215], v17 offset:43008
    v_cvt_pk_bf16_f32 v237, v238, v239
    v_mfma_f32_16x16x32_bf16 v[240:243], v[228:231], v[34:37], 0
    v_mfma_f32_16x16x32_bf16 v[120:123], v[224:227], a[68:71], v[120:123]
    ds_read_b64_tr_b16 v[216:217], v17 offset:35840
    v_mfma_f32_16x16x32_bf16 v[244:247], v[228:231], v[40:43], 0
    v_rcp_f32 v149, v149
    v_mfma_f32_16x16x32_bf16 v[128:131], v[220:223], a[128:131], 0
    buffer_load_dwordx4 v10, s[44:47], s73 offen offset:3072 lds
    v_mfma_f32_16x16x16_bf16 v[240:243], v[236:237], v[32:33], v[240:243]
    v_mfma_f32_16x16x32_bf16 v[128:131], v[224:227], a[132:135], v[128:131]
    ds_read_b64_tr_b16 v[218:219], v17 offset:44032
    v_mfma_f32_16x16x16_bf16 v[244:247], v[236:237], v[38:39], v[244:247]
    v_mul_f32 v165, v165, v149
    v_mfma_f32_16x16x32_bf16 v[136:139], v[220:223], a[192:195], 0
    s_nop 2
    v_mul_f32 v240, v240, v249
    v_mul_f32 v241, v241, v249
    v_mul_f32 v242, v242, v249
    v_mfma_f32_16x16x32_bf16 v[136:139], v[224:227], a[196:199], v[136:139]
    v_mul_f32 v243, v243, v249
    v_cvt_pk_bf16_f32 v240, v240, v241
    v_cvt_pk_bf16_f32 v241, v242, v243
    v_mfma_f32_16x16x32_bf16 v[108:111], v[204:207], a[8:11], v[108:111]
    ds_write_b64 v5, v[240:241] offset:8192
    v_mul_f32 v244, v244, v251
    v_mul_f32 v245, v245, v251
    v_mfma_f32_16x16x32_bf16 v[108:111], v[208:211], a[12:15], v[108:111]
    s_lshl_b32 s3, s52, 11
    s_add_u32 s56, s3, 98304
    v_mul_f32 v246, v246, v251
    v_mul_f32 v247, v247, v251
    v_cvt_pk_bf16_f32 v244, v244, v245
    v_mfma_f32_16x16x32_bf16 v[116:119], v[204:207], a[72:75], v[116:119]
    s_waitcnt vmcnt(11) lgkmcnt(0)
    s_barrier
    v_cvt_pk_bf16_f32 v245, v246, v247
    v_mul_f32 v150, v4, v150
    v_fma_f32 v252, v151, v151, s64
    v_mfma_f32_16x16x32_bf16 v[116:119], v[208:211], a[76:79], v[116:119]
    s_add_u32 s3, s14, 32768
    ds_read_b64_tr_b16 v[220:221], v16 offset:49152
    ds_read_b128 a[52:55], v12 offset:16384
    ds_read_b128 a[116:119], v12 offset:17408
    ds_read_b128 a[180:183], v13 offset:16384
    ds_read_b128 a[244:247], v13 offset:17408
    ds_write_b64 v5, v[244:245] offset:9216
    v_mfma_f32_16x16x32_bf16 v[124:127], v[204:207], a[136:139], v[124:127]
    s_mov_b32 m0, s56
    ds_read_b64_tr_b16 v[222:223], v16 offset:57344
    v_exp_f32 v150, v150
    v_mul_f32 v167, v151, v167
    v_add_f32 v150, 1.0, v150
    v_mfma_f32_16x16x32_bf16 v[124:127], v[208:211], a[140:143], v[124:127]
    buffer_load_dwordx4 v12, s[48:51], s3 offen offset:0 sc1 lds
    v_rcp_f32 v150, v150
    v_mul_f32 v151, v252, v151
    v_mfma_f32_16x16x32_bf16 v[132:135], v[204:207], a[200:203], v[132:135]
    ds_read_b64_tr_b16 v[224:225], v16 offset:50176
    ds_read_b64_tr_b16 v[226:227], v16 offset:58368
    v_mul_f32 v166, v166, v150
    v_exp_f32 v151, v151
    v_mfma_f32_16x16x32_bf16 v[132:135], v[208:211], a[204:207], v[132:135]
    v_add_f32 v151, 1.0, v151
    v_cvt_pk_bf16_f32 v148, v164, v165
    v_rcp_f32 v151, v151
    v_mfma_f32_16x16x32_bf16 v[112:115], v[212:215], a[8:11], v[112:115]
    ds_read_b64_tr_b16 v[204:205], v17 offset:49152
    v_mul_f32 v167, v167, v151
    v_fma_f32 v1, v180, v180, s64
    v_mfma_f32_16x16x32_bf16 v[112:115], v[216:219], a[12:15], v[112:115]
    buffer_load_dwordx4 v12, s[48:51], s3 offen offset:1024 sc1 lds
    v_cvt_pk_bf16_f32 v149, v166, v167
    v_mul_f32 v196, v180, v196
    v_mul_f32 v180, v1, v180
    v_mfma_f32_16x16x32_bf16 v[120:123], v[212:215], a[72:75], v[120:123]
    s_add_u32 m0, s55, 32768
    ds_read_b64_tr_b16 v[206:207], v17 offset:57344
    v_exp_f32 v180, v180
    v_fma_f32 v2, v181, v181, s64
    v_mfma_f32_16x16x32_bf16 v[120:123], v[216:219], a[76:79], v[120:123]
    s_add_u32 s70, s59, 221184
    ds_read_b64_tr_b16 v[208:209], v17 offset:50176
    v_add_f32 v180, 1.0, v180
    v_mul_f32 v197, v181, v197
    v_rcp_f32 v180, v180
    v_mfma_f32_16x16x32_bf16 v[128:131], v[212:215], a[136:139], v[128:131]
    s_add_u32 s70, s70, s11
    ds_read_b64_tr_b16 v[210:211], v17 offset:58368
    v_mul_f32 v196, v196, v180
    v_mul_f32 v181, v2, v181
    v_mfma_f32_16x16x32_bf16 v[128:131], v[216:219], a[140:143], v[128:131]
    buffer_load_dwordx4 v10, s[44:47], s70 offen offset:0 lds
    v_exp_f32 v181, v181
    v_fma_f32 v3, v182, v182, s64
    v_mfma_f32_16x16x32_bf16 v[136:139], v[212:215], a[200:203], v[136:139]
    s_add_u32 s71, s59, 257024
    s_add_u32 s71, s71, s11
    v_add_f32 v181, 1.0, v181
    v_mul_f32 v198, v182, v198
    v_rcp_f32 v181, v181
    v_mfma_f32_16x16x32_bf16 v[136:139], v[216:219], a[204:207], v[136:139]
    s_waitcnt lgkmcnt(4)
    v_mul_f32 v197, v197, v181
    v_mul_f32 v182, v3, v182
    v_mfma_f32_16x16x32_bf16 v[108:111], v[220:223], a[16:19], v[108:111]
    ds_read_b64_tr_b16 v[212:213], v16 offset:51200
    v_exp_f32 v182, v182
    v_fma_f32 v4, v183, v183, s64
    v_mfma_f32_16x16x32_bf16 v[108:111], v[224:227], a[20:23], v[108:111]
    ds_read_b64_tr_b16 v[214:215], v16 offset:59392
    v_add_f32 v182, 1.0, v182
    v_mul_f32 v199, v183, v199
    v_rcp_f32 v182, v182
    v_mfma_f32_16x16x32_bf16 v[116:119], v[220:223], a[80:83], v[116:119]
    buffer_load_dwordx4 v10, s[44:47], s71 offen offset:1024 lds
    v_mul_f32 v198, v198, v182
    v_mul_f32 v183, v4, v183
    v_mfma_f32_16x16x32_bf16 v[116:119], v[224:227], a[84:87], v[116:119]
    s_add_u32 s72, s59, 219136
    ds_read_b64_tr_b16 v[216:217], v16 offset:52224
    v_exp_f32 v183, v183
    v_cvt_pk_bf16_f32 v150, v196, v197
    v_mfma_f32_16x16x32_bf16 v[124:127], v[220:223], a[144:147], v[124:127]
    ds_read_b64_tr_b16 v[218:219], v16 offset:60416
    v_add_f32 v183, 1.0, v183
    v_fma_f32 v252, v152, v152, s64
    v_rcp_f32 v183, v183
    v_mfma_f32_16x16x32_bf16 v[124:127], v[224:227], a[148:151], v[124:127]
    v_mul_f32 v199, v199, v183
    v_mul_f32 v168, v152, v168
    v_cvt_pk_bf16_f32 v151, v198, v199
    v_mfma_f32_16x16x32_bf16 v[132:135], v[220:223], a[208:211], v[132:135]
    buffer_store_dwordx4 v[148:151], v19, s[48:51], s12 offen offset:0 sc1
    v_mul_f32 v152, v252, v152
    v_fma_f32 v1, v153, v153, s64
    v_exp_f32 v152, v152
    v_mfma_f32_16x16x32_bf16 v[132:135], v[224:227], a[212:215], v[132:135]
    s_waitcnt lgkmcnt(4)
    ds_write_b128 v19, v[148:151] offset:49152
    v_mfma_f32_16x16x32_bf16 v[112:115], v[204:207], a[16:19], v[112:115]
    buffer_load_dwordx4 v10, s[44:47], s72 offen offset:2048 lds
    v_add_f32 v152, 1.0, v152
    v_mul_f32 v169, v153, v169
    v_rcp_f32 v152, v152
    v_mfma_f32_16x16x32_bf16 v[112:115], v[208:211], a[20:23], v[112:115]
    s_add_u32 s73, s59, 254976
    ds_read_b64_tr_b16 v[220:221], v17 offset:51200
    v_mul_f32 v168, v168, v152
    v_mul_f32 v153, v1, v153
    v_mfma_f32_16x16x32_bf16 v[120:123], v[204:207], a[80:83], v[120:123]
    ds_read_b64_tr_b16 v[222:223], v17 offset:59392
    v_exp_f32 v153, v153
    v_fma_f32 v2, v154, v154, s64
    v_mfma_f32_16x16x32_bf16 v[120:123], v[208:211], a[84:87], v[120:123]
    ds_read_b64_tr_b16 v[224:225], v17 offset:52224
    v_add_f32 v153, 1.0, v153
    v_mul_f32 v170, v154, v170
    v_rcp_f32 v153, v153
    v_mfma_f32_16x16x32_bf16 v[128:131], v[204:207], a[144:147], v[128:131]
    buffer_load_dwordx4 v10, s[44:47], s73 offen offset:3072 lds
    v_mul_f32 v169, v169, v153
    v_mul_f32 v154, v2, v154
    v_mfma_f32_16x16x32_bf16 v[128:131], v[208:211], a[148:151], v[128:131]
    s_lshl_b32 s3, s52, 11
    ds_read_b64_tr_b16 v[226:227], v17 offset:60416
    v_exp_f32 v154, v154
    v_fma_f32 v3, v155, v155, s64
    v_mfma_f32_16x16x32_bf16 v[136:139], v[204:207], a[208:211], v[136:139]
    s_add_u32 s56, s3, 106496
    s_add_u32 s3, s14, 40960
    v_add_f32 v154, 1.0, v154
    v_mul_f32 v171, v155, v171
    v_rcp_f32 v154, v154
    v_mfma_f32_16x16x32_bf16 v[136:139], v[208:211], a[212:215], v[136:139]
    s_waitcnt lgkmcnt(5)
    v_mul_f32 v170, v170, v154
    v_mul_f32 v155, v3, v155
    v_mfma_f32_16x16x32_bf16 v[44:47], v[212:215], a[0:3], 0
    s_mov_b32 m0, s56
    v_exp_f32 v155, v155
    v_cvt_pk_bf16_f32 v152, v168, v169
    v_mfma_f32_16x16x32_bf16 v[44:47], v[216:219], a[4:7], v[44:47]
    buffer_load_dwordx4 v12, s[48:51], s3 offen offset:0 sc1 lds
    v_add_f32 v155, 1.0, v155
    v_fma_f32 v4, v184, v184, s64
    v_rcp_f32 v155, v155
    v_mfma_f32_16x16x32_bf16 v[52:55], v[212:215], a[64:67], 0
    s_waitcnt vmcnt(12) lgkmcnt(0)
    s_barrier
    v_mul_f32 v171, v171, v155
    v_mul_f32 v200, v184, v200
    v_mfma_f32_16x16x32_bf16 v[52:55], v[216:219], a[68:71], v[52:55]
    ds_read_b64_tr_b16 v[204:205], v16 offset:0
    ds_read_b128 a[56:59], v12 offset:24576
    ds_read_b128 a[120:123], v12 offset:25600
    ds_read_b128 a[184:187], v13 offset:24576
    ds_read_b128 a[248:251], v13 offset:25600
    ds_read_b128 a[36:39], v6 offset:8192
    v_mfma_f32_16x16x32_bf16 v[60:63], v[212:215], a[128:131], 0
    ds_read_b64_tr_b16 v[206:207], v16 offset:8192
    ds_read_b128 a[100:103], v6 offset:9216
    ds_read_b128 a[164:167], v7 offset:8192
    ds_read_b128 a[228:231], v7 offset:9216
    ds_read_b64 a[40:41], v6 offset:16384
    ds_read_b64 a[104:105], v6 offset:17408
    v_mfma_f32_16x16x32_bf16 v[60:63], v[216:219], a[132:135], v[60:63]
    ds_read_b64_tr_b16 v[208:209], v16 offset:1024
    ds_read_b64_tr_b16 v[210:211], v16 offset:9216
    ds_read_b64 a[168:169], v7 offset:16384
    ds_read_b64 a[232:233], v7 offset:17408
    v_cvt_pk_bf16_f32 v153, v170, v171
    v_mul_f32 v184, v4, v184
    v_mfma_f32_16x16x32_bf16 v[68:71], v[212:215], a[192:195], 0
    buffer_load_dwordx4 v12, s[48:51], s3 offen offset:1024 sc1 lds
    v_exp_f32 v184, v184
    v_fma_f32 v252, v185, v185, s64
    v_add_f32 v184, 1.0, v184
    v_mfma_f32_16x16x32_bf16 v[68:71], v[216:219], a[196:199], v[68:71]
    v_rcp_f32 v184, v184
    v_mul_f32 v201, v185, v201
    v_mfma_f32_16x16x32_bf16 v[48:51], v[220:223], a[0:3], 0
    s_add_u32 m0, s55, 49152
    ds_read_b64_tr_b16 v[212:213], v17 offset:0
    v_mul_f32 v200, v200, v184
    v_mul_f32 v185, v252, v185
    v_fma_f32 v1, v186, v186, s64
    v_mfma_f32_16x16x32_bf16 v[48:51], v[224:227], a[4:7], v[48:51]
    s_add_u32 s70, s61, 0
    ds_read_b64_tr_b16 v[214:215], v17 offset:8192
    v_exp_f32 v185, v185
    v_mul_f32 v202, v186, v202
    v_mfma_f32_16x16x32_bf16 v[56:59], v[220:223], a[64:67], 0
    s_add_u32 s70, s70, s11
    ds_read_b64_tr_b16 v[216:217], v17 offset:1024
    v_add_f32 v185, 1.0, v185
    v_mul_f32 v186, v1, v186
    v_rcp_f32 v185, v185
    v_mfma_f32_16x16x32_bf16 v[56:59], v[224:227], a[68:71], v[56:59]
    buffer_load_dwordx4 v10, s[32:35], s70 offen offset:0 lds
    v_mul_f32 v201, v201, v185
    v_exp_f32 v186, v186
    v_mfma_f32_16x16x32_bf16 v[64:67], v[220:223], a[128:131], 0
    s_sub_u32 s71, s60, 1024
    ds_read_b64_tr_b16 v[218:219], v17 offset:9216
    v_add_f32 v186, 1.0, v186
    v_fma_f32 v2, v187, v187, s64
    v_mfma_f32_16x16x32_bf16 v[64:67], v[224:227], a[132:135], v[64:67]
    s_add_u32 s71, s71, s11
    v_rcp_f32 v186, v186
    v_mul_f32 v203, v187, v203
    v_mul_f32 v202, v202, v186
    v_mfma_f32_16x16x32_bf16 v[72:75], v[220:223], a[192:195], 0
    v_mul_f32 v187, v2, v187
    v_cvt_pk_bf16_f32 v154, v200, v201
    v_exp_f32 v187, v187
    v_mfma_f32_16x16x32_bf16 v[72:75], v[224:227], a[196:199], v[72:75]
    s_waitcnt lgkmcnt(6)
    v_add_f32 v187, 1.0, v187
    v_fma_f32 v1, v76, v76, s64
    v_mfma_f32_16x16x32_bf16 v[44:47], v[204:207], a[8:11], v[44:47]
    buffer_load_dwordx4 v10, s[44:47], s71 offen offset:1024 lds
    v_rcp_f32 v187, v187
    v_mul_f32 v92, v76, v92
    v_mfma_f32_16x16x32_bf16 v[44:47], v[208:211], a[12:15], v[44:47]
    s_sub_u32 s72, s61, 2048
    ds_read_b64_tr_b16 v[220:221], v16 offset:2048
    v_mul_f32 v203, v203, v187
    v_mul_f32 v76, v1, v76
    v_cvt_pk_bf16_f32 v155, v202, v203
    v_mfma_f32_16x16x32_bf16 v[52:55], v[204:207], a[72:75], v[52:55]
    buffer_store_dwordx4 v[152:155], v19, s[48:51], s12 offen offset:1024 sc1
    v_exp_f32 v76, v76
    s_add_u32 s12, s12, 16384
    v_add_f32 v76, 1.0, v76
    v_mfma_f32_16x16x32_bf16 v[52:55], v[208:211], a[76:79], v[52:55]
    s_add_u32 s13, s12, 8192
    ds_read_b64_tr_b16 v[222:223], v16 offset:10240
    ds_write_b128 v19, v[152:155] offset:50176
    v_rcp_f32 v76, v76
    v_mfma_f32_16x16x32_bf16 v[60:63], v[204:207], a[136:139], v[60:63]
    buffer_store_dwordx4 a[36:39], v12, s[48:51], s13 offen offset:0 sc1
    v_mul_f32 v92, v92, v76
    v_fma_f32 v2, v77, v77, s64
    v_mfma_f32_16x16x32_bf16 v[60:63], v[208:211], a[140:143], v[60:63]
    buffer_store_dwordx4 a[100:103], v12, s[48:51], s13 offen offset:1024 sc1
    v_mul_f32 v93, v77, v93
    v_mul_f32 v77, v2, v77
    v_fma_f32 v3, v78, v78, s64
    v_exp_f32 v77, v77
    v_mfma_f32_16x16x32_bf16 v[68:71], v[204:207], a[200:203], v[68:71]
    buffer_load_dwordx4 v10, s[32:35], s72 offen offset:2048 lds
    v_add_f32 v77, 1.0, v77
    v_mul_f32 v94, v78, v94
    v_mfma_f32_16x16x32_bf16 v[68:71], v[208:211], a[204:207], v[68:71]
    s_waitcnt lgkmcnt(3)
    ds_read_b64_tr_b16 v[224:225], v16 offset:3072
    ds_read_b64_tr_b16 v[226:227], v16 offset:11264
    v_rcp_f32 v77, v77
    v_mul_f32 v78, v3, v78
    v_mfma_f32_16x16x32_bf16 v[48:51], v[212:215], a[8:11], v[48:51]
    s_sub_u32 s73, s60, 3072
    ds_read_b64_tr_b16 v[204:205], v17 offset:2048
    v_mul_f32 v93, v93, v77
    v_exp_f32 v78, v78
    v_mfma_f32_16x16x32_bf16 v[48:51], v[216:219], a[12:15], v[48:51]
    s_add_u32 s13, s12, 16384
    ds_read_b64_tr_b16 v[206:207], v17 offset:10240
    v_add_f32 v78, 1.0, v78
    v_fma_f32 v4, v79, v79, s64
    v_rcp_f32 v78, v78
    v_mfma_f32_16x16x32_bf16 v[56:59], v[212:215], a[72:75], v[56:59]
    buffer_store_dwordx4 a[40:43], v15, s[48:51], s13 offen offset:0 sc1
L_pad9:
    s_cbranch_execz L_pad11
    v_mul_f32 v94, v94, v78
    v_mul_f32 v95, v79, v95
    v_mfma_f32_16x16x32_bf16 v[56:59], v[216:219], a[76:79], v[56:59]
    buffer_store_dwordx4 a[104:107], v15, s[48:51], s13 offen offset:1024 sc1
    v_mul_f32 v79, v4, v79
    v_cvt_pk_bf16_f32 v76, v92, v93
    v_exp_f32 v79, v79
    v_mfma_f32_16x16x32_bf16 v[64:67], v[212:215], a[136:139], v[64:67]
    buffer_load_dwordx4 v10, s[44:47], s73 offen offset:3072 lds
    v_add_f32 v79, 1.0, v79
    v_fma_f32 v252, v80, v80, s64
    v_mfma_f32_16x16x32_bf16 v[64:67], v[216:219], a[140:143], v[64:67]
    s_add_u32 s13, s12, 0
    ds_read_b64_tr_b16 v[208:209], v17 offset:3072
    ds_read_b64_tr_b16 v[210:211], v17 offset:11264
    v_rcp_f32 v79, v79
    v_mul_f32 v96, v80, v96
    v_mfma_f32_16x16x32_bf16 v[72:75], v[212:215], a[200:203], v[72:75]
    v_mul_f32 v95, v95, v79
    v_mul_f32 v80, v252, v80
    v_cvt_pk_bf16_f32 v77, v94, v95
    v_mfma_f32_16x16x32_bf16 v[72:75], v[216:219], a[204:207], v[72:75]
    s_waitcnt lgkmcnt(4)
    ds_write_b64 v8, v[76:77] offset:0
    v_exp_f32 v80, v80
    v_mfma_f32_16x16x32_bf16 v[44:47], v[220:223], a[16:19], v[44:47]
    v_add_f32 v80, 1.0, v80
    v_fma_f32 v1, v81, v81, s64
    v_rcp_f32 v80, v80
    v_mfma_f32_16x16x32_bf16 v[44:47], v[224:227], a[20:23], v[44:47]
    v_mul_f32 v96, v96, v80
    v_mul_f32 v97, v81, v97
    v_mfma_f32_16x16x32_bf16 v[52:55], v[220:223], a[80:83], v[52:55]
    s_waitcnt vmcnt(16) lgkmcnt(0)
    s_barrier
    v_mul_f32 v81, v1, v81
    v_fma_f32 v2, v82, v82, s64
    v_exp_f32 v81, v81
    v_mfma_f32_16x16x32_bf16 v[52:55], v[224:227], a[84:87], v[52:55]
    s_add_u32 m0, s55, 0
    ds_read_b64_tr_b16 v[212:213], v16 offset:16384
    ds_read_b128 a[60:63], v12 offset:32768
    ds_read_b128 a[124:127], v12 offset:33792
    ds_read_b128 a[188:191], v13 offset:32768
    ds_read_b128 a[252:255], v13 offset:33792
    ds_read_b128 a[24:27], v12 offset:49152
    v_mfma_f32_16x16x32_bf16 v[60:63], v[220:223], a[144:147], v[60:63]
    s_add_u32 s70, s59, 128
    ds_read_b64_tr_b16 v[214:215], v16 offset:24576
    ds_read_b128 a[88:91], v12 offset:50176
    ds_read_b128 a[152:155], v13 offset:49152
    ds_read_b128 a[216:219], v13 offset:50176
    ds_read_b128 a[28:31], v12 offset:57344
    ds_read_b128 a[92:95], v12 offset:58368
    v_mfma_f32_16x16x32_bf16 v[60:63], v[224:227], a[148:151], v[60:63]
    buffer_load_dwordx4 v10, s[44:47], s70 offen offset:0 lds
    v_add_f32 v81, 1.0, v81
    v_mul_f32 v98, v82, v98
    v_rcp_f32 v81, v81
    v_mfma_f32_16x16x32_bf16 v[68:71], v[220:223], a[208:211], v[68:71]
    s_add_u32 s71, s59, 35968
    ds_read_b64_tr_b16 v[216:217], v16 offset:17408
    ds_read_b64_tr_b16 v[218:219], v16 offset:25600
    ds_read_b128 a[156:159], v13 offset:57344
    ds_read_b128 a[220:223], v13 offset:58368
    v_mul_f32 v97, v97, v81
    v_mul_f32 v82, v2, v82
    v_mfma_f32_16x16x32_bf16 v[68:71], v[224:227], a[212:215], v[68:71]
    v_exp_f32 v82, v82
    v_fma_f32 v3, v83, v83, s64
    v_add_f32 v82, 1.0, v82
    v_mfma_f32_16x16x32_bf16 v[48:51], v[204:207], a[16:19], v[48:51]
    ds_read_b64_tr_b16 v[220:221], v17 offset:16384
    v_rcp_f32 v82, v82
    v_mul_f32 v99, v83, v99
    v_mfma_f32_16x16x32_bf16 v[48:51], v[208:211], a[20:23], v[48:51]
    ds_read_b64_tr_b16 v[222:223], v17 offset:24576
    v_mul_f32 v98, v98, v82
    v_mul_f32 v83, v3, v83
    v_cvt_pk_bf16_f32 v80, v96, v97
    v_mfma_f32_16x16x32_bf16 v[56:59], v[204:207], a[80:83], v[56:59]
    ds_read_b64_tr_b16 v[224:225], v17 offset:17408
    v_exp_f32 v83, v83
    v_fma_f32 v4, v84, v84, s64
    v_mfma_f32_16x16x32_bf16 v[56:59], v[208:211], a[84:87], v[56:59]
    ds_read_b64_tr_b16 v[226:227], v17 offset:25600
    v_add_f32 v83, 1.0, v83
    v_mul_f32 v100, v84, v100
    v_rcp_f32 v83, v83
    v_mfma_f32_16x16x32_bf16 v[64:67], v[204:207], a[144:147], v[64:67]
    buffer_load_dwordx4 v10, s[44:47], s71 offen offset:1024 lds
    v_mul_f32 v99, v99, v83
    v_mul_f32 v84, v4, v84
    v_cvt_pk_bf16_f32 v81, v98, v99
    v_mfma_f32_16x16x32_bf16 v[64:67], v[208:211], a[148:151], v[64:67]
    s_add_u32 s72, s59, 71808
    ds_write_b64 v8, v[80:81] offset:1024
    v_exp_f32 v84, v84
    v_mfma_f32_16x16x32_bf16 v[72:75], v[204:207], a[208:211], v[72:75]
    v_add_f32 v84, 1.0, v84
    v_fma_f32 v252, v85, v85, s64
    v_mfma_f32_16x16x32_bf16 v[72:75], v[208:211], a[212:215], v[72:75]
    s_waitcnt lgkmcnt(7)
    v_rcp_f32 v84, v84
    v_mul_f32 v101, v85, v101
    v_mul_f32 v100, v100, v84
    v_mfma_f32_16x16x32_bf16 v[44:47], v[212:215], a[44:47], v[44:47]
    ds_read_b64_tr_b16 v[204:205], v16 offset:18432
    v_mul_f32 v85, v252, v85
    v_fma_f32 v1, v86, v86, s64
    v_exp_f32 v85, v85
    v_mfma_f32_16x16x32_bf16 v[44:47], v[216:219], a[48:51], v[44:47]
    ds_read_b64_tr_b16 v[206:207], v16 offset:26624
    v_add_f32 v85, 1.0, v85
    v_mul_f32 v102, v86, v102
    v_mfma_f32_16x16x32_bf16 v[52:55], v[212:215], a[108:111], v[52:55]
    ds_read_b64_tr_b16 v[208:209], v16 offset:19456
    v_rcp_f32 v85, v85
    v_mul_f32 v86, v1, v86
    v_mfma_f32_16x16x32_bf16 v[52:55], v[216:219], a[112:115], v[52:55]
    buffer_load_dwordx4 v10, s[44:47], s72 offen offset:2048 lds
    v_mul_f32 v101, v101, v85
    v_exp_f32 v86, v86
    v_fma_f32 v2, v87, v87, s64
    v_mfma_f32_16x16x32_bf16 v[60:63], v[212:215], a[172:175], v[60:63]
    s_add_u32 s73, s59, 107648
    ds_read_b64_tr_b16 v[210:211], v16 offset:27648
    v_add_f32 v86, 1.0, v86
    v_mul_f32 v103, v87, v103
    v_rcp_f32 v86, v86
    v_mfma_f32_16x16x32_bf16 v[60:63], v[216:219], a[176:179], v[60:63]
    s_waitcnt vmcnt(4)
    v_mul_f32 v102, v102, v86
    v_mul_f32 v87, v2, v87
    v_mfma_f32_16x16x32_bf16 v[68:71], v[212:215], a[236:239], v[68:71]
    buffer_store_dword v255, off, s[48:51], s17 sc1
    v_mov_b32 v255, 5
    v_exp_f32 v87, v87
    v_cvt_pk_bf16_f32 v84, v100, v101
    v_mfma_f32_16x16x32_bf16 v[68:71], v[216:219], a[240:243], v[68:71]
    s_waitcnt lgkmcnt(5)
    v_add_f32 v87, 1.0, v87
    v_fma_f32 v3, v88, v88, s64
    v_rcp_f32 v87, v87
    v_mfma_f32_16x16x32_bf16 v[48:51], v[220:223], a[44:47], v[48:51]
    ds_read_b64_tr_b16 v[212:213], v17 offset:18432
    v_mul_f32 v103, v103, v87
    v_mul_f32 v104, v88, v104
    v_cvt_pk_bf16_f32 v85, v102, v103
    v_mfma_f32_16x16x32_bf16 v[48:51], v[224:227], a[48:51], v[48:51]
    ds_read_b64_tr_b16 v[214:215], v17 offset:26624
    ds_write_b64 v11, v[84:85] offset:0
    v_mul_f32 v88, v3, v88
    v_mfma_f32_16x16x32_bf16 v[56:59], v[220:223], a[108:111], v[56:59]
    buffer_load_dwordx4 v10, s[44:47], s73 offen offset:3072 lds
    v_exp_f32 v88, v88
    v_fma_f32 v4, v89, v89, s64
    v_add_f32 v88, 1.0, v88
    v_mfma_f32_16x16x32_bf16 v[56:59], v[224:227], a[112:115], v[56:59]
    ds_read_b64_tr_b16 v[216:217], v17 offset:19456
    v_rcp_f32 v88, v88
    v_mul_f32 v105, v89, v105
    v_mfma_f32_16x16x32_bf16 v[64:67], v[220:223], a[172:175], v[64:67]
    ds_read_b64_tr_b16 v[218:219], v17 offset:27648
    v_mul_f32 v104, v104, v88
    v_mul_f32 v89, v4, v89
    v_fma_f32 v252, v90, v90, s64
    v_mfma_f32_16x16x32_bf16 v[64:67], v[224:227], a[176:179], v[64:67]
    v_exp_f32 v89, v89
    v_mul_f32 v106, v90, v106
    v_add_f32 v89, 1.0, v89
    v_mfma_f32_16x16x32_bf16 v[72:75], v[220:223], a[236:239], v[72:75]
    v_rcp_f32 v89, v89
    v_mul_f32 v90, v252, v90
    v_mfma_f32_16x16x32_bf16 v[72:75], v[224:227], a[240:243], v[72:75]
    s_waitcnt lgkmcnt(5)
    v_exp_f32 v90, v90
    v_mul_f32 v105, v105, v89
    v_mfma_f32_16x16x32_bf16 v[44:47], v[204:207], a[52:55], v[44:47]
    v_add_f32 v90, 1.0, v90
    v_fma_f32 v1, v91, v91, s64
    v_rcp_f32 v90, v90
    v_mfma_f32_16x16x32_bf16 v[44:47], v[208:211], a[56:59], v[44:47]
    s_waitcnt lgkmcnt(0)
    s_barrier
    v_mul_f32 v106, v106, v90
    v_mul_f32 v107, v91, v107
    v_mul_f32 v91, v1, v91
    v_mfma_f32_16x16x32_bf16 v[52:55], v[204:207], a[116:119], v[52:55]
    s_add_u32 m0, s55, 16384
    ds_read_b64_tr_b16 v[220:221], v16 offset:32768
    ds_read_b128 v[140:143], v12 offset:40960
    ds_read_b128 v[144:147], v12 offset:41984
    ds_read_b128 v[148:151], v13 offset:40960
    ds_read_b128 v[152:155], v13 offset:41984
    v_exp_f32 v91, v91
    v_mfma_f32_16x16x32_bf16 v[52:55], v[208:211], a[120:123], v[52:55]
    s_add_u32 s70, s59, 147584
    ds_read_b64_tr_b16 v[222:223], v16 offset:40960
    v_add_f32 v91, 1.0, v91
    v_cvt_pk_bf16_f32 v88, v104, v105
    v_mfma_f32_16x16x32_bf16 v[60:63], v[204:207], a[180:183], v[60:63]
    buffer_load_dwordx4 v10, s[44:47], s70 offen offset:0 lds
    v_rcp_f32 v91, v91
    v_mfma_f32_16x16x32_bf16 v[60:63], v[208:211], a[184:187], v[60:63]
    s_add_u32 s71, s59, 183424
    ds_read_b64_tr_b16 v[224:225], v16 offset:33792
    ds_read_b64_tr_b16 v[226:227], v16 offset:41984
    v_mul_f32 v107, v107, v91
    v_mfma_f32_16x16x32_bf16 v[68:71], v[204:207], a[244:247], v[68:71]
    v_cvt_pk_bf16_f32 v89, v106, v107
    v_mfma_f32_16x16x32_bf16 v[68:71], v[208:211], a[248:251], v[68:71]
    ds_write_b64 v11, v[88:89] offset:1024
    v_mfma_f32_16x16x32_bf16 v[48:51], v[212:215], a[52:55], v[48:51]
    ds_read_b64_tr_b16 v[204:205], v17 offset:32768
    v_mfma_f32_16x16x32_bf16 v[48:51], v[216:219], a[56:59], v[48:51]
    ds_read_b64_tr_b16 v[206:207], v17 offset:40960
    v_mfma_f32_16x16x32_bf16 v[56:59], v[212:215], a[116:119], v[56:59]
    ds_read_b64_tr_b16 v[208:209], v17 offset:33792
    v_mfma_f32_16x16x32_bf16 v[56:59], v[216:219], a[120:123], v[56:59]
    buffer_load_dword v254, v253, s[48:51], s15 offen sc1
    v_mfma_f32_16x16x32_bf16 v[64:67], v[212:215], a[180:183], v[64:67]
    buffer_load_dwordx4 v10, s[44:47], s71 offen offset:1024 lds
    v_mfma_f32_16x16x32_bf16 v[64:67], v[216:219], a[184:187], v[64:67]
    s_add_u32 s72, s59, 219264
    ds_read_b64_tr_b16 v[210:211], v17 offset:41984
    v_mfma_f32_16x16x32_bf16 v[72:75], v[212:215], a[244:247], v[72:75]
    v_mfma_f32_16x16x32_bf16 v[72:75], v[216:219], a[248:251], v[72:75]
    s_waitcnt lgkmcnt(5)
    v_mfma_f32_16x16x32_bf16 v[108:111], v[220:223], a[24:27], v[108:111]
    ds_read_b64_tr_b16 v[212:213], v16 offset:34816
    v_mfma_f32_16x16x32_bf16 v[108:111], v[224:227], a[28:31], v[108:111]
    ds_read_b64_tr_b16 v[214:215], v16 offset:43008
    v_mfma_f32_16x16x32_bf16 v[116:119], v[220:223], a[88:91], v[116:119]
    buffer_load_dwordx4 v10, s[44:47], s72 offen offset:2048 lds
    v_mfma_f32_16x16x32_bf16 v[116:119], v[224:227], a[92:95], v[116:119]
    s_add_u32 s73, s59, 255104
    ds_read_b64_tr_b16 v[216:217], v16 offset:35840
    v_mfma_f32_16x16x32_bf16 v[124:127], v[220:223], a[152:155], v[124:127]
    ds_read_b64_tr_b16 v[218:219], v16 offset:44032
    v_mfma_f32_16x16x32_bf16 v[124:127], v[224:227], a[156:159], v[124:127]
    v_mfma_f32_16x16x32_bf16 v[132:135], v[220:223], a[216:219], v[132:135]
    v_mfma_f32_16x16x32_bf16 v[132:135], v[224:227], a[220:223], v[132:135]
    s_waitcnt lgkmcnt(4)
    v_mfma_f32_16x16x32_bf16 v[112:115], v[204:207], a[24:27], v[112:115]
    ds_read_b64_tr_b16 v[220:221], v17 offset:34816
    v_mfma_f32_16x16x32_bf16 v[112:115], v[208:211], a[28:31], v[112:115]
    buffer_load_dwordx4 v10, s[44:47], s73 offen offset:3072 lds
    v_mfma_f32_16x16x32_bf16 v[120:123], v[204:207], a[88:91], v[120:123]
    ds_read_b64_tr_b16 v[222:223], v17 offset:43008
    v_mfma_f32_16x16x32_bf16 v[120:123], v[208:211], a[92:95], v[120:123]
    ds_read_b64_tr_b16 v[224:225], v17 offset:35840
    v_mfma_f32_16x16x32_bf16 v[128:131], v[204:207], a[152:155], v[128:131]
    ds_read_b64_tr_b16 v[226:227], v17 offset:44032
    v_mfma_f32_16x16x32_bf16 v[128:131], v[208:211], a[156:159], v[128:131]
    v_mfma_f32_16x16x32_bf16 v[136:139], v[204:207], a[216:219], v[136:139]
    v_mfma_f32_16x16x32_bf16 v[136:139], v[208:211], a[220:223], v[136:139]
    s_waitcnt lgkmcnt(4)
    v_mfma_f32_16x16x32_bf16 v[44:47], v[212:215], a[24:27], v[44:47]
    v_mfma_f32_16x16x32_bf16 v[44:47], v[216:219], a[28:31], v[44:47]
    s_waitcnt vmcnt(10) lgkmcnt(0)
    s_barrier
    v_mfma_f32_16x16x32_bf16 v[52:55], v[212:215], a[88:91], v[52:55]
    s_add_u32 m0, s55, 32768
    ds_read_b64_tr_b16 v[204:205], v16 offset:49152
    ds_read_b128 a[32:35], v6 offset:0
    v_mfma_f32_16x16x32_bf16 v[52:55], v[216:219], a[92:95], v[52:55]
    s_add_u32 s70, s61, 128
    ds_read_b64_tr_b16 v[206:207], v16 offset:57344
    ds_read_b128 a[96:99], v6 offset:1024
    v_mfma_f32_16x16x32_bf16 v[60:63], v[212:215], a[152:155], v[60:63]
    buffer_load_dwordx4 v10, s[32:35], s70 offen offset:0 lds
    v_mfma_f32_16x16x32_bf16 v[60:63], v[216:219], a[156:159], v[60:63]
    s_sub_u32 s71, s60, 896
    ds_read_b64_tr_b16 v[208:209], v16 offset:50176
    ds_read_b64_tr_b16 v[210:211], v16 offset:58368
    v_mfma_f32_16x16x32_bf16 v[68:71], v[212:215], a[216:219], v[68:71]
    ds_read_b128 a[160:163], v7 offset:0
    ds_read_b128 a[224:227], v7 offset:1024
    v_mfma_f32_16x16x32_bf16 v[68:71], v[216:219], a[220:223], v[68:71]
    v_mfma_f32_16x16x32_bf16 v[48:51], v[220:223], a[24:27], v[48:51]
    s_waitcnt lgkmcnt(6)
    buffer_store_dwordx4 a[32:35], v12, s[48:51], s13 offen offset:0 sc1
    v_mfma_f32_16x16x32_bf16 v[48:51], v[224:227], a[28:31], v[48:51]
    s_waitcnt lgkmcnt(4)
    buffer_store_dwordx4 a[96:99], v12, s[48:51], s13 offen offset:1024 sc1
    v_mfma_f32_16x16x32_bf16 v[56:59], v[220:223], a[88:91], v[56:59]
    ds_read_b64_tr_b16 v[212:213], v17 offset:49152
    v_mfma_f32_16x16x32_bf16 v[56:59], v[224:227], a[92:95], v[56:59]
    buffer_load_dwordx4 v10, s[44:47], s71 offen offset:1024 lds
    v_mfma_f32_16x16x32_bf16 v[64:67], v[220:223], a[152:155], v[64:67]
    s_sub_u32 s72, s0, 1920
    ds_read_b64_tr_b16 v[214:215], v17 offset:57344
    v_mfma_f32_16x16x32_bf16 v[64:67], v[224:227], a[156:159], v[64:67]
    ds_read_b64_tr_b16 v[216:217], v17 offset:50176
    ds_read_b64_tr_b16 v[218:219], v17 offset:58368
    v_mfma_f32_16x16x32_bf16 v[72:75], v[220:223], a[216:219], v[72:75]
    v_mfma_f32_16x16x32_bf16 v[72:75], v[224:227], a[220:223], v[72:75]
    s_waitcnt lgkmcnt(4)
    v_mfma_f32_16x16x32_bf16 v[108:111], v[204:207], a[36:39], v[108:111]
    ds_read_b64_tr_b16 v[220:221], v9 offset:0
    v_mfma_f32_16x16x32_bf16 v[108:111], v[208:211], a[32:35], v[108:111]
    s_waitcnt vmcnt(7)
    v_cmp_gt_u32 vcc, 4, v254
    s_nop 0
    s_cbranch_vccnz L_sp_hb
L_bk_hb:
    v_mfma_f32_16x16x32_bf16 v[116:119], v[204:207], a[100:103], v[116:119]
    buffer_load_dwordx4 v10, s[44:47], s72 offen offset:2048 lds
    v_mfma_f32_16x16x32_bf16 v[116:119], v[208:211], a[96:99], v[116:119]
    s_add_u32 s73, s0, 33920
    v_mfma_f32_16x16x32_bf16 v[124:127], v[204:207], a[164:167], v[124:127]
    ds_read_b64_tr_b16 v[224:225], v9 offset:32
    v_mfma_f32_16x16x32_bf16 v[124:127], v[208:211], a[160:163], v[124:127]
    v_mfma_f32_16x16x32_bf16 v[132:135], v[204:207], a[228:231], v[132:135]
    v_mfma_f32_16x16x32_bf16 v[132:135], v[208:211], a[224:227], v[132:135]
    s_waitcnt lgkmcnt(2)
    v_mfma_f32_16x16x32_bf16 v[112:115], v[212:215], a[36:39], v[112:115]
    ds_read_b64_tr_b16 v[204:205], v16 offset:51200
    v_mfma_f32_16x16x32_bf16 v[112:115], v[216:219], a[32:35], v[112:115]
    buffer_load_dwordx4 v10, s[44:47], s73 offen offset:3072 lds
    v_mfma_f32_16x16x32_bf16 v[120:123], v[212:215], a[100:103], v[120:123]
    s_lshl_b32 s3, s52, 11
    ds_read_b64_tr_b16 v[206:207], v16 offset:59392
    v_mfma_f32_16x16x32_bf16 v[120:123], v[216:219], a[96:99], v[120:123]
    s_add_u32 s56, s3, 114688
    ds_read_b64_tr_b16 v[208:209], v16 offset:52224
    v_mfma_f32_16x16x32_bf16 v[128:131], v[212:215], a[164:167], v[128:131]
    s_add_u32 s3, s14, 49152
    ds_read_b64_tr_b16 v[210:211], v16 offset:60416
    v_mfma_f32_16x16x32_bf16 v[128:131], v[216:219], a[160:163], v[128:131]
    s_mov_b32 m0, s56
    v_mfma_f32_16x16x32_bf16 v[136:139], v[212:215], a[228:231], v[136:139]
    buffer_load_dwordx4 v12, s[48:51], s3 offen offset:0 sc1 lds
    v_mfma_f32_16x16x32_bf16 v[136:139], v[216:219], a[224:227], v[136:139]
    s_waitcnt lgkmcnt(5)
    v_mfma_f32_16x16x16_bf16 v[108:111], v[220:221], a[40:41], v[108:111]
    buffer_load_dwordx4 v12, s[48:51], s3 offen offset:1024 sc1 lds
    v_mfma_f32_16x16x16_bf16 v[116:119], v[220:221], a[104:105], v[116:119]
    ds_read_b64_tr_b16 v[212:213], v17 offset:51200
    v_mfma_f32_16x16x16_bf16 v[124:127], v[220:221], a[168:169], v[124:127]
    ds_read_b64_tr_b16 v[214:215], v17 offset:59392
    v_mfma_f32_16x16x16_bf16 v[132:135], v[220:221], a[232:233], v[132:135]
    s_waitcnt lgkmcnt(6)
    ds_read_b64_tr_b16 v[216:217], v17 offset:52224
    v_mfma_f32_16x16x16_bf16 v[112:115], v[224:225], a[40:41], v[112:115]
    ds_read_b64_tr_b16 v[218:219], v17 offset:60416
    v_mfma_f32_16x16x16_bf16 v[120:123], v[224:225], a[104:105], v[120:123]
    v_mfma_f32_16x16x16_bf16 v[128:131], v[224:225], a[168:169], v[128:131]
    v_mfma_f32_16x16x16_bf16 v[136:139], v[224:225], a[232:233], v[136:139]
    s_waitcnt lgkmcnt(4)
    v_subrev_u32 v9, s11, v9
    v_mfma_f32_16x16x32_bf16 v[44:47], v[204:207], a[36:39], v[44:47]
    s_lshl_b32 s3, s52, 11
    s_add_u32 s56, s3, 122880
    s_lshl_b32 s82, s11, 7
    v_mfma_f32_16x16x32_bf16 v[44:47], v[208:211], a[32:35], v[44:47]
    s_waitcnt lgkmcnt(0)
    s_barrier
    v_mfma_f32_16x16x32_bf16 v[52:55], v[204:207], a[100:103], v[52:55]
    s_add_u32 s3, s14, 57344
    ds_read_b64_tr_b16 v[220:221], v16 offset:0
    s_add_u32 s82, s82, s62
    v_mfma_f32_16x16x32_bf16 v[52:55], v[208:211], a[96:99], v[52:55]
    s_mov_b32 m0, s56
    ds_read_b64_tr_b16 v[222:223], v16 offset:8192
    s_sub_u32 s83, s82, s65
    v_mfma_f32_16x16x32_bf16 v[60:63], v[204:207], a[164:167], v[60:63]
    buffer_load_dwordx4 v12, s[48:51], s3 offen offset:0 sc1 lds
    v_mfma_f32_16x16x32_bf16 v[60:63], v[208:211], a[160:163], v[60:63]
    s_add_u32 s83, s83, 1024
    ds_read_b64_tr_b16 v[224:225], v16 offset:1024
    ds_read_b64_tr_b16 v[226:227], v16 offset:9216
    v_mfma_f32_16x16x32_bf16 v[68:71], v[204:207], a[228:231], v[68:71]
    s_add_u32 s82, s82, s65
    v_cvt_pk_bf16_f32 v108, v108, v109
    v_cvt_pk_bf16_f32 v109, v110, v111
    v_mfma_f32_16x16x32_bf16 v[68:71], v[208:211], a[224:227], v[68:71]
    v_cvt_pk_bf16_f32 v110, v112, v113
    v_cvt_pk_bf16_f32 v111, v114, v115
    v_mfma_f32_16x16x32_bf16 v[48:51], v[212:215], a[36:39], v[48:51]
    buffer_store_dwordx4 v[108:111], v18, s[48:51], s82 offen sc1
    v_mfma_f32_16x16x32_bf16 v[48:51], v[216:219], a[32:35], v[48:51]
    buffer_load_dwordx4 v12, s[48:51], s3 offen offset:1024 sc1 lds
    v_mfma_f32_16x16x32_bf16 v[56:59], v[212:215], a[100:103], v[56:59]
    s_add_u32 m0, s55, 49152
    ds_read_b64_tr_b16 v[204:205], v17 offset:0
    v_cvt_pk_bf16_f32 v116, v116, v117
    v_mfma_f32_16x16x32_bf16 v[56:59], v[216:219], a[96:99], v[56:59]
    s_add_u32 s70, s0, 73856
    ds_read_b64_tr_b16 v[206:207], v17 offset:8192
    v_cvt_pk_bf16_f32 v117, v118, v119
    v_mfma_f32_16x16x32_bf16 v[64:67], v[212:215], a[164:167], v[64:67]
    s_waitcnt vmcnt(8)
    ds_read_b64_tr_b16 v[208:209], v17 offset:1024
    v_cvt_pk_bf16_f32 v118, v120, v121
    v_mfma_f32_16x16x32_bf16 v[64:67], v[216:219], a[160:163], v[64:67]
    buffer_store_dword v255, off, s[48:51], s17 sc1
    v_mfma_f32_16x16x32_bf16 v[72:75], v[212:215], a[228:231], v[72:75]
    buffer_load_dwordx4 v10, s[44:47], s70 offen offset:0 lds
    v_mfma_f32_16x16x32_bf16 v[72:75], v[216:219], a[224:227], v[72:75]
    s_waitcnt lgkmcnt(3)
    ds_read_b64_tr_b16 v[210:211], v17 offset:9216
    v_cvt_pk_bf16_f32 v119, v122, v123
    v_mfma_f32_16x16x32_bf16 v[76:79], v[220:223], a[0:3], 0
    s_add_u32 s71, s0, 109696
    ds_read_b64_tr_b16 v[212:213], v16 offset:2048
    v_cvt_pk_bf16_f32 v124, v124, v125
    v_mfma_f32_16x16x32_bf16 v[76:79], v[224:227], a[4:7], v[76:79]
    buffer_store_dwordx4 v[116:119], v18, s[48:51], s83 offen sc1
    v_mfma_f32_16x16x32_bf16 v[84:87], v[220:223], a[64:67], 0
    buffer_load_dwordx4 v10, s[44:47], s71 offen offset:1024 lds
    v_mfma_f32_16x16x32_bf16 v[84:87], v[224:227], a[68:71], v[84:87]
    s_add_u32 s72, s0, 145536
    ds_read_b64_tr_b16 v[214:215], v16 offset:10240
    v_cvt_pk_bf16_f32 v125, v126, v127
    v_mfma_f32_16x16x32_bf16 v[92:95], v[220:223], a[128:131], 0
    s_mov_b32 s28, s18
    ds_read_b64_tr_b16 v[216:217], v16 offset:3072
    v_cvt_pk_bf16_f32 v126, v128, v129
    v_mfma_f32_16x16x32_bf16 v[92:95], v[224:227], a[132:135], v[92:95]
    s_mov_b32 s29, s19
    ds_read_b64_tr_b16 v[218:219], v16 offset:11264
    v_cvt_pk_bf16_f32 v127, v130, v131
    v_mfma_f32_16x16x32_bf16 v[100:103], v[220:223], a[192:195], 0
    buffer_store_dwordx4 v[124:127], v19, s[48:51], s82 offen sc1
    v_mfma_f32_16x16x32_bf16 v[100:103], v[224:227], a[196:199], v[100:103]
    s_waitcnt lgkmcnt(4)
    v_cvt_pk_bf16_f32 v132, v132, v133
    v_cvt_pk_bf16_f32 v133, v134, v135
    v_mfma_f32_16x16x32_bf16 v[80:83], v[204:207], a[0:3], 0
    buffer_load_dwordx4 v10, s[44:47], s72 offen offset:2048 lds
    v_mfma_f32_16x16x32_bf16 v[80:83], v[208:211], a[4:7], v[80:83]
    s_add_u32 s73, s0, 181376
    ds_read_b64_tr_b16 v[220:221], v17 offset:2048
    v_cvt_pk_bf16_f32 v134, v136, v137
    v_mfma_f32_16x16x32_bf16 v[88:91], v[204:207], a[64:67], 0
    s_mov_b32 s30, 2359296
    ds_read_b64_tr_b16 v[222:223], v17 offset:10240
    v_cvt_pk_bf16_f32 v135, v138, v139
    v_mfma_f32_16x16x32_bf16 v[88:91], v[208:211], a[68:71], v[88:91]
    buffer_store_dwordx4 v[132:135], v19, s[48:51], s83 offen sc1
    v_mfma_f32_16x16x32_bf16 v[96:99], v[204:207], a[128:131], 0
    buffer_load_dwordx4 v10, s[44:47], s73 offen offset:3072 lds
    v_mfma_f32_16x16x32_bf16 v[96:99], v[208:211], a[132:135], v[96:99]
    s_lshl_b32 s3, s52, 11
    ds_read_b64_tr_b16 v[224:225], v17 offset:3072
    ds_read_b64_tr_b16 v[226:227], v17 offset:11264
    v_mfma_f32_16x16x32_bf16 v[104:107], v[204:207], a[192:195], 0
    s_add_u32 s56, s3, 139264
    s_add_u32 s3, s14, 73728
    v_mov_b32 v255, 6
    v_mfma_f32_16x16x32_bf16 v[104:107], v[208:211], a[196:199], v[104:107]
    s_waitcnt lgkmcnt(4)
    s_mov_b32 s31, 0x20000
    s_mul_i32 s64, s54, 151808
    v_mfma_f32_16x16x32_bf16 v[76:79], v[212:215], a[8:11], v[76:79]
    s_mov_b32 m0, s56
    s_lshl_b32 s66, s53, 10
    s_lshl_b32 s68, s54, 3
    v_mfma_f32_16x16x32_bf16 v[76:79], v[216:219], a[12:15], v[76:79]
    buffer_load_dwordx4 v12, s[48:51], s3 offen offset:0 sc1 lds
    v_mfma_f32_16x16x32_bf16 v[84:87], v[212:215], a[72:75], v[84:87]
    s_waitcnt vmcnt(12) lgkmcnt(0)
    s_barrier
    v_mfma_f32_16x16x32_bf16 v[84:87], v[216:219], a[76:79], v[84:87]
    s_add_u32 s64, s64, s66
    ds_read_b64_tr_b16 v[204:205], v16 offset:16384
    ds_read_b128 v[156:159], v12 offset:49152
    v_mfma_f32_16x16x32_bf16 v[92:95], v[212:215], a[136:139], v[92:95]
    s_add_u32 s64, s64, 1048576
    ds_read_b64_tr_b16 v[206:207], v16 offset:24576
    ds_read_b128 v[160:163], v12 offset:50176
    v_mfma_f32_16x16x32_bf16 v[92:95], v[216:219], a[140:143], v[92:95]
    s_and_b32 s66, s53, 7
    ds_read_b64_tr_b16 v[208:209], v16 offset:17408
    ds_read_b64_tr_b16 v[210:211], v16 offset:25600
    v_mfma_f32_16x16x32_bf16 v[100:103], v[212:215], a[200:203], v[100:103]
    buffer_load_dwordx4 v12, s[48:51], s3 offen offset:1024 sc1 lds
    v_mfma_f32_16x16x32_bf16 v[100:103], v[216:219], a[204:207], v[100:103]
    ds_read_b128 v[164:167], v13 offset:49152
    ds_read_b128 v[168:171], v13 offset:50176
    v_mfma_f32_16x16x32_bf16 v[80:83], v[220:223], a[8:11], v[80:83]
    s_add_u32 m0, s55, 0
    ds_read_b64_tr_b16 v[212:213], v17 offset:16384
    s_add_u32 s66, s66, s68
    v_mfma_f32_16x16x32_bf16 v[80:83], v[224:227], a[12:15], v[80:83]
    s_add_u32 s70, s0, 147456
    ds_read_b64_tr_b16 v[214:215], v17 offset:24576
    s_mul_i32 s66, s66, 18432
    v_mfma_f32_16x16x32_bf16 v[88:91], v[220:223], a[72:75], v[88:91]
    s_lshr_b32 s68, s53, 3
    ds_read_b64_tr_b16 v[216:217], v17 offset:17408
    v_and_b32 v14, 15, v0
    v_mfma_f32_16x16x32_bf16 v[88:91], v[224:227], a[76:79], v[88:91]
    buffer_load_dword v254, v253, s[48:51], s15 offen sc1
    v_mfma_f32_16x16x32_bf16 v[96:99], v[220:223], a[136:139], v[96:99]
    buffer_load_dwordx4 v10, s[44:47], s70 offen offset:0 lds
    v_mfma_f32_16x16x32_bf16 v[96:99], v[224:227], a[140:143], v[96:99]
    s_add_u32 s71, s0, 183296
    ds_read_b64_tr_b16 v[218:219], v17 offset:25600
    s_lshl_b32 s57, s68, 6
    v_mfma_f32_16x16x32_bf16 v[104:107], v[220:223], a[200:203], v[104:107]
    s_add_u32 s66, s66, s57
    v_lshlrev_b32 v14, 9, v14
    s_bfe_u32 s57, s53, 0x10002
    v_mfma_f32_16x16x32_bf16 v[104:107], v[224:227], a[204:207], v[104:107]
    s_waitcnt lgkmcnt(6)
    s_lshl_b32 s57, s57, 1
    s_add_u32 s58, s66, 512
    v_mfma_f32_16x16x32_bf16 v[76:79], v[204:207], a[16:19], v[76:79]
    s_add_u32 s68, s68, s57
    ds_read_b64_tr_b16 v[220:221], v16 offset:18432
    s_lshr_b32 s63, s52, 1
    v_mfma_f32_16x16x32_bf16 v[76:79], v[208:211], a[20:23], v[76:79]
    buffer_load_dwordx4 v10, s[44:47], s71 offen offset:1024 lds
    v_mfma_f32_16x16x32_bf16 v[84:87], v[204:207], a[80:83], v[84:87]
    s_add_u32 s72, s0, 219136
    ds_read_b64_tr_b16 v[222:223], v16 offset:26624
    s_lshl_b32 s57, s54, 6
    v_mfma_f32_16x16x32_bf16 v[84:87], v[208:211], a[84:87], v[84:87]
    s_add_u32 s68, s68, s57
    ds_read_b64_tr_b16 v[224:225], v16 offset:19456
    s_mul_i32 s67, s63, 640
    v_mfma_f32_16x16x32_bf16 v[92:95], v[204:207], a[144:147], v[92:95]
    s_lshl_b32 s68, s68, 7
    ds_read_b64_tr_b16 v[226:227], v16 offset:27648
    s_and_b32 s57, s52, 1
    v_mfma_f32_16x16x32_bf16 v[92:95], v[208:211], a[148:151], v[92:95]
    s_add_u32 s68, s68, 58720256
    s_lshl_b32 s57, s57, 6
    s_add_u32 s67, s67, s66
    v_mfma_f32_16x16x32_bf16 v[100:103], v[204:207], a[208:211], v[100:103]
    buffer_load_dwordx4 v10, s[44:47], s72 offen offset:2048 lds
    v_mfma_f32_16x16x32_bf16 v[100:103], v[208:211], a[212:215], v[100:103]
    s_waitcnt lgkmcnt(4)
    v_add_u32 v36, s57, v0
    s_and_b32 s57, s52, 3
    v_mfma_f32_16x16x32_bf16 v[80:83], v[212:215], a[16:19], v[80:83]
    s_add_u32 s73, s0, 254976
    ds_read_b64_tr_b16 v[204:205], v17 offset:18432
    v_lshlrev_b32 v36, 3, v36
    v_mfma_f32_16x16x32_bf16 v[80:83], v[216:219], a[20:23], v[80:83]
    s_lshl_b32 s57, s57, 6
    ds_read_b64_tr_b16 v[206:207], v17 offset:26624
    v_bfe_u32 v37, v36, 4, 4
    v_mfma_f32_16x16x32_bf16 v[88:91], v[212:215], a[80:83], v[88:91]
    s_add_u32 s67, s67, 0
    ds_read_b64_tr_b16 v[208:209], v17 offset:19456
    v_mul_u32_u24 v37, 1152, v37
    v_mfma_f32_16x16x32_bf16 v[88:91], v[216:219], a[84:87], v[88:91]
    buffer_load_dwordx4 v10, s[44:47], s73 offen offset:3072 lds
    v_mfma_f32_16x16x32_bf16 v[96:99], v[212:215], a[144:147], v[96:99]
    s_lshl_b32 s3, s52, 11
    ds_read_b64_tr_b16 v[210:211], v17 offset:27648
    v_lshrrev_b32 v40, 8, v36
    v_mfma_f32_16x16x32_bf16 v[96:99], v[216:219], a[148:151], v[96:99]
    s_add_u32 s56, s3, 147456
    s_add_u32 s3, s14, 81920
    v_lshl_add_u32 v37, v40, 3, v37
    v_mfma_f32_16x16x32_bf16 v[104:107], v[212:215], a[208:211], v[104:107]
    s_mov_b32 m0, s56
    v_bfe_u32 v40, v36, 3, 1
    v_add_u32 v38, s57, v0
    v_mfma_f32_16x16x32_bf16 v[104:107], v[216:219], a[212:215], v[104:107]
    s_waitcnt lgkmcnt(4)
    v_lshl_add_u32 v37, v40, 5, v37
    v_lshlrev_b32 v38, 2, v38
    v_mfma_f32_16x16x32_bf16 v[76:79], v[220:223], a[24:27], v[76:79]
    buffer_load_dwordx4 v15, s[48:51], s3 offen offset:0 sc1 lds
    v_mfma_f32_16x16x32_bf16 v[76:79], v[224:227], a[28:31], v[76:79]
    s_waitcnt vmcnt(16) lgkmcnt(0)
    s_barrier
    v_mfma_f32_16x16x32_bf16 v[84:87], v[220:223], a[88:91], v[84:87]
    s_add_u32 s57, s64, 65536
    ds_read_b64_tr_b16 v[212:213], v16 offset:32768
    ds_read_b128 v[172:175], v12 offset:57344
    v_mfma_f32_16x16x32_bf16 v[84:87], v[224:227], a[92:95], v[84:87]
    s_mul_i32 s63, s63, 2510848
    ds_read_b64_tr_b16 v[214:215], v16 offset:40960
    ds_read_b128 v[176:179], v12 offset:58368
    v_mfma_f32_16x16x32_bf16 v[92:95], v[220:223], a[152:155], v[92:95]
    s_add_u32 s63, s63, s64
    ds_read_b64_tr_b16 v[216:217], v16 offset:33792
    ds_read_b128 v[180:183], v13 offset:57344
    v_mfma_f32_16x16x32_bf16 v[92:95], v[224:227], a[156:159], v[92:95]
    buffer_load_dwordx4 v15, s[48:51], s3 offen offset:1024 sc1 lds
    v_mfma_f32_16x16x32_bf16 v[100:103], v[220:223], a[216:219], v[100:103]
    s_add_u32 m0, s55, 16384
    ds_read_b64_tr_b16 v[218:219], v16 offset:41984
    ds_read_b128 v[184:187], v13 offset:58368
    v_mfma_f32_16x16x32_bf16 v[100:103], v[224:227], a[220:223], v[100:103]
L_pad10:
    s_cbranch_execz L_pad12
    v_bfe_u32 v39, v38, 4, 4
    v_lshrrev_b32 v40, 8, v38
    v_mfma_f32_16x16x32_bf16 v[80:83], v[204:207], a[24:27], v[80:83]
    s_add_u32 s70, s0, 221312
    ds_read_b64_tr_b16 v[220:221], v17 offset:32768
    v_mul_u32_u24 v39, 1152, v39
    v_mfma_f32_16x16x32_bf16 v[80:83], v[208:211], a[28:31], v[80:83]
    s_add_u32 s63, s63, 0
    ds_read_b64_tr_b16 v[222:223], v17 offset:40960
    v_lshl_add_u32 v39, v40, 3, v39
    v_mfma_f32_16x16x32_bf16 v[88:91], v[204:207], a[88:91], v[88:91]
    buffer_load_dwordx4 v10, s[44:47], s70 offen offset:0 lds
    v_mfma_f32_16x16x32_bf16 v[88:91], v[208:211], a[92:95], v[88:91]
    s_add_u32 s71, s0, 257152
    ds_read_b64_tr_b16 v[224:225], v17 offset:33792
    v_bfe_u32 v40, v38, 3, 1
    v_mfma_f32_16x16x32_bf16 v[96:99], v[204:207], a[152:155], v[96:99]
    s_lshr_b32 s86, s52, 1
    ds_read_b64_tr_b16 v[226:227], v17 offset:41984
    v_lshl_add_u32 v39, v40, 5, v39
    v_mfma_f32_16x16x32_bf16 v[96:99], v[208:211], a[156:159], v[96:99]
    s_waitcnt vmcnt(11)
    v_and_b32 v40, 4, v38
    s_mul_i32 s87, s86, 640
    v_mfma_f32_16x16x32_bf16 v[104:107], v[204:207], a[216:219], v[104:107]
    buffer_store_dword v255, off, s[48:51], s17 sc1
    v_mfma_f32_16x16x32_bf16 v[104:107], v[208:211], a[220:223], v[104:107]
    s_waitcnt lgkmcnt(5)
    v_add_u32 v39, v40, v39
    s_add_u32 s87, s87, s66
    v_mfma_f32_16x16x32_bf16 v[76:79], v[212:215], a[36:39], v[76:79]
    buffer_load_dwordx4 v10, s[44:47], s71 offen offset:1024 lds
    v_mfma_f32_16x16x32_bf16 v[76:79], v[216:219], a[32:35], v[76:79]
    s_sub_u32 s72, s10, 2048
    ds_read_b64_tr_b16 v[204:205], v16 offset:34816
    s_add_u32 s87, s87, 128
    v_mfma_f32_16x16x32_bf16 v[84:87], v[212:215], a[100:103], v[84:87]
    s_mul_i32 s86, s86, 2510848
    ds_read_b64_tr_b16 v[206:207], v16 offset:43008
    s_lshr_b32 s36, s52, 1
    v_mfma_f32_16x16x32_bf16 v[84:87], v[216:219], a[96:99], v[84:87]
    s_add_u32 s86, s86, s64
    ds_read_b64_tr_b16 v[208:209], v16 offset:35840
    s_mul_i32 s37, s36, 640
    v_mfma_f32_16x16x32_bf16 v[92:95], v[212:215], a[164:167], v[92:95]
    s_add_u32 s86, s86, 16384
    ds_read_b64_tr_b16 v[210:211], v16 offset:44032
    s_add_u32 s37, s37, s66
    v_mfma_f32_16x16x32_bf16 v[92:95], v[216:219], a[160:163], v[92:95]
    buffer_load_dwordx4 v10, s[32:35], s72 offen offset:2048 lds
    v_mfma_f32_16x16x32_bf16 v[100:103], v[212:215], a[228:231], v[100:103]
    s_sub_u32 s73, s1, 3072
    s_waitcnt vmcnt(10)
    v_cmp_gt_u32 vcc, 5, v254
    s_nop 0
    s_cbranch_vccnz L_sp_hc
L_bk_hc:
    v_mfma_f32_16x16x32_bf16 v[100:103], v[216:219], a[224:227], v[100:103]
    s_waitcnt lgkmcnt(4)
    s_add_u32 s37, s37, 256
    s_mul_i32 s36, s36, 2510848
    v_mfma_f32_16x16x32_bf16 v[80:83], v[220:223], a[36:39], v[80:83]
    s_add_u32 s36, s36, s64
    ds_read_b64_tr_b16 v[212:213], v17 offset:34816
    s_lshr_b32 s38, s52, 1
    v_mfma_f32_16x16x32_bf16 v[80:83], v[224:227], a[32:35], v[80:83]
    s_add_u32 s36, s36, 32768
    ds_read_b64_tr_b16 v[214:215], v17 offset:43008
    s_mul_i32 s39, s38, 640
    v_mfma_f32_16x16x32_bf16 v[88:91], v[220:223], a[100:103], v[88:91]
    buffer_load_dwordx4 v10, s[44:47], s73 offen offset:3072 lds
    v_mfma_f32_16x16x32_bf16 v[88:91], v[224:227], a[96:99], v[88:91]
    s_lshl_b32 s3, s52, 11
    ds_read_b64_tr_b16 v[216:217], v17 offset:35840
    s_add_u32 s39, s39, s66
    v_mfma_f32_16x16x32_bf16 v[96:99], v[220:223], a[164:167], v[96:99]
    s_add_u32 s56, s3, 131072
    ds_read_b64_tr_b16 v[218:219], v17 offset:44032
    s_add_u32 s39, s39, 384
    v_mfma_f32_16x16x32_bf16 v[96:99], v[224:227], a[160:163], v[96:99]
    s_add_u32 s3, s14, 65536
    s_mul_i32 s38, s38, 2510848
    s_lshl_b32 s40, s54, 4
    v_mfma_f32_16x16x32_bf16 v[104:107], v[220:223], a[228:231], v[104:107]
    s_mov_b32 m0, s56
    s_add_u32 s38, s38, s64
    v_mfma_f32_16x16x32_bf16 v[104:107], v[224:227], a[224:227], v[104:107]
    s_waitcnt lgkmcnt(4)
    s_add_u32 s38, s38, 49152
    s_lshr_b32 s38, s52, 1
    v_mfma_f32_16x16x32_bf16 v[76:79], v[204:207], a[44:47], v[76:79]
    buffer_load_dwordx4 v12, s[48:51], s3 offen offset:0 sc1 lds
    v_mfma_f32_16x16x32_bf16 v[76:79], v[208:211], a[48:51], v[76:79]
    s_waitcnt lgkmcnt(0)
    s_barrier
    v_mfma_f32_16x16x32_bf16 v[84:87], v[204:207], a[108:111], v[84:87]
    s_add_u32 s38, s38, s40
    ds_read_b64_tr_b16 v[220:221], v16 offset:49152
    ds_read_b128 v[20:23], v6 offset:8192
    v_mfma_f32_16x16x32_bf16 v[84:87], v[208:211], a[112:115], v[84:87]
    s_mul_i32 s38, s38, 90368
    ds_read_b64_tr_b16 v[222:223], v16 offset:57344
    ds_read_b128 v[24:27], v6 offset:9216
    v_mfma_f32_16x16x32_bf16 v[92:95], v[204:207], a[172:175], v[92:95]
    s_lshl_b32 s40, s53, 10
    ds_read_b64_tr_b16 v[224:225], v16 offset:50176
    ds_read_b128 v[28:31], v7 offset:8192
    v_mfma_f32_16x16x32_bf16 v[92:95], v[208:211], a[176:179], v[92:95]
    buffer_load_dwordx4 v12, s[48:51], s3 offen offset:1024 sc1 lds
    v_mfma_f32_16x16x32_bf16 v[100:103], v[204:207], a[236:239], v[100:103]
    s_add_u32 m0, s55, 32768
    ds_read_b64_tr_b16 v[226:227], v16 offset:58368
    ds_read_b128 v[32:35], v7 offset:9216
    v_mfma_f32_16x16x32_bf16 v[100:103], v[208:211], a[240:243], v[100:103]
    s_add_u32 s38, s38, s40
    v_mfma_f32_16x16x32_bf16 v[80:83], v[212:215], a[44:47], v[80:83]
    s_add_u32 s70, s10, 128
    ds_read_b64_tr_b16 v[204:205], v17 offset:49152
    s_add_u32 s38, s38, 67108864
    v_mfma_f32_16x16x32_bf16 v[80:83], v[216:219], a[48:51], v[80:83]
    ds_read_b64_tr_b16 v[206:207], v17 offset:57344
    v_mfma_f32_16x16x32_bf16 v[88:91], v[212:215], a[108:111], v[88:91]
    buffer_load_dwordx4 v10, s[32:35], s70 offen offset:0 lds
    v_mfma_f32_16x16x32_bf16 v[88:91], v[216:219], a[112:115], v[88:91]
    s_sub_u32 s71, s1, 896
    ds_read_b64_tr_b16 v[208:209], v17 offset:50176
    v_mfma_f32_16x16x32_bf16 v[96:99], v[212:215], a[172:175], v[96:99]
    ds_read_b64_tr_b16 v[210:211], v17 offset:58368
    v_mfma_f32_16x16x32_bf16 v[96:99], v[216:219], a[176:179], v[96:99]
    buffer_load_dword v230, v39, s[24:27], s58 offen
    v_mfma_f32_16x16x32_bf16 v[104:107], v[212:215], a[236:239], v[104:107]
    buffer_load_dwordx2 v[240:241], v37, s[24:27], s67 offen
    v_mfma_f32_16x16x32_bf16 v[104:107], v[216:219], a[240:243], v[104:107]
    s_waitcnt lgkmcnt(5)
    v_mfma_f32_16x16x32_bf16 v[76:79], v[220:223], a[52:55], v[76:79]
    buffer_load_dwordx4 v10, s[44:47], s71 offen offset:1024 lds
    v_mfma_f32_16x16x32_bf16 v[76:79], v[224:227], a[56:59], v[76:79]
    s_sub_u32 s72, s59, 1792
    ds_read_b64_tr_b16 v[212:213], v16 offset:51200
    v_mfma_f32_16x16x32_bf16 v[84:87], v[220:223], a[116:119], v[84:87]
    ds_read_b64_tr_b16 v[214:215], v16 offset:59392
    v_mfma_f32_16x16x32_bf16 v[84:87], v[224:227], a[120:123], v[84:87]
    ds_read_b64_tr_b16 v[216:217], v16 offset:52224
    v_mfma_f32_16x16x32_bf16 v[92:95], v[220:223], a[180:183], v[92:95]
    ds_read_b64_tr_b16 v[218:219], v16 offset:60416
    v_mfma_f32_16x16x32_bf16 v[92:95], v[224:227], a[184:187], v[92:95]
    buffer_load_dwordx4 v10, s[44:47], s72 offen offset:2048 lds
    v_mfma_f32_16x16x32_bf16 v[100:103], v[220:223], a[244:247], v[100:103]
    s_add_u32 s73, s59, 34048
    v_mfma_f32_16x16x32_bf16 v[100:103], v[224:227], a[248:251], v[100:103]
    s_waitcnt lgkmcnt(4)
    v_mfma_f32_16x16x32_bf16 v[80:83], v[204:207], a[52:55], v[80:83]
    ds_read_b64_tr_b16 v[220:221], v17 offset:51200
    v_mfma_f32_16x16x32_bf16 v[80:83], v[208:211], a[56:59], v[80:83]
    ds_read_b64_tr_b16 v[222:223], v17 offset:59392
    v_mfma_f32_16x16x32_bf16 v[88:91], v[204:207], a[116:119], v[88:91]
    buffer_load_dwordx4 v10, s[44:47], s73 offen offset:3072 lds
    v_mfma_f32_16x16x32_bf16 v[88:91], v[208:211], a[120:123], v[88:91]
    ds_read_b64_tr_b16 v[224:225], v17 offset:52224
    v_mfma_f32_16x16x32_bf16 v[96:99], v[204:207], a[180:183], v[96:99]
    ds_read_b64_tr_b16 v[226:227], v17 offset:60416
    v_mfma_f32_16x16x32_bf16 v[96:99], v[208:211], a[184:187], v[96:99]
    buffer_load_dwordx2 v[248:249], v37, s[24:27], s87 offen
    v_mfma_f32_16x16x32_bf16 v[104:107], v[204:207], a[244:247], v[104:107]
    buffer_load_dwordx2 v[250:251], v37, s[24:27], s37 offen
    v_mfma_f32_16x16x32_bf16 v[104:107], v[208:211], a[248:251], v[104:107]
    s_waitcnt lgkmcnt(4)
    v_mfma_f32_16x16x32_bf16 v[76:79], v[212:215], a[60:63], v[76:79]
    v_mfma_f32_16x16x32_bf16 v[76:79], v[216:219], v[140:143], v[76:79]
    s_waitcnt vmcnt(15) lgkmcnt(0)
    s_barrier
    v_mfma_f32_16x16x32_bf16 v[84:87], v[212:215], a[124:127], v[84:87]
    s_add_u32 m0, s55, 49152
    ds_read_b64_tr_b16 v[204:205], v16 offset:0
    ds_read_b64 a[42:43], v6 offset:16384
    v_mfma_f32_16x16x32_bf16 v[84:87], v[216:219], v[144:147], v[84:87]
    s_add_u32 s70, s59, 73984
    ds_read_b64_tr_b16 v[206:207], v16 offset:8192
    ds_read_b64 a[106:107], v6 offset:17408
    v_mfma_f32_16x16x32_bf16 v[92:95], v[212:215], a[188:191], v[92:95]
    buffer_load_dwordx4 v10, s[44:47], s70 offen offset:0 lds
    v_mfma_f32_16x16x32_bf16 v[92:95], v[216:219], v[148:151], v[92:95]
    s_add_u32 s71, s59, 109824
    ds_read_b64_tr_b16 v[208:209], v16 offset:1024
    ds_read_b64_tr_b16 v[210:211], v16 offset:9216
    v_mfma_f32_16x16x32_bf16 v[100:103], v[212:215], a[252:255], v[100:103]
    ds_read_b64 a[170:171], v7 offset:16384
    ds_read_b64 a[234:235], v7 offset:17408
    v_mfma_f32_16x16x32_bf16 v[100:103], v[216:219], v[152:155], v[100:103]
    v_mfma_f32_16x16x32_bf16 v[80:83], v[220:223], a[60:63], v[80:83]
    ds_read_b64_tr_b16 v[212:213], v17 offset:0
    v_mfma_f32_16x16x32_bf16 v[80:83], v[224:227], v[140:143], v[80:83]
    ds_read_b64_tr_b16 v[214:215], v17 offset:8192
    v_mfma_f32_16x16x32_bf16 v[88:91], v[220:223], a[124:127], v[88:91]
    ds_read_b64_tr_b16 v[216:217], v17 offset:1024
    v_mfma_f32_16x16x32_bf16 v[88:91], v[224:227], v[144:147], v[88:91]
    buffer_load_dwordx4 v10, s[44:47], s71 offen offset:1024 lds
    v_mfma_f32_16x16x32_bf16 v[96:99], v[220:223], a[188:191], v[96:99]
    s_add_u32 s72, s59, 145664
    ds_read_b64_tr_b16 v[218:219], v17 offset:9216
    v_mfma_f32_16x16x32_bf16 v[96:99], v[224:227], v[148:151], v[96:99]
    v_mfma_f32_16x16x32_bf16 v[104:107], v[220:223], a[252:255], v[104:107]
    v_mfma_f32_16x16x32_bf16 v[104:107], v[224:227], v[152:155], v[104:107]
    s_waitcnt lgkmcnt(6)
    v_mfma_f32_16x16x32_bf16 v[44:47], v[204:207], a[60:63], v[44:47]
    ds_read_b64_tr_b16 v[220:221], v16 offset:2048
    v_mfma_f32_16x16x32_bf16 v[44:47], v[208:211], v[140:143], v[44:47]
    ds_read_b64_tr_b16 v[222:223], v16 offset:10240
    v_mfma_f32_16x16x32_bf16 v[52:55], v[204:207], a[124:127], v[52:55]
    buffer_load_dwordx4 v10, s[44:47], s72 offen offset:2048 lds
    v_mfma_f32_16x16x32_bf16 v[52:55], v[208:211], v[144:147], v[52:55]
    s_add_u32 s73, s59, 181504
    ds_read_b64_tr_b16 v[224:225], v16 offset:3072
    v_mfma_f32_16x16x32_bf16 v[60:63], v[204:207], a[188:191], v[60:63]
    ds_read_b64_tr_b16 v[226:227], v16 offset:11264
    v_mfma_f32_16x16x32_bf16 v[60:63], v[208:211], v[148:151], v[60:63]
    v_mfma_f32_16x16x32_bf16 v[68:71], v[204:207], a[252:255], v[68:71]
    v_mfma_f32_16x16x32_bf16 v[68:71], v[208:211], v[152:155], v[68:71]
    s_waitcnt lgkmcnt(4)
    v_mfma_f32_16x16x32_bf16 v[48:51], v[212:215], a[60:63], v[48:51]
    ds_read_b64_tr_b16 v[204:205], v17 offset:2048
    v_mfma_f32_16x16x32_bf16 v[48:51], v[216:219], v[140:143], v[48:51]
    buffer_load_dwordx4 v10, s[44:47], s73 offen offset:3072 lds
    v_mfma_f32_16x16x32_bf16 v[56:59], v[212:215], a[124:127], v[56:59]
    ds_read_b64_tr_b16 v[206:207], v17 offset:10240
    v_mfma_f32_16x16x32_bf16 v[56:59], v[216:219], v[144:147], v[56:59]
    ds_read_b64_tr_b16 v[208:209], v17 offset:3072
    v_mfma_f32_16x16x32_bf16 v[64:67], v[212:215], a[188:191], v[64:67]
    ds_read_b64_tr_b16 v[210:211], v17 offset:11264
    v_mfma_f32_16x16x32_bf16 v[64:67], v[216:219], v[148:151], v[64:67]
    v_mfma_f32_16x16x32_bf16 v[72:75], v[212:215], a[252:255], v[72:75]
    v_mfma_f32_16x16x32_bf16 v[72:75], v[216:219], v[152:155], v[72:75]
    s_waitcnt lgkmcnt(4)
    v_mfma_f32_16x16x32_bf16 v[44:47], v[220:223], v[156:159], v[44:47]
    v_mfma_f32_16x16x32_bf16 v[44:47], v[224:227], v[172:175], v[44:47]
    s_waitcnt vmcnt(12) lgkmcnt(0)
    s_barrier
    v_mfma_f32_16x16x32_bf16 v[52:55], v[220:223], v[160:163], v[52:55]
    s_add_u32 m0, s55, 0
    ds_read_b64_tr_b16 v[212:213], v16 offset:16384
    ds_read_b128 v[188:191], v6 offset:0
    v_mfma_f32_16x16x32_bf16 v[52:55], v[224:227], v[176:179], v[52:55]
    s_add_u32 s70, s59, 221440
    ds_read_b64_tr_b16 v[214:215], v16 offset:24576
    ds_read_b128 v[192:195], v6 offset:1024
    v_mfma_f32_16x16x32_bf16 v[60:63], v[220:223], v[164:167], v[60:63]
    buffer_load_dwordx4 v10, s[44:47], s70 offen offset:0 lds
    v_mfma_f32_16x16x32_bf16 v[60:63], v[224:227], v[180:183], v[60:63]
    s_add_u32 s71, s59, 257280
    ds_read_b64_tr_b16 v[216:217], v16 offset:17408
    ds_read_b64_tr_b16 v[218:219], v16 offset:25600
    v_mfma_f32_16x16x32_bf16 v[68:71], v[220:223], v[168:171], v[68:71]
    ds_read_b128 v[196:199], v7 offset:0
    ds_read_b128 v[200:203], v7 offset:1024
    v_mfma_f32_16x16x32_bf16 v[68:71], v[224:227], v[184:187], v[68:71]
    v_mfma_f32_16x16x32_bf16 v[48:51], v[204:207], v[156:159], v[48:51]
    ds_read_b64_tr_b16 v[220:221], v17 offset:16384
    v_mfma_f32_16x16x32_bf16 v[48:51], v[208:211], v[172:175], v[48:51]
    ds_read_b64_tr_b16 v[222:223], v17 offset:24576
    v_mfma_f32_16x16x32_bf16 v[56:59], v[204:207], v[160:163], v[56:59]
    ds_read_b64_tr_b16 v[224:225], v17 offset:17408
    v_mfma_f32_16x16x32_bf16 v[56:59], v[208:211], v[176:179], v[56:59]
    buffer_load_dwordx4 v10, s[44:47], s71 offen offset:1024 lds
    v_mfma_f32_16x16x32_bf16 v[64:67], v[204:207], v[164:167], v[64:67]
    s_sub_u32 s72, s61, 1792
    ds_read_b64_tr_b16 v[226:227], v17 offset:25600
    v_mfma_f32_16x16x32_bf16 v[64:67], v[208:211], v[180:183], v[64:67]
    buffer_load_dwordx2 v[6:7], v37, s[24:27], s39 offen
    v_mfma_f32_16x16x32_bf16 v[72:75], v[204:207], v[168:171], v[72:75]
    v_mfma_f32_16x16x32_bf16 v[72:75], v[208:211], v[184:187], v[72:75]
    s_waitcnt lgkmcnt(6)
    v_mfma_f32_16x16x32_bf16 v[76:79], v[212:215], v[156:159], v[76:79]
    ds_read_b64_tr_b16 v[204:205], v16 offset:18432
    v_mfma_f32_16x16x32_bf16 v[76:79], v[216:219], v[172:175], v[76:79]
    ds_read_b64_tr_b16 v[206:207], v16 offset:26624
    v_mfma_f32_16x16x32_bf16 v[84:87], v[212:215], v[160:163], v[84:87]
    buffer_load_dwordx4 v10, s[32:35], s72 offen offset:2048 lds
    v_mfma_f32_16x16x32_bf16 v[84:87], v[216:219], v[176:179], v[84:87]
    s_sub_u32 s73, s60, 2816
    ds_read_b64_tr_b16 v[208:209], v16 offset:19456
    v_mfma_f32_16x16x32_bf16 v[92:95], v[212:215], v[164:167], v[92:95]
    ds_read_b64_tr_b16 v[210:211], v16 offset:27648
    v_mfma_f32_16x16x32_bf16 v[92:95], v[216:219], v[180:183], v[92:95]
    v_mfma_f32_16x16x32_bf16 v[100:103], v[212:215], v[168:171], v[100:103]
    v_mfma_f32_16x16x32_bf16 v[100:103], v[216:219], v[184:187], v[100:103]
    s_waitcnt lgkmcnt(4)
    v_mfma_f32_16x16x32_bf16 v[80:83], v[220:223], v[156:159], v[80:83]
    ds_read_b64_tr_b16 v[212:213], v17 offset:18432
    v_mfma_f32_16x16x32_bf16 v[80:83], v[224:227], v[172:175], v[80:83]
    buffer_load_dwordx4 v10, s[44:47], s73 offen offset:3072 lds
    v_mfma_f32_16x16x32_bf16 v[88:91], v[220:223], v[160:163], v[88:91]
    ds_read_b64_tr_b16 v[214:215], v17 offset:26624
    v_mfma_f32_16x16x32_bf16 v[88:91], v[224:227], v[176:179], v[88:91]
    ds_read_b64_tr_b16 v[216:217], v17 offset:19456
    v_mfma_f32_16x16x32_bf16 v[96:99], v[220:223], v[164:167], v[96:99]
    ds_read_b64_tr_b16 v[218:219], v17 offset:27648
    v_mfma_f32_16x16x32_bf16 v[96:99], v[224:227], v[180:183], v[96:99]
    v_mfma_f32_16x16x32_bf16 v[104:107], v[220:223], v[168:171], v[104:107]
    v_mfma_f32_16x16x32_bf16 v[104:107], v[224:227], v[184:187], v[104:107]
    s_waitcnt lgkmcnt(4)
    v_mfma_f32_16x16x32_bf16 v[44:47], v[204:207], v[20:23], v[44:47]
    ds_read_b64_tr_b16 v[220:221], v9 offset:0
    v_mfma_f32_16x16x32_bf16 v[44:47], v[208:211], v[188:191], v[44:47]
    ds_read_b64_tr_b16 v[222:223], v9 offset:2560
    v_mfma_f32_16x16x32_bf16 v[52:55], v[204:207], v[24:27], v[52:55]
    v_mfma_f32_16x16x32_bf16 v[52:55], v[208:211], v[192:195], v[52:55]
    v_mfma_f32_16x16x32_bf16 v[60:63], v[204:207], v[28:31], v[60:63]
    ds_read_b64_tr_b16 v[224:225], v9 offset:32
    v_mfma_f32_16x16x32_bf16 v[60:63], v[208:211], v[196:199], v[60:63]
    ds_read_b64_tr_b16 v[226:227], v9 offset:2592
    v_mfma_f32_16x16x32_bf16 v[68:71], v[204:207], v[32:35], v[68:71]
    v_mfma_f32_16x16x32_bf16 v[68:71], v[208:211], v[200:203], v[68:71]
    s_waitcnt lgkmcnt(4)
    v_mfma_f32_16x16x32_bf16 v[48:51], v[212:215], v[20:23], v[48:51]
    v_mfma_f32_16x16x32_bf16 v[48:51], v[216:219], v[188:191], v[48:51]
    v_mfma_f32_16x16x32_bf16 v[56:59], v[212:215], v[24:27], v[56:59]
    s_waitcnt vmcnt(11) lgkmcnt(0)
    s_barrier
    v_mfma_f32_16x16x32_bf16 v[56:59], v[216:219], v[192:195], v[56:59]
    s_add_u32 m0, s55, 16384
    ds_read_b64_tr_b16 v[204:205], v16 offset:32768
    v_mfma_f32_16x16x32_bf16 v[64:67], v[212:215], v[28:31], v[64:67]
    s_add_u32 s70, s0, 256
    ds_read_b64_tr_b16 v[206:207], v16 offset:40960
    v_mfma_f32_16x16x32_bf16 v[64:67], v[216:219], v[196:199], v[64:67]
    buffer_load_dwordx4 v10, s[44:47], s70 offen offset:0 lds
    v_mfma_f32_16x16x32_bf16 v[72:75], v[212:215], v[32:35], v[72:75]
    s_add_u32 s71, s0, 36096
    ds_read_b64_tr_b16 v[208:209], v16 offset:33792
    ds_read_b64_tr_b16 v[210:211], v16 offset:41984
    v_mfma_f32_16x16x32_bf16 v[72:75], v[216:219], v[200:203], v[72:75]
    v_mfma_f32_16x16x32_bf16 v[44:47], v[220:223], a[40:43], v[44:47]
    ds_read_b64_tr_b16 v[212:213], v17 offset:32768
    v_mfma_f32_16x16x32_bf16 v[52:55], v[220:223], a[104:107], v[52:55]
    ds_read_b64_tr_b16 v[214:215], v17 offset:40960
    v_mfma_f32_16x16x32_bf16 v[60:63], v[220:223], a[168:171], v[60:63]
    ds_read_b64_tr_b16 v[216:217], v17 offset:33792
    v_mfma_f32_16x16x32_bf16 v[68:71], v[220:223], a[232:235], v[68:71]
    ds_read_b64_tr_b16 v[218:219], v17 offset:41984
    v_mfma_f32_16x16x32_bf16 v[48:51], v[224:227], a[40:43], v[48:51]
    buffer_load_dwordx4 v10, s[44:47], s71 offen offset:1024 lds
    v_mfma_f32_16x16x32_bf16 v[56:59], v[224:227], a[104:107], v[56:59]
    s_add_u32 s72, s0, 71936
    v_mfma_f32_16x16x32_bf16 v[64:67], v[224:227], a[168:171], v[64:67]
    buffer_load_dword v254, v14, s[48:51], s68 offen sc1
    v_mfma_f32_16x16x32_bf16 v[72:75], v[224:227], a[232:235], v[72:75]
    s_waitcnt lgkmcnt(4)
    v_mfma_f32_16x16x32_bf16 v[76:79], v[204:207], v[20:23], v[76:79]
    s_add_u32 s84, s62, 0
    ds_read_b64_tr_b16 v[220:221], v9 offset:128
    v_mfma_f32_16x16x32_bf16 v[76:79], v[208:211], v[188:191], v[76:79]
    s_sub_u32 s85, s84, s65
    ds_read_b64_tr_b16 v[222:223], v9 offset:2688
    v_mfma_f32_16x16x32_bf16 v[84:87], v[204:207], v[24:27], v[84:87]
    s_add_u32 s85, s85, 1024
    s_add_u32 s84, s84, s65
    v_cvt_pk_bf16_f32 v44, v44, v45
    v_mfma_f32_16x16x32_bf16 v[84:87], v[208:211], v[192:195], v[84:87]
    buffer_load_dwordx4 v10, s[44:47], s72 offen offset:2048 lds
    v_mfma_f32_16x16x32_bf16 v[92:95], v[204:207], v[28:31], v[92:95]
    s_add_u32 s73, s0, 107776
    ds_read_b64_tr_b16 v[224:225], v9 offset:160
    v_cvt_pk_bf16_f32 v45, v46, v47
    v_mfma_f32_16x16x32_bf16 v[92:95], v[208:211], v[196:199], v[92:95]
    ds_read_b64_tr_b16 v[226:227], v9 offset:2720
    v_cvt_pk_bf16_f32 v46, v48, v49
    v_mfma_f32_16x16x32_bf16 v[100:103], v[204:207], v[32:35], v[100:103]
    v_cvt_pk_bf16_f32 v47, v50, v51
    v_cvt_pk_bf16_f32 v52, v52, v53
    v_mfma_f32_16x16x32_bf16 v[100:103], v[208:211], v[200:203], v[100:103]
    s_waitcnt lgkmcnt(4)
    v_cvt_pk_bf16_f32 v53, v54, v55
    v_cvt_pk_bf16_f32 v54, v56, v57
    v_mfma_f32_16x16x32_bf16 v[80:83], v[212:215], v[20:23], v[80:83]
    buffer_store_dwordx4 v[44:47], v18, s[48:51], s84 offen sc1
    v_mfma_f32_16x16x32_bf16 v[80:83], v[216:219], v[188:191], v[80:83]
    ds_read_b64_tr_b16 v[204:205], v16 offset:34816
    v_cvt_pk_bf16_f32 v55, v58, v59
    v_mfma_f32_16x16x32_bf16 v[88:91], v[212:215], v[24:27], v[88:91]
    buffer_load_dwordx4 v10, s[44:47], s73 offen offset:3072 lds
    v_mfma_f32_16x16x32_bf16 v[88:91], v[216:219], v[192:195], v[88:91]
    ds_read_b64_tr_b16 v[206:207], v16 offset:43008
    v_cvt_pk_bf16_f32 v60, v60, v61
    v_mfma_f32_16x16x32_bf16 v[96:99], v[212:215], v[28:31], v[96:99]
    buffer_store_dwordx4 v[52:55], v18, s[48:51], s85 offen sc1
    v_mfma_f32_16x16x32_bf16 v[96:99], v[216:219], v[196:199], v[96:99]
    ds_read_b64_tr_b16 v[208:209], v16 offset:35840
    ds_read_b64_tr_b16 v[210:211], v16 offset:44032
    v_mfma_f32_16x16x32_bf16 v[104:107], v[212:215], v[32:35], v[104:107]
    v_cvt_pk_bf16_f32 v61, v62, v63
    v_cvt_pk_bf16_f32 v62, v64, v65
    v_mfma_f32_16x16x32_bf16 v[104:107], v[216:219], v[200:203], v[104:107]
    s_waitcnt lgkmcnt(6)
    v_cvt_pk_bf16_f32 v63, v66, v67
    v_cvt_pk_bf16_f32 v68, v68, v69
    v_mfma_f32_16x16x32_bf16 v[76:79], v[220:223], a[40:43], v[76:79]
    buffer_store_dwordx4 v[60:63], v19, s[48:51], s84 offen sc1
    v_mfma_f32_16x16x32_bf16 v[84:87], v[220:223], a[104:107], v[84:87]
    ds_read_b64_tr_b16 v[212:213], v17 offset:34816
    v_cvt_pk_bf16_f32 v69, v70, v71
    v_mfma_f32_16x16x32_bf16 v[92:95], v[220:223], a[168:171], v[92:95]
    ds_read_b64_tr_b16 v[214:215], v17 offset:43008
    v_cvt_pk_bf16_f32 v70, v72, v73
    v_mfma_f32_16x16x32_bf16 v[100:103], v[220:223], a[232:235], v[100:103]
    s_waitcnt lgkmcnt(6)
    ds_read_b64_tr_b16 v[216:217], v17 offset:35840
    v_cvt_pk_bf16_f32 v71, v74, v75
    v_mfma_f32_16x16x32_bf16 v[80:83], v[224:227], a[40:43], v[80:83]
    buffer_store_dwordx4 v[68:71], v19, s[48:51], s85 offen sc1
    v_mfma_f32_16x16x32_bf16 v[88:91], v[224:227], a[104:107], v[88:91]
    ds_read_b64_tr_b16 v[218:219], v17 offset:44032
    v_mfma_f32_16x16x32_bf16 v[96:99], v[224:227], a[168:171], v[96:99]
    v_mfma_f32_16x16x32_bf16 v[104:107], v[224:227], a[232:235], v[104:107]
    s_waitcnt lgkmcnt(4)
    v_mfma_f32_16x16x32_bf16 v[108:111], v[204:207], a[0:3], 0
    s_add_u32 s82, s62, 16384
    v_mov_b32 v255, 8
    v_mfma_f32_16x16x32_bf16 v[108:111], v[208:211], a[4:7], v[108:111]
    s_sub_u32 s83, s82, s65
    v_mfma_f32_16x16x32_bf16 v[116:119], v[204:207], a[64:67], 0
    s_waitcnt vmcnt(14) lgkmcnt(0)
    s_barrier
    v_mfma_f32_16x16x32_bf16 v[116:119], v[208:211], a[68:71], v[116:119]
    s_add_u32 m0, s55, 32768
    ds_read_b64_tr_b16 v[220:221], v16 offset:49152
    s_add_u32 s83, s83, 1024
    v_mfma_f32_16x16x32_bf16 v[124:127], v[204:207], a[128:131], 0
    s_add_u32 s70, s0, 147712
    ds_read_b64_tr_b16 v[222:223], v16 offset:57344
    s_add_u32 s82, s82, s65
    v_mfma_f32_16x16x32_bf16 v[124:127], v[208:211], a[132:135], v[124:127]
    buffer_load_dwordx4 v10, s[44:47], s70 offen offset:0 lds
    v_mfma_f32_16x16x32_bf16 v[132:135], v[204:207], a[192:195], 0
    s_add_u32 s71, s0, 183552
    ds_read_b64_tr_b16 v[224:225], v16 offset:50176
    ds_read_b64_tr_b16 v[226:227], v16 offset:58368
    v_mfma_f32_16x16x32_bf16 v[132:135], v[208:211], a[196:199], v[132:135]
    v_cvt_pk_bf16_f32 v76, v76, v77
    v_cvt_pk_bf16_f32 v77, v78, v79
    v_mfma_f32_16x16x32_bf16 v[112:115], v[212:215], a[0:3], 0
    ds_read_b64_tr_b16 v[204:205], v17 offset:49152
    v_cvt_pk_bf16_f32 v78, v80, v81
    v_mfma_f32_16x16x32_bf16 v[112:115], v[216:219], a[4:7], v[112:115]
    ds_read_b64_tr_b16 v[206:207], v17 offset:57344
    v_cvt_pk_bf16_f32 v79, v82, v83
    v_mfma_f32_16x16x32_bf16 v[120:123], v[212:215], a[64:67], 0
    buffer_store_dwordx4 v[76:79], v18, s[48:51], s82 offen sc1
    v_mfma_f32_16x16x32_bf16 v[120:123], v[216:219], a[68:71], v[120:123]
    ds_read_b64_tr_b16 v[208:209], v17 offset:50176
    v_cvt_pk_bf16_f32 v84, v84, v85
    v_mfma_f32_16x16x32_bf16 v[128:131], v[212:215], a[128:131], 0
    buffer_load_dwordx4 v10, s[44:47], s71 offen offset:1024 lds
    v_mfma_f32_16x16x32_bf16 v[128:131], v[216:219], a[132:135], v[128:131]
    s_add_u32 s72, s0, 219392
    ds_read_b64_tr_b16 v[210:211], v17 offset:58368
    v_cvt_pk_bf16_f32 v85, v86, v87
    v_mfma_f32_16x16x32_bf16 v[136:139], v[212:215], a[192:195], 0
    v_cvt_pk_bf16_f32 v86, v88, v89
    v_cvt_pk_bf16_f32 v87, v90, v91
    v_mfma_f32_16x16x32_bf16 v[136:139], v[216:219], a[196:199], v[136:139]
    s_waitcnt lgkmcnt(4)
    v_cvt_pk_bf16_f32 v92, v92, v93
    v_cvt_pk_bf16_f32 v93, v94, v95
    v_mfma_f32_16x16x32_bf16 v[108:111], v[220:223], a[8:11], v[108:111]
    buffer_store_dwordx4 v[84:87], v18, s[48:51], s83 offen sc1
    v_mfma_f32_16x16x32_bf16 v[108:111], v[224:227], a[12:15], v[108:111]
    ds_read_b64_tr_b16 v[212:213], v16 offset:51200
    v_cvt_pk_bf16_f32 v94, v96, v97
    v_mfma_f32_16x16x32_bf16 v[116:119], v[220:223], a[72:75], v[116:119]
    ds_read_b64_tr_b16 v[214:215], v16 offset:59392
    v_cvt_pk_bf16_f32 v95, v98, v99
    v_mfma_f32_16x16x32_bf16 v[116:119], v[224:227], a[76:79], v[116:119]
    buffer_load_dwordx4 v10, s[44:47], s72 offen offset:2048 lds
    v_mfma_f32_16x16x32_bf16 v[124:127], v[220:223], a[136:139], v[124:127]
    s_add_u32 s73, s0, 255232
    ds_read_b64_tr_b16 v[216:217], v16 offset:52224
    v_cvt_pk_bf16_f32 v100, v100, v101
    v_mfma_f32_16x16x32_bf16 v[124:127], v[224:227], a[140:143], v[124:127]
    buffer_store_dwordx4 v[92:95], v19, s[48:51], s82 offen sc1
    v_mfma_f32_16x16x32_bf16 v[132:135], v[220:223], a[200:203], v[132:135]
    ds_read_b64_tr_b16 v[218:219], v16 offset:60416
    v_cvt_pk_bf16_f32 v101, v102, v103
    v_mfma_f32_16x16x32_bf16 v[132:135], v[224:227], a[204:207], v[132:135]
    s_waitcnt lgkmcnt(4)
    v_cvt_pk_bf16_f32 v102, v104, v105
    v_cvt_pk_bf16_f32 v103, v106, v107
    v_mfma_f32_16x16x32_bf16 v[112:115], v[204:207], a[8:11], v[112:115]
    ds_read_b64_tr_b16 v[220:221], v17 offset:51200
    v_mfma_f32_16x16x32_bf16 v[112:115], v[208:211], a[12:15], v[112:115]
    buffer_store_dwordx4 v[100:103], v19, s[48:51], s83 offen sc1
    v_mfma_f32_16x16x32_bf16 v[120:123], v[204:207], a[72:75], v[120:123]
    buffer_load_dwordx4 v10, s[44:47], s73 offen offset:3072 lds
    v_mfma_f32_16x16x32_bf16 v[120:123], v[208:211], a[76:79], v[120:123]
    ds_read_b64_tr_b16 v[222:223], v17 offset:59392
    v_mfma_f32_16x16x32_bf16 v[128:131], v[204:207], a[136:139], v[128:131]
    ds_read_b64_tr_b16 v[224:225], v17 offset:52224
    v_mfma_f32_16x16x32_bf16 v[128:131], v[208:211], a[140:143], v[128:131]
    ds_read_b64_tr_b16 v[226:227], v17 offset:60416
    v_mfma_f32_16x16x32_bf16 v[136:139], v[204:207], a[200:203], v[136:139]
    s_waitcnt vmcnt(14)
    v_cmp_gt_u32 vcc, 6, v254
    s_nop 0
    s_cbranch_vccnz L_sp_r0
L_bk_r0:
    v_mfma_f32_16x16x32_bf16 v[136:139], v[208:211], a[204:207], v[136:139]
    s_waitcnt lgkmcnt(4)
    v_mfma_f32_16x16x32_bf16 v[108:111], v[212:215], a[16:19], v[108:111]
    buffer_load_dword v1, v38, s[48:51], s57 offen sc1
    v_mfma_f32_16x16x32_bf16 v[108:111], v[216:219], a[20:23], v[108:111]
    s_add_u32 s57, s57, 2428928
    v_mfma_f32_16x16x32_bf16 v[116:119], v[212:215], a[80:83], v[116:119]
    s_waitcnt lgkmcnt(0)
    s_barrier
    v_mfma_f32_16x16x32_bf16 v[116:119], v[216:219], a[84:87], v[116:119]
    s_add_u32 m0, s55, 49152
    ds_read_b64_tr_b16 v[204:205], v16 offset:0
    v_mfma_f32_16x16x32_bf16 v[124:127], v[212:215], a[144:147], v[124:127]
    s_add_u32 s70, s10, 256
    ds_read_b64_tr_b16 v[206:207], v16 offset:8192
    v_mfma_f32_16x16x32_bf16 v[124:127], v[216:219], a[148:151], v[124:127]
    buffer_load_dwordx4 v10, s[32:35], s70 offen offset:0 lds
    v_mfma_f32_16x16x32_bf16 v[132:135], v[212:215], a[208:211], v[132:135]
    s_sub_u32 s71, s1, 768
    ds_read_b64_tr_b16 v[208:209], v16 offset:1024
    ds_read_b64_tr_b16 v[210:211], v16 offset:9216
    v_mfma_f32_16x16x32_bf16 v[132:135], v[216:219], a[212:215], v[132:135]
    v_mfma_f32_16x16x32_bf16 v[112:115], v[220:223], a[16:19], v[112:115]
    ds_read_b64_tr_b16 v[212:213], v17 offset:0
    v_mfma_f32_16x16x32_bf16 v[112:115], v[224:227], a[20:23], v[112:115]
    ds_read_b64_tr_b16 v[214:215], v17 offset:8192
    v_mfma_f32_16x16x32_bf16 v[120:123], v[220:223], a[80:83], v[120:123]
    ds_read_b64_tr_b16 v[216:217], v17 offset:1024
    v_mfma_f32_16x16x32_bf16 v[120:123], v[224:227], a[84:87], v[120:123]
    ds_read_b64_tr_b16 v[218:219], v17 offset:9216
    v_mfma_f32_16x16x32_bf16 v[128:131], v[220:223], a[144:147], v[128:131]
    buffer_load_dwordx4 v10, s[44:47], s71 offen offset:1024 lds
    v_mfma_f32_16x16x32_bf16 v[128:131], v[224:227], a[148:151], v[128:131]
    s_sub_u32 s72, s59, 1664
    v_mfma_f32_16x16x32_bf16 v[136:139], v[220:223], a[208:211], v[136:139]
    buffer_load_dword v2, v38, s[48:51], s57 offen sc1
    v_mfma_f32_16x16x32_bf16 v[136:139], v[224:227], a[212:215], v[136:139]
    s_waitcnt lgkmcnt(4)
    s_add_u32 s57, s57, 2428928
    v_mfma_f32_16x16x32_bf16 v[108:111], v[204:207], a[24:27], v[108:111]
    ds_read_b64_tr_b16 v[220:221], v16 offset:2048
    v_mfma_f32_16x16x32_bf16 v[108:111], v[208:211], a[28:31], v[108:111]
L_pad11:
    s_cbranch_execz L_pad13
    ds_read_b64_tr_b16 v[222:223], v16 offset:10240
    v_mfma_f32_16x16x32_bf16 v[116:119], v[204:207], a[88:91], v[116:119]
    ds_read_b64_tr_b16 v[224:225], v16 offset:3072
    v_mfma_f32_16x16x32_bf16 v[116:119], v[208:211], a[92:95], v[116:119]
    buffer_load_dwordx4 v10, s[44:47], s72 offen offset:2048 lds
    v_mfma_f32_16x16x32_bf16 v[124:127], v[204:207], a[152:155], v[124:127]
    s_add_u32 s73, s59, 34176
    ds_read_b64_tr_b16 v[226:227], v16 offset:11264
    v_mfma_f32_16x16x32_bf16 v[124:127], v[208:211], a[156:159], v[124:127]
    buffer_load_dword v3, v38, s[48:51], s57 offen sc1
    v_mfma_f32_16x16x32_bf16 v[132:135], v[204:207], a[216:219], v[132:135]
    s_add_u32 s57, s57, 2428928
    v_mfma_f32_16x16x32_bf16 v[132:135], v[208:211], a[220:223], v[132:135]
    s_waitcnt lgkmcnt(4)
    v_mfma_f32_16x16x32_bf16 v[112:115], v[212:215], a[24:27], v[112:115]
    ds_read_b64_tr_b16 v[204:205], v17 offset:2048
    v_mfma_f32_16x16x32_bf16 v[112:115], v[216:219], a[28:31], v[112:115]
    ds_read_b64_tr_b16 v[206:207], v17 offset:10240
    v_mfma_f32_16x16x32_bf16 v[120:123], v[212:215], a[88:91], v[120:123]
    buffer_load_dwordx4 v10, s[44:47], s73 offen offset:3072 lds
    v_mfma_f32_16x16x32_bf16 v[120:123], v[216:219], a[92:95], v[120:123]
    ds_read_b64_tr_b16 v[208:209], v17 offset:3072
    v_mfma_f32_16x16x32_bf16 v[128:131], v[212:215], a[152:155], v[128:131]
    ds_read_b64_tr_b16 v[210:211], v17 offset:11264
    v_mfma_f32_16x16x32_bf16 v[128:131], v[216:219], a[156:159], v[128:131]
    buffer_load_dword v4, v38, s[48:51], s57 offen sc1
    v_mfma_f32_16x16x32_bf16 v[136:139], v[212:215], a[216:219], v[136:139]
    s_add_u32 s57, s57, 2428928
    v_mfma_f32_16x16x32_bf16 v[136:139], v[216:219], a[220:223], v[136:139]
    s_waitcnt lgkmcnt(4)
    v_mfma_f32_16x16x32_bf16 v[108:111], v[220:223], a[36:39], v[108:111]
    buffer_load_dword v5, v38, s[48:51], s57 offen sc1
    v_mfma_f32_16x16x32_bf16 v[108:111], v[224:227], a[32:35], v[108:111]
    s_waitcnt vmcnt(20) lgkmcnt(0)
    s_barrier
    v_mfma_f32_16x16x32_bf16 v[116:119], v[220:223], a[100:103], v[116:119]
    s_add_u32 m0, s55, 0
    ds_read_b64_tr_b16 v[212:213], v16 offset:16384
    s_add_u32 s57, s57, 2428928
    v_mfma_f32_16x16x32_bf16 v[116:119], v[224:227], a[96:99], v[116:119]
    s_add_u32 s70, s59, 74112
    ds_read_b64_tr_b16 v[214:215], v16 offset:24576
    v_mfma_f32_16x16x32_bf16 v[124:127], v[220:223], a[164:167], v[124:127]
    buffer_load_dwordx4 v10, s[44:47], s70 offen offset:0 lds
    v_mfma_f32_16x16x32_bf16 v[124:127], v[224:227], a[160:163], v[124:127]
    s_add_u32 s71, s59, 109952
    ds_read_b64_tr_b16 v[216:217], v16 offset:17408
    ds_read_b64_tr_b16 v[218:219], v16 offset:25600
    v_mfma_f32_16x16x32_bf16 v[132:135], v[220:223], a[228:231], v[132:135]
    buffer_load_dword v8, v38, s[48:51], s57 offen sc1
    v_mfma_f32_16x16x32_bf16 v[132:135], v[224:227], a[224:227], v[132:135]
    s_add_u32 s57, s57, 2428928
    v_mfma_f32_16x16x32_bf16 v[112:115], v[204:207], a[36:39], v[112:115]
    ds_read_b64_tr_b16 v[220:221], v17 offset:16384
    v_mfma_f32_16x16x32_bf16 v[112:115], v[208:211], a[32:35], v[112:115]
    ds_read_b64_tr_b16 v[222:223], v17 offset:24576
    v_mfma_f32_16x16x32_bf16 v[120:123], v[204:207], a[100:103], v[120:123]
    ds_read_b64_tr_b16 v[224:225], v17 offset:17408
    v_mfma_f32_16x16x32_bf16 v[120:123], v[208:211], a[96:99], v[120:123]
    buffer_load_dwordx4 v10, s[44:47], s71 offen offset:1024 lds
    v_mfma_f32_16x16x32_bf16 v[128:131], v[204:207], a[164:167], v[128:131]
    s_add_u32 s72, s59, 145792
    ds_read_b64_tr_b16 v[226:227], v17 offset:25600
    s_waitcnt vmcnt(13)
    v_mfma_f32_16x16x32_bf16 v[128:131], v[208:211], a[160:163], v[128:131]
    buffer_store_dword v255, off, s[48:51], s17 sc1
    v_mfma_f32_16x16x32_bf16 v[136:139], v[204:207], a[228:231], v[136:139]
    buffer_load_dword v11, v38, s[48:51], s57 offen sc1
    v_mfma_f32_16x16x32_bf16 v[136:139], v[208:211], a[224:227], v[136:139]
    s_waitcnt lgkmcnt(4)
    s_add_u32 s57, s57, 2428928
    v_mfma_f32_16x16x32_bf16 v[108:111], v[212:215], a[44:47], v[108:111]
    ds_read_b64_tr_b16 v[204:205], v16 offset:18432
    v_mfma_f32_16x16x32_bf16 v[108:111], v[216:219], a[48:51], v[108:111]
    ds_read_b64_tr_b16 v[206:207], v16 offset:26624
    v_mfma_f32_16x16x32_bf16 v[116:119], v[212:215], a[108:111], v[116:119]
    buffer_load_dwordx4 v10, s[44:47], s72 offen offset:2048 lds
    v_mfma_f32_16x16x32_bf16 v[116:119], v[216:219], a[112:115], v[116:119]
    s_add_u32 s73, s59, 181632
    ds_read_b64_tr_b16 v[208:209], v16 offset:19456
    v_mfma_f32_16x16x32_bf16 v[124:127], v[212:215], a[172:175], v[124:127]
    ds_read_b64_tr_b16 v[210:211], v16 offset:27648
    v_mfma_f32_16x16x32_bf16 v[124:127], v[216:219], a[176:179], v[124:127]
    buffer_load_dword v15, v38, s[48:51], s57 offen sc1
    v_mfma_f32_16x16x32_bf16 v[132:135], v[212:215], a[236:239], v[132:135]
    s_add_u32 s57, s57, 2428928
    v_mfma_f32_16x16x32_bf16 v[132:135], v[216:219], a[240:243], v[132:135]
    s_waitcnt lgkmcnt(4)
    v_mfma_f32_16x16x32_bf16 v[112:115], v[220:223], a[44:47], v[112:115]
    ds_read_b64_tr_b16 v[212:213], v17 offset:18432
    v_mfma_f32_16x16x32_bf16 v[112:115], v[224:227], a[48:51], v[112:115]
    buffer_load_dwordx4 v10, s[44:47], s73 offen offset:3072 lds
    v_mfma_f32_16x16x32_bf16 v[120:123], v[220:223], a[108:111], v[120:123]
    ds_read_b64_tr_b16 v[214:215], v17 offset:26624
    v_mfma_f32_16x16x32_bf16 v[120:123], v[224:227], a[112:115], v[120:123]
    ds_read_b64_tr_b16 v[216:217], v17 offset:19456
    v_mfma_f32_16x16x32_bf16 v[128:131], v[220:223], a[172:175], v[128:131]
    ds_read_b64_tr_b16 v[218:219], v17 offset:27648
    v_mfma_f32_16x16x32_bf16 v[128:131], v[224:227], a[176:179], v[128:131]
    buffer_load_dword v252, v38, s[48:51], s57 offen sc1
    v_mfma_f32_16x16x32_bf16 v[136:139], v[220:223], a[236:239], v[136:139]
    s_add_u32 s57, s57, 2428928
    v_mfma_f32_16x16x32_bf16 v[136:139], v[224:227], a[240:243], v[136:139]
    s_waitcnt lgkmcnt(4)
    v_mfma_f32_16x16x32_bf16 v[108:111], v[204:207], a[52:55], v[108:111]
    buffer_load_dword v231, v38, s[48:51], s57 offen sc1
    v_mfma_f32_16x16x32_bf16 v[108:111], v[208:211], a[56:59], v[108:111]
    s_waitcnt vmcnt(19) lgkmcnt(0)
    s_barrier
    v_mfma_f32_16x16x32_bf16 v[116:119], v[204:207], a[116:119], v[116:119]
    s_add_u32 m0, s55, 16384
    ds_read_b64_tr_b16 v[220:221], v16 offset:32768
    s_add_u32 s57, s57, 2428928
    v_mfma_f32_16x16x32_bf16 v[116:119], v[208:211], a[120:123], v[116:119]
    s_add_u32 s70, s59, 221568
    ds_read_b64_tr_b16 v[222:223], v16 offset:40960
    v_mfma_f32_16x16x32_bf16 v[124:127], v[204:207], a[180:183], v[124:127]
    buffer_load_dwordx4 v10, s[44:47], s70 offen offset:0 lds
    v_mfma_f32_16x16x32_bf16 v[124:127], v[208:211], a[184:187], v[124:127]
    s_add_u32 s71, s59, 257408
    ds_read_b64_tr_b16 v[224:225], v16 offset:33792
    ds_read_b64_tr_b16 v[226:227], v16 offset:41984
    v_mfma_f32_16x16x32_bf16 v[132:135], v[204:207], a[244:247], v[132:135]
    buffer_load_dword v232, v38, s[48:51], s57 offen sc1
    v_mfma_f32_16x16x32_bf16 v[132:135], v[208:211], a[248:251], v[132:135]
    s_add_u32 s57, s57, 2428928
    v_mfma_f32_16x16x32_bf16 v[112:115], v[212:215], a[52:55], v[112:115]
    ds_read_b64_tr_b16 v[204:205], v17 offset:32768
    v_mfma_f32_16x16x32_bf16 v[112:115], v[216:219], a[56:59], v[112:115]
    ds_read_b64_tr_b16 v[206:207], v17 offset:40960
    v_mfma_f32_16x16x32_bf16 v[120:123], v[212:215], a[116:119], v[120:123]
    ds_read_b64_tr_b16 v[208:209], v17 offset:33792
    v_mfma_f32_16x16x32_bf16 v[120:123], v[216:219], a[120:123], v[120:123]
    buffer_load_dwordx4 v10, s[44:47], s71 offen offset:1024 lds
    v_mfma_f32_16x16x32_bf16 v[128:131], v[212:215], a[180:183], v[128:131]
    s_sub_u32 s72, s61, 1664
    ds_read_b64_tr_b16 v[210:211], v17 offset:41984
    s_waitcnt vmcnt(21)
    v_lshlrev_b32 v228, 16, v1
    v_mfma_f32_16x16x32_bf16 v[128:131], v[216:219], a[184:187], v[128:131]
    buffer_load_dword v233, v38, s[48:51], s57 offen sc1
    v_mfma_f32_16x16x32_bf16 v[136:139], v[212:215], a[244:247], v[136:139]
    s_add_u32 s57, s57, 2428928
    v_and_b32 v229, 0xffff0000, v1
    v_mfma_f32_16x16x32_bf16 v[136:139], v[216:219], a[248:251], v[136:139]
    s_waitcnt lgkmcnt(4)
    v_mfma_f32_16x16x32_bf16 v[108:111], v[220:223], a[60:63], v[108:111]
    ds_read_b64_tr_b16 v[212:213], v16 offset:34816
    v_mfma_f32_16x16x32_bf16 v[108:111], v[224:227], v[140:143], v[108:111]
    ds_read_b64_tr_b16 v[214:215], v16 offset:43008
    v_mfma_f32_16x16x32_bf16 v[116:119], v[220:223], a[124:127], v[116:119]
    buffer_load_dwordx4 v10, s[32:35], s72 offen offset:2048 lds
    v_mfma_f32_16x16x32_bf16 v[116:119], v[224:227], v[144:147], v[116:119]
    s_sub_u32 s73, s60, 2688
    ds_read_b64_tr_b16 v[216:217], v16 offset:35840
    v_mfma_f32_16x16x32_bf16 v[124:127], v[220:223], a[188:191], v[124:127]
    ds_read_b64_tr_b16 v[218:219], v16 offset:44032
    v_mfma_f32_16x16x32_bf16 v[124:127], v[224:227], v[148:151], v[124:127]
    buffer_load_dword v234, v38, s[48:51], s57 offen sc1
    v_mfma_f32_16x16x32_bf16 v[132:135], v[220:223], a[252:255], v[132:135]
    s_add_u32 s57, s57, 2428928
    v_mfma_f32_16x16x32_bf16 v[132:135], v[224:227], v[152:155], v[132:135]
    s_waitcnt lgkmcnt(4)
    v_mfma_f32_16x16x32_bf16 v[112:115], v[204:207], a[60:63], v[112:115]
    ds_read_b64_tr_b16 v[220:221], v17 offset:34816
    v_mfma_f32_16x16x32_bf16 v[112:115], v[208:211], v[140:143], v[112:115]
    buffer_load_dwordx4 v10, s[44:47], s73 offen offset:3072 lds
    v_mfma_f32_16x16x32_bf16 v[120:123], v[204:207], a[124:127], v[120:123]
    ds_read_b64_tr_b16 v[222:223], v17 offset:43008
    s_waitcnt vmcnt(22)
    v_lshlrev_b32 v41, 16, v2
    v_mfma_f32_16x16x32_bf16 v[120:123], v[208:211], v[144:147], v[120:123]
    ds_read_b64_tr_b16 v[224:225], v17 offset:35840
    v_and_b32 v2, 0xffff0000, v2
    v_mfma_f32_16x16x32_bf16 v[128:131], v[204:207], a[188:191], v[128:131]
    ds_read_b64_tr_b16 v[226:227], v17 offset:44032
    v_add_f32 v228, v228, v41
    v_mfma_f32_16x16x32_bf16 v[128:131], v[208:211], v[148:151], v[128:131]
    buffer_load_dword v235, v38, s[48:51], s57 offen sc1
    v_mfma_f32_16x16x32_bf16 v[136:139], v[204:207], a[252:255], v[136:139]
    s_add_u32 s57, s57, 2428928
    v_add_f32 v229, v229, v2
    v_mfma_f32_16x16x32_bf16 v[136:139], v[208:211], v[152:155], v[136:139]
    s_waitcnt lgkmcnt(4)
    v_mfma_f32_16x16x32_bf16 v[108:111], v[212:215], v[156:159], v[108:111]
    buffer_load_dword v242, v38, s[48:51], s57 offen sc1
    v_mfma_f32_16x16x32_bf16 v[108:111], v[216:219], v[172:175], v[108:111]
    s_waitcnt vmcnt(21) lgkmcnt(0)
    s_barrier
    v_mfma_f32_16x16x32_bf16 v[116:119], v[212:215], v[160:163], v[116:119]
    s_add_u32 m0, s55, 32768
    ds_read_b64_tr_b16 v[204:205], v16 offset:49152
    s_add_u32 s57, s57, 2428928
    v_mfma_f32_16x16x32_bf16 v[116:119], v[216:219], v[176:179], v[116:119]
    s_add_u32 s70, s0, 384
    ds_read_b64_tr_b16 v[206:207], v16 offset:57344
    v_lshlrev_b32 v42, 16, v3
    v_mfma_f32_16x16x32_bf16 v[124:127], v[212:215], v[164:167], v[124:127]
    buffer_load_dwordx4 v10, s[44:47], s70 offen offset:0 lds
    v_mfma_f32_16x16x32_bf16 v[124:127], v[216:219], v[180:183], v[124:127]
    s_add_u32 s71, s0, 36224
    ds_read_b64_tr_b16 v[208:209], v16 offset:50176
    ds_read_b64_tr_b16 v[210:211], v16 offset:58368
    v_mfma_f32_16x16x32_bf16 v[132:135], v[212:215], v[168:171], v[132:135]
    buffer_load_dword v243, v38, s[48:51], s57 offen sc1
    v_mfma_f32_16x16x32_bf16 v[132:135], v[216:219], v[184:187], v[132:135]
    v_and_b32 v3, 0xffff0000, v3
    v_add_f32 v228, v228, v42
    v_mfma_f32_16x16x32_bf16 v[112:115], v[220:223], v[156:159], v[112:115]
    ds_read_b64_tr_b16 v[212:213], v17 offset:49152
    v_add_f32 v229, v229, v3
    v_mfma_f32_16x16x32_bf16 v[112:115], v[224:227], v[172:175], v[112:115]
    ds_read_b64_tr_b16 v[214:215], v17 offset:57344
    s_waitcnt vmcnt(22)
    v_lshlrev_b32 v43, 16, v4
    v_mfma_f32_16x16x32_bf16 v[120:123], v[220:223], v[160:163], v[120:123]
    ds_read_b64_tr_b16 v[216:217], v17 offset:50176
    v_and_b32 v4, 0xffff0000, v4
    v_mfma_f32_16x16x32_bf16 v[120:123], v[224:227], v[176:179], v[120:123]
    buffer_load_dwordx4 v10, s[44:47], s71 offen offset:1024 lds
    v_mfma_f32_16x16x32_bf16 v[128:131], v[220:223], v[164:167], v[128:131]
    s_add_u32 s72, s0, 72064
    ds_read_b64_tr_b16 v[218:219], v17 offset:58368
    v_add_f32 v228, v228, v43
    v_mfma_f32_16x16x32_bf16 v[128:131], v[224:227], v[180:183], v[128:131]
    v_add_f32 v229, v229, v4
    s_waitcnt vmcnt(22)
    v_lshlrev_b32 v40, 16, v5
    v_mfma_f32_16x16x32_bf16 v[136:139], v[220:223], v[168:171], v[136:139]
    v_and_b32 v5, 0xffff0000, v5
    v_add_f32 v228, v228, v40
    v_mfma_f32_16x16x32_bf16 v[136:139], v[224:227], v[184:187], v[136:139]
    s_waitcnt lgkmcnt(4)
    v_add_f32 v229, v229, v5
    v_mfma_f32_16x16x32_bf16 v[108:111], v[204:207], v[20:23], v[108:111]
    ds_read_b64_tr_b16 v[220:221], v9 offset:256
    v_mfma_f32_16x16x32_bf16 v[108:111], v[208:211], v[188:191], v[108:111]
    ds_read_b64_tr_b16 v[222:223], v9 offset:2816
    s_waitcnt vmcnt(20)
    v_lshlrev_b32 v41, 16, v8
    v_mfma_f32_16x16x32_bf16 v[116:119], v[204:207], v[24:27], v[116:119]
    buffer_load_dwordx4 v10, s[44:47], s72 offen offset:2048 lds
    v_mfma_f32_16x16x32_bf16 v[116:119], v[208:211], v[192:195], v[116:119]
    s_add_u32 s73, s0, 107904
    v_and_b32 v8, 0xffff0000, v8
    v_add_f32 v228, v228, v41
    v_mfma_f32_16x16x32_bf16 v[124:127], v[204:207], v[28:31], v[124:127]
    ds_read_b64_tr_b16 v[224:225], v9 offset:288
    v_add_f32 v229, v229, v8
    v_mfma_f32_16x16x32_bf16 v[124:127], v[208:211], v[196:199], v[124:127]
    ds_read_b64_tr_b16 v[226:227], v9 offset:2848
    v_mfma_f32_16x16x32_bf16 v[132:135], v[204:207], v[32:35], v[132:135]
    v_mfma_f32_16x16x32_bf16 v[132:135], v[208:211], v[200:203], v[132:135]
    s_waitcnt lgkmcnt(4)
    v_mfma_f32_16x16x32_bf16 v[112:115], v[212:215], v[20:23], v[112:115]
    ds_read_b64_tr_b16 v[204:205], v16 offset:51200
    v_mfma_f32_16x16x32_bf16 v[112:115], v[216:219], v[188:191], v[112:115]
    buffer_load_dwordx4 v10, s[44:47], s73 offen offset:3072 lds
    v_mfma_f32_16x16x32_bf16 v[120:123], v[212:215], v[24:27], v[120:123]
    ds_read_b64_tr_b16 v[206:207], v16 offset:59392
    s_waitcnt vmcnt(19)
    v_lshlrev_b32 v42, 16, v11
    v_mfma_f32_16x16x32_bf16 v[120:123], v[216:219], v[192:195], v[120:123]
    ds_read_b64_tr_b16 v[208:209], v16 offset:52224
    v_and_b32 v11, 0xffff0000, v11
    v_mfma_f32_16x16x32_bf16 v[128:131], v[212:215], v[28:31], v[128:131]
    ds_read_b64_tr_b16 v[210:211], v16 offset:60416
    v_add_f32 v228, v228, v42
    v_mfma_f32_16x16x32_bf16 v[128:131], v[216:219], v[196:199], v[128:131]
    v_add_f32 v229, v229, v11
    v_mfma_f32_16x16x32_bf16 v[136:139], v[212:215], v[32:35], v[136:139]
    v_mfma_f32_16x16x32_bf16 v[136:139], v[216:219], v[200:203], v[136:139]
    s_waitcnt lgkmcnt(6)
    v_mfma_f32_16x16x32_bf16 v[108:111], v[220:223], a[40:43], v[108:111]
    ds_read_b64_tr_b16 v[212:213], v17 offset:51200
    s_waitcnt vmcnt(17)
    v_lshlrev_b32 v43, 16, v15
    v_mfma_f32_16x16x32_bf16 v[116:119], v[220:223], a[104:107], v[116:119]
    ds_read_b64_tr_b16 v[214:215], v17 offset:59392
    v_and_b32 v15, 0xffff0000, v15
    v_mfma_f32_16x16x32_bf16 v[124:127], v[220:223], a[168:171], v[124:127]
    ds_read_b64_tr_b16 v[216:217], v17 offset:52224
    v_add_f32 v228, v228, v43
    v_mfma_f32_16x16x32_bf16 v[132:135], v[220:223], a[232:235], v[132:135]
    s_waitcnt lgkmcnt(7)
    ds_read_b64_tr_b16 v[218:219], v17 offset:60416
    v_add_f32 v229, v229, v15
    v_mfma_f32_16x16x32_bf16 v[112:115], v[224:227], a[40:43], v[112:115]
    buffer_load_dword v254, v14, s[48:51], s68 offen sc1
    v_mfma_f32_16x16x32_bf16 v[120:123], v[224:227], a[104:107], v[120:123]
    v_mfma_f32_16x16x32_bf16 v[128:131], v[224:227], a[168:171], v[128:131]
    v_mfma_f32_16x16x32_bf16 v[136:139], v[224:227], a[232:235], v[136:139]
    s_waitcnt lgkmcnt(4)
    v_mfma_f32_16x16x32_bf16 v[44:47], v[204:207], a[0:3], 0
    s_waitcnt vmcnt(17) lgkmcnt(0)
    s_barrier
    v_mfma_f32_16x16x32_bf16 v[44:47], v[208:211], a[4:7], v[44:47]
    s_add_u32 m0, s55, 49152
    ds_read_b64_tr_b16 v[220:221], v16 offset:0
    s_add_u32 s84, s62, 32768
    v_mfma_f32_16x16x32_bf16 v[52:55], v[204:207], a[64:67], 0
    s_add_u32 s70, s0, 147840
    ds_read_b64_tr_b16 v[222:223], v16 offset:8192
    s_sub_u32 s85, s84, s65
    v_mfma_f32_16x16x32_bf16 v[52:55], v[208:211], a[68:71], v[52:55]
    buffer_load_dwordx4 v10, s[44:47], s70 offen offset:0 lds
    v_mfma_f32_16x16x32_bf16 v[60:63], v[204:207], a[128:131], 0
    s_add_u32 s71, s0, 183680
    ds_read_b64_tr_b16 v[224:225], v16 offset:1024
    s_add_u32 s85, s85, 1024
    v_mfma_f32_16x16x32_bf16 v[60:63], v[208:211], a[132:135], v[60:63]
    s_add_u32 s84, s84, s65
    ds_read_b64_tr_b16 v[226:227], v16 offset:9216
    v_cvt_pk_bf16_f32 v108, v108, v109
    v_mfma_f32_16x16x32_bf16 v[68:71], v[204:207], a[192:195], 0
    v_cvt_pk_bf16_f32 v109, v110, v111
    v_cvt_pk_bf16_f32 v110, v112, v113
    v_mfma_f32_16x16x32_bf16 v[68:71], v[208:211], a[196:199], v[68:71]
    v_cvt_pk_bf16_f32 v111, v114, v115
    v_cvt_pk_bf16_f32 v116, v116, v117
    v_mfma_f32_16x16x32_bf16 v[48:51], v[212:215], a[0:3], 0
    buffer_store_dwordx4 v[108:111], v18, s[48:51], s84 offen sc1
    v_mfma_f32_16x16x32_bf16 v[48:51], v[216:219], a[4:7], v[48:51]
    ds_read_b64_tr_b16 v[204:205], v17 offset:0
    v_cvt_pk_bf16_f32 v117, v118, v119
    v_mfma_f32_16x16x32_bf16 v[56:59], v[212:215], a[64:67], 0
    buffer_load_dwordx4 v10, s[44:47], s71 offen offset:1024 lds
    v_mfma_f32_16x16x32_bf16 v[56:59], v[216:219], a[68:71], v[56:59]
    s_add_u32 s72, s0, 219520
    ds_read_b64_tr_b16 v[206:207], v17 offset:8192
    v_cvt_pk_bf16_f32 v118, v120, v121
    v_mfma_f32_16x16x32_bf16 v[64:67], v[212:215], a[128:131], 0
    ds_read_b64_tr_b16 v[208:209], v17 offset:1024
    v_cvt_pk_bf16_f32 v119, v122, v123
    v_mfma_f32_16x16x32_bf16 v[64:67], v[216:219], a[132:135], v[64:67]
    buffer_store_dwordx4 v[116:119], v18, s[48:51], s85 offen sc1
    v_mfma_f32_16x16x32_bf16 v[72:75], v[212:215], a[192:195], 0
    ds_read_b64_tr_b16 v[210:211], v17 offset:9216
    v_cvt_pk_bf16_f32 v124, v124, v125
    v_mfma_f32_16x16x32_bf16 v[72:75], v[216:219], a[196:199], v[72:75]
    s_waitcnt lgkmcnt(4)
    v_cvt_pk_bf16_f32 v125, v126, v127
    v_cvt_pk_bf16_f32 v126, v128, v129
    v_mfma_f32_16x16x32_bf16 v[44:47], v[220:223], a[8:11], v[44:47]
    ds_read_b64_tr_b16 v[212:213], v16 offset:2048
    v_cvt_pk_bf16_f32 v127, v130, v131
    v_mfma_f32_16x16x32_bf16 v[44:47], v[224:227], a[12:15], v[44:47]
    buffer_store_dwordx4 v[124:127], v19, s[48:51], s84 offen sc1
    v_mfma_f32_16x16x32_bf16 v[52:55], v[220:223], a[72:75], v[52:55]
    buffer_load_dwordx4 v10, s[44:47], s72 offen offset:2048 lds
    v_mfma_f32_16x16x32_bf16 v[52:55], v[224:227], a[76:79], v[52:55]
    s_add_u32 s73, s0, 255360
    ds_read_b64_tr_b16 v[214:215], v16 offset:10240
    v_cvt_pk_bf16_f32 v132, v132, v133
    v_mfma_f32_16x16x32_bf16 v[60:63], v[220:223], a[136:139], v[60:63]
    ds_read_b64_tr_b16 v[216:217], v16 offset:3072
    v_cvt_pk_bf16_f32 v133, v134, v135
    v_mfma_f32_16x16x32_bf16 v[60:63], v[224:227], a[140:143], v[60:63]
    ds_read_b64_tr_b16 v[218:219], v16 offset:11264
    v_cvt_pk_bf16_f32 v134, v136, v137
    v_mfma_f32_16x16x32_bf16 v[68:71], v[220:223], a[200:203], v[68:71]
    v_cvt_pk_bf16_f32 v135, v138, v139
    v_mov_b32 v255, 9
    v_mfma_f32_16x16x32_bf16 v[68:71], v[224:227], a[204:207], v[68:71]
    s_waitcnt lgkmcnt(4)
    s_waitcnt vmcnt(22)
    v_lshlrev_b32 v40, 16, v252
    v_and_b32 v252, 0xffff0000, v252
    v_mfma_f32_16x16x32_bf16 v[48:51], v[204:207], a[8:11], v[48:51]
    buffer_store_dwordx4 v[132:135], v19, s[48:51], s85 offen sc1
    v_mfma_f32_16x16x32_bf16 v[48:51], v[208:211], a[12:15], v[48:51]
    buffer_load_dwordx4 v10, s[44:47], s73 offen offset:3072 lds
    v_mfma_f32_16x16x32_bf16 v[56:59], v[204:207], a[72:75], v[56:59]
    ds_read_b64_tr_b16 v[220:221], v17 offset:2048
    v_add_f32 v228, v228, v40
    v_mfma_f32_16x16x32_bf16 v[56:59], v[208:211], a[76:79], v[56:59]
    ds_read_b64_tr_b16 v[222:223], v17 offset:10240
    v_add_f32 v229, v229, v252
    v_mfma_f32_16x16x32_bf16 v[64:67], v[204:207], a[136:139], v[64:67]
    ds_read_b64_tr_b16 v[224:225], v17 offset:3072
    s_waitcnt vmcnt(23)
    v_lshlrev_b32 v41, 16, v231
    v_mfma_f32_16x16x32_bf16 v[64:67], v[208:211], a[140:143], v[64:67]
    ds_read_b64_tr_b16 v[226:227], v17 offset:11264
    v_and_b32 v231, 0xffff0000, v231
    v_mfma_f32_16x16x32_bf16 v[72:75], v[204:207], a[200:203], v[72:75]
    v_add_f32 v228, v228, v41
    v_add_f32 v229, v229, v231
    v_mfma_f32_16x16x32_bf16 v[72:75], v[208:211], a[204:207], v[72:75]
    s_waitcnt lgkmcnt(4)
    s_waitcnt vmcnt(21)
    v_lshlrev_b32 v42, 16, v232
    v_and_b32 v232, 0xffff0000, v232
    v_mfma_f32_16x16x32_bf16 v[44:47], v[212:215], a[16:19], v[44:47]
    v_add_f32 v228, v228, v42
    v_add_f32 v229, v229, v232
    v_mfma_f32_16x16x32_bf16 v[44:47], v[216:219], a[20:23], v[44:47]
    s_waitcnt vmcnt(19)
    v_lshlrev_b32 v43, 16, v233
    v_and_b32 v233, 0xffff0000, v233
    v_mfma_f32_16x16x32_bf16 v[52:55], v[212:215], a[80:83], v[52:55]
    s_waitcnt vmcnt(16) lgkmcnt(0)
    s_barrier
    v_mfma_f32_16x16x32_bf16 v[52:55], v[216:219], a[84:87], v[52:55]
    s_add_u32 m0, s55, 0
    ds_read_b64_tr_b16 v[204:205], v16 offset:16384
    v_add_f32 v228, v228, v43
    v_mfma_f32_16x16x32_bf16 v[60:63], v[212:215], a[144:147], v[60:63]
    s_add_u32 s70, s10, 384
    ds_read_b64_tr_b16 v[206:207], v16 offset:24576
    v_add_f32 v229, v229, v233
    v_mfma_f32_16x16x32_bf16 v[60:63], v[216:219], a[148:151], v[60:63]
    buffer_load_dwordx4 v10, s[32:35], s70 offen offset:0 lds
    v_mfma_f32_16x16x32_bf16 v[68:71], v[212:215], a[208:211], v[68:71]
    s_sub_u32 s71, s1, 640
    ds_read_b64_tr_b16 v[208:209], v16 offset:17408
    ds_read_b64_tr_b16 v[210:211], v16 offset:25600
    v_mfma_f32_16x16x32_bf16 v[68:71], v[216:219], a[212:215], v[68:71]
    v_lshlrev_b32 v40, 16, v234
    v_and_b32 v234, 0xffff0000, v234
    v_mfma_f32_16x16x32_bf16 v[48:51], v[220:223], a[16:19], v[48:51]
    ds_read_b64_tr_b16 v[212:213], v17 offset:16384
    v_add_f32 v228, v228, v40
    v_mfma_f32_16x16x32_bf16 v[48:51], v[224:227], a[20:23], v[48:51]
    ds_read_b64_tr_b16 v[214:215], v17 offset:24576
    v_add_f32 v229, v229, v234
    v_mfma_f32_16x16x32_bf16 v[56:59], v[220:223], a[80:83], v[56:59]
    ds_read_b64_tr_b16 v[216:217], v17 offset:17408
    s_waitcnt vmcnt(16)
    v_lshlrev_b32 v41, 16, v235
    v_mfma_f32_16x16x32_bf16 v[56:59], v[224:227], a[84:87], v[56:59]
    ds_read_b64_tr_b16 v[218:219], v17 offset:25600
    v_and_b32 v235, 0xffff0000, v235
    v_mfma_f32_16x16x32_bf16 v[64:67], v[220:223], a[144:147], v[64:67]
    buffer_load_dwordx4 v10, s[44:47], s71 offen offset:1024 lds
    v_mfma_f32_16x16x32_bf16 v[64:67], v[224:227], a[148:151], v[64:67]
    v_add_f32 v228, v228, v41
    v_add_f32 v229, v229, v235
    v_mfma_f32_16x16x32_bf16 v[72:75], v[220:223], a[208:211], v[72:75]
    s_waitcnt vmcnt(10)
    v_cmp_gt_u32 vcc, 8, v254
    s_nop 0
    s_cbranch_vccnz L_sp_r1
L_bk_r1:
    v_mfma_f32_16x16x32_bf16 v[72:75], v[224:227], a[212:215], v[72:75]
    s_waitcnt lgkmcnt(4)
    v_lshlrev_b32 v42, 16, v242
    v_and_b32 v242, 0xffff0000, v242
    v_mfma_f32_16x16x32_bf16 v[44:47], v[204:207], a[24:27], v[44:47]
    ds_read_b64_tr_b16 v[220:221], v16 offset:18432
    v_add_f32 v228, v228, v42
    v_mfma_f32_16x16x32_bf16 v[44:47], v[208:211], a[28:31], v[44:47]
    ds_read_b64_tr_b16 v[222:223], v16 offset:26624
    v_add_f32 v229, v229, v242
    v_mfma_f32_16x16x32_bf16 v[52:55], v[204:207], a[88:91], v[52:55]
    ds_read_b64_tr_b16 v[224:225], v16 offset:19456
    v_lshlrev_b32 v43, 16, v243
    v_mfma_f32_16x16x32_bf16 v[52:55], v[208:211], a[92:95], v[52:55]
    ds_read_b64_tr_b16 v[226:227], v16 offset:27648
    v_and_b32 v243, 0xffff0000, v243
    v_mfma_f32_16x16x32_bf16 v[60:63], v[204:207], a[152:155], v[60:63]
    buffer_load_dwordx2 v[76:77], v36, s[48:51], s63 offen sc1
    v_mfma_f32_16x16x32_bf16 v[60:63], v[208:211], a[156:159], v[60:63]
    s_add_u32 s63, s63, 4857856
    v_add_f32 v228, v228, v43
    v_add_f32 v229, v229, v243
    v_mfma_f32_16x16x32_bf16 v[68:71], v[204:207], a[216:219], v[68:71]
    v_lshlrev_b32 v40, 16, v230
    v_and_b32 v230, 0xffff0000, v230
    v_mfma_f32_16x16x32_bf16 v[68:71], v[208:211], a[220:223], v[68:71]
    s_waitcnt lgkmcnt(4)
    v_fmamk_f32 v228, v228, 0x4091afa4, v40
    v_fmamk_f32 v229, v229, 0x4091afa4, v230
    v_mfma_f32_16x16x32_bf16 v[48:51], v[212:215], a[24:27], v[48:51]
    ds_read_b64_tr_b16 v[204:205], v17 offset:18432
    v_cvt_pk_bf16_f32 v230, v228, v229
    v_mfma_f32_16x16x32_bf16 v[48:51], v[216:219], a[28:31], v[48:51]
    ds_read_b64_tr_b16 v[206:207], v17 offset:26624
    v_mfma_f32_16x16x32_bf16 v[56:59], v[212:215], a[88:91], v[56:59]
    ds_read_b64_tr_b16 v[208:209], v17 offset:19456
    v_mfma_f32_16x16x32_bf16 v[56:59], v[216:219], a[92:95], v[56:59]
    ds_read_b64_tr_b16 v[210:211], v17 offset:27648
    v_mfma_f32_16x16x32_bf16 v[64:67], v[212:215], a[152:155], v[64:67]
    buffer_store_dword v230, v39, s[28:31], s58 offen
    v_mfma_f32_16x16x32_bf16 v[64:67], v[216:219], a[156:159], v[64:67]
    buffer_load_dwordx2 v[78:79], v36, s[48:51], s63 offen sc1
    v_mfma_f32_16x16x32_bf16 v[72:75], v[212:215], a[216:219], v[72:75]
    s_add_u32 s63, s63, 4857856
    v_mfma_f32_16x16x32_bf16 v[72:75], v[216:219], a[220:223], v[72:75]
    s_waitcnt lgkmcnt(4)
    v_mfma_f32_16x16x32_bf16 v[44:47], v[220:223], a[36:39], v[44:47]
    s_waitcnt lgkmcnt(0)
    s_barrier
    v_mfma_f32_16x16x32_bf16 v[44:47], v[224:227], a[32:35], v[44:47]
    ds_read_b64_tr_b16 v[212:213], v16 offset:32768
    v_mfma_f32_16x16x32_bf16 v[52:55], v[220:223], a[100:103], v[52:55]
    ds_read_b64_tr_b16 v[214:215], v16 offset:40960
    v_mfma_f32_16x16x32_bf16 v[52:55], v[224:227], a[96:99], v[52:55]
    ds_read_b64_tr_b16 v[216:217], v16 offset:33792
    v_mfma_f32_16x16x32_bf16 v[60:63], v[220:223], a[164:167], v[60:63]
    ds_read_b64_tr_b16 v[218:219], v16 offset:41984
    v_mfma_f32_16x16x32_bf16 v[60:63], v[224:227], a[160:163], v[60:63]
    buffer_load_dwordx2 v[80:81], v36, s[48:51], s63 offen sc1
    v_mfma_f32_16x16x32_bf16 v[68:71], v[220:223], a[228:231], v[68:71]
    s_add_u32 s63, s63, 4857856
    v_mfma_f32_16x16x32_bf16 v[68:71], v[224:227], a[224:227], v[68:71]
    v_mfma_f32_16x16x32_bf16 v[48:51], v[204:207], a[36:39], v[48:51]
    ds_read_b64_tr_b16 v[220:221], v17 offset:32768
    v_mfma_f32_16x16x32_bf16 v[48:51], v[208:211], a[32:35], v[48:51]
    ds_read_b64_tr_b16 v[222:223], v17 offset:40960
    v_mfma_f32_16x16x32_bf16 v[56:59], v[204:207], a[100:103], v[56:59]
    s_waitcnt vmcnt(7)
    ds_read_b64_tr_b16 v[224:225], v17 offset:33792
    v_mfma_f32_16x16x32_bf16 v[56:59], v[208:211], a[96:99], v[56:59]
    buffer_store_dword v255, off, s[48:51], s17 sc1
    v_mfma_f32_16x16x32_bf16 v[64:67], v[204:207], a[164:167], v[64:67]
    ds_read_b64_tr_b16 v[226:227], v17 offset:41984
    v_mov_b32 v255, 10
    v_mfma_f32_16x16x32_bf16 v[64:67], v[208:211], a[160:163], v[64:67]
    buffer_load_dwordx2 v[82:83], v36, s[48:51], s63 offen sc1
    v_mfma_f32_16x16x32_bf16 v[72:75], v[204:207], a[228:231], v[72:75]
    s_add_u32 s63, s63, 4857856
    v_mfma_f32_16x16x32_bf16 v[72:75], v[208:211], a[224:227], v[72:75]
    s_waitcnt lgkmcnt(4)
    v_mfma_f32_16x16x32_bf16 v[44:47], v[212:215], a[44:47], v[44:47]
    ds_read_b64_tr_b16 v[204:205], v16 offset:34816
    v_mfma_f32_16x16x32_bf16 v[44:47], v[216:219], a[48:51], v[44:47]
    ds_read_b64_tr_b16 v[206:207], v16 offset:43008
    v_mfma_f32_16x16x32_bf16 v[52:55], v[212:215], a[108:111], v[52:55]
    ds_read_b64_tr_b16 v[208:209], v16 offset:35840
    v_mfma_f32_16x16x32_bf16 v[52:55], v[216:219], a[112:115], v[52:55]
    ds_read_b64_tr_b16 v[210:211], v16 offset:44032
    v_mfma_f32_16x16x32_bf16 v[60:63], v[212:215], a[172:175], v[60:63]
    buffer_load_dwordx2 v[84:85], v36, s[48:51], s63 offen sc1
    v_mfma_f32_16x16x32_bf16 v[60:63], v[216:219], a[176:179], v[60:63]
    s_add_u32 s63, s63, 4857856
    v_mfma_f32_16x16x32_bf16 v[68:71], v[212:215], a[236:239], v[68:71]
    v_mfma_f32_16x16x32_bf16 v[68:71], v[216:219], a[240:243], v[68:71]
    s_waitcnt lgkmcnt(4)
    v_mfma_f32_16x16x32_bf16 v[48:51], v[220:223], a[44:47], v[48:51]
    ds_read_b64_tr_b16 v[212:213], v17 offset:34816
    v_mfma_f32_16x16x32_bf16 v[48:51], v[224:227], a[48:51], v[48:51]
    ds_read_b64_tr_b16 v[214:215], v17 offset:43008
    v_mfma_f32_16x16x32_bf16 v[56:59], v[220:223], a[108:111], v[56:59]
    ds_read_b64_tr_b16 v[216:217], v17 offset:35840
    v_mfma_f32_16x16x32_bf16 v[56:59], v[224:227], a[112:115], v[56:59]
    ds_read_b64_tr_b16 v[218:219], v17 offset:44032
    v_mfma_f32_16x16x32_bf16 v[64:67], v[220:223], a[172:175], v[64:67]
    buffer_load_dwordx2 v[86:87], v36, s[48:51], s63 offen sc1
    v_mfma_f32_16x16x32_bf16 v[64:67], v[224:227], a[176:179], v[64:67]
    s_add_u32 s63, s63, 4857856
    v_mfma_f32_16x16x32_bf16 v[72:75], v[220:223], a[236:239], v[72:75]
    v_mfma_f32_16x16x32_bf16 v[72:75], v[224:227], a[240:243], v[72:75]
    s_waitcnt lgkmcnt(4)
    v_mfma_f32_16x16x32_bf16 v[44:47], v[204:207], a[52:55], v[44:47]
    s_waitcnt vmcnt(10) lgkmcnt(0)
    s_barrier
    v_mfma_f32_16x16x32_bf16 v[44:47], v[208:211], a[56:59], v[44:47]
    ds_read_b64_tr_b16 v[220:221], v16 offset:49152
    v_mfma_f32_16x16x32_bf16 v[52:55], v[204:207], a[116:119], v[52:55]
    ds_read_b64_tr_b16 v[222:223], v16 offset:57344
    v_mfma_f32_16x16x32_bf16 v[52:55], v[208:211], a[120:123], v[52:55]
    ds_read_b64_tr_b16 v[224:225], v16 offset:50176
    v_mfma_f32_16x16x32_bf16 v[60:63], v[204:207], a[180:183], v[60:63]
    ds_read_b64_tr_b16 v[226:227], v16 offset:58368
    v_mfma_f32_16x16x32_bf16 v[60:63], v[208:211], a[184:187], v[60:63]
    buffer_load_dwordx2 v[88:89], v36, s[48:51], s63 offen sc1
    v_mfma_f32_16x16x32_bf16 v[68:71], v[204:207], a[244:247], v[68:71]
    s_add_u32 s63, s63, 4857856
    v_mfma_f32_16x16x32_bf16 v[68:71], v[208:211], a[248:251], v[68:71]
L_pad12:
    s_cbranch_execz L_padretB
    v_mfma_f32_16x16x32_bf16 v[48:51], v[212:215], a[52:55], v[48:51]
    ds_read_b64_tr_b16 v[204:205], v17 offset:49152
    v_mfma_f32_16x16x32_bf16 v[48:51], v[216:219], a[56:59], v[48:51]
    ds_read_b64_tr_b16 v[206:207], v17 offset:57344
    v_mfma_f32_16x16x32_bf16 v[56:59], v[212:215], a[116:119], v[56:59]
    ds_read_b64_tr_b16 v[208:209], v17 offset:50176
    v_mfma_f32_16x16x32_bf16 v[56:59], v[216:219], a[120:123], v[56:59]
    ds_read_b64_tr_b16 v[210:211], v17 offset:58368
    v_mfma_f32_16x16x32_bf16 v[64:67], v[212:215], a[180:183], v[64:67]
    buffer_load_dwordx2 v[90:91], v36, s[48:51], s63 offen sc1
    v_mfma_f32_16x16x32_bf16 v[64:67], v[216:219], a[184:187], v[64:67]
    v_mfma_f32_16x16x32_bf16 v[72:75], v[212:215], a[244:247], v[72:75]
    v_mfma_f32_16x16x32_bf16 v[72:75], v[216:219], a[248:251], v[72:75]
    s_waitcnt lgkmcnt(4)
    v_mfma_f32_16x16x32_bf16 v[44:47], v[220:223], a[60:63], v[44:47]
    ds_read_b64_tr_b16 v[212:213], v16 offset:51200
    v_mfma_f32_16x16x32_bf16 v[44:47], v[224:227], v[140:143], v[44:47]
    ds_read_b64_tr_b16 v[214:215], v16 offset:59392
    v_mfma_f32_16x16x32_bf16 v[52:55], v[220:223], a[124:127], v[52:55]
    ds_read_b64_tr_b16 v[216:217], v16 offset:52224
    v_mfma_f32_16x16x32_bf16 v[52:55], v[224:227], v[144:147], v[52:55]
    ds_read_b64_tr_b16 v[218:219], v16 offset:60416
    v_mfma_f32_16x16x32_bf16 v[60:63], v[220:223], a[188:191], v[60:63]
    buffer_load_dwordx2 v[92:93], v36, s[48:51], s86 offen sc1
    v_mfma_f32_16x16x32_bf16 v[60:63], v[224:227], v[148:151], v[60:63]
    s_add_u32 s86, s86, 4857856
    v_mfma_f32_16x16x32_bf16 v[68:71], v[220:223], a[252:255], v[68:71]
    v_mfma_f32_16x16x32_bf16 v[68:71], v[224:227], v[152:155], v[68:71]
    s_waitcnt lgkmcnt(4)
    v_mfma_f32_16x16x32_bf16 v[48:51], v[204:207], a[60:63], v[48:51]
    ds_read_b64_tr_b16 v[220:221], v17 offset:51200
    v_mfma_f32_16x16x32_bf16 v[48:51], v[208:211], v[140:143], v[48:51]
    ds_read_b64_tr_b16 v[222:223], v17 offset:59392
    v_mfma_f32_16x16x32_bf16 v[56:59], v[204:207], a[124:127], v[56:59]
    ds_read_b64_tr_b16 v[224:225], v17 offset:52224
    v_mfma_f32_16x16x32_bf16 v[56:59], v[208:211], v[144:147], v[56:59]
    ds_read_b64_tr_b16 v[226:227], v17 offset:60416
    v_mfma_f32_16x16x32_bf16 v[64:67], v[204:207], a[188:191], v[64:67]
    buffer_load_dwordx2 v[94:95], v36, s[48:51], s86 offen sc1
    v_mfma_f32_16x16x32_bf16 v[64:67], v[208:211], v[148:151], v[64:67]
    s_add_u32 s86, s86, 4857856
    v_mfma_f32_16x16x32_bf16 v[72:75], v[204:207], a[252:255], v[72:75]
    v_mfma_f32_16x16x32_bf16 v[72:75], v[208:211], v[152:155], v[72:75]
    s_waitcnt lgkmcnt(4)
    s_waitcnt vmcnt(11)
    v_lshlrev_b32 v236, 16, v76
    v_and_b32 v237, 0xffff0000, v76
    v_mfma_f32_16x16x32_bf16 v[44:47], v[212:215], v[156:159], v[44:47]
    s_waitcnt lgkmcnt(0)
    s_barrier
    v_mfma_f32_16x16x32_bf16 v[44:47], v[216:219], v[172:175], v[44:47]
    ds_read_b64_tr_b16 v[204:205], v16 offset:0
    v_lshlrev_b32 v238, 16, v77
    v_mfma_f32_16x16x32_bf16 v[52:55], v[212:215], v[160:163], v[52:55]
    ds_read_b64_tr_b16 v[206:207], v16 offset:8192
    v_and_b32 v239, 0xffff0000, v77
    v_mfma_f32_16x16x32_bf16 v[52:55], v[216:219], v[176:179], v[52:55]
    ds_read_b64_tr_b16 v[208:209], v16 offset:1024
    v_mfma_f32_16x16x32_bf16 v[60:63], v[212:215], v[164:167], v[60:63]
    ds_read_b64_tr_b16 v[210:211], v16 offset:9216
    v_mfma_f32_16x16x32_bf16 v[60:63], v[216:219], v[180:183], v[60:63]
    buffer_load_dwordx2 v[96:97], v36, s[48:51], s86 offen sc1
    v_mfma_f32_16x16x32_bf16 v[68:71], v[212:215], v[168:171], v[68:71]
    s_add_u32 s86, s86, 4857856
    v_mfma_f32_16x16x32_bf16 v[68:71], v[216:219], v[184:187], v[68:71]
    v_mfma_f32_16x16x32_bf16 v[48:51], v[220:223], v[156:159], v[48:51]
    ds_read_b64_tr_b16 v[212:213], v17 offset:0
    s_waitcnt vmcnt(10)
    v_lshlrev_b32 v42, 16, v78
    v_mfma_f32_16x16x32_bf16 v[48:51], v[224:227], v[172:175], v[48:51]
    ds_read_b64_tr_b16 v[214:215], v17 offset:8192
    v_and_b32 v78, 0xffff0000, v78
    v_mfma_f32_16x16x32_bf16 v[56:59], v[220:223], v[160:163], v[56:59]
    buffer_store_dword v255, off, s[48:51], s17 sc1
    v_mfma_f32_16x16x32_bf16 v[56:59], v[224:227], v[176:179], v[56:59]
    ds_read_b64_tr_b16 v[216:217], v17 offset:1024
    v_add_f32 v236, v236, v42
    v_mfma_f32_16x16x32_bf16 v[64:67], v[220:223], v[164:167], v[64:67]
    ds_read_b64_tr_b16 v[218:219], v17 offset:9216
    v_add_f32 v237, v237, v78
    v_mfma_f32_16x16x32_bf16 v[64:67], v[224:227], v[180:183], v[64:67]
    buffer_load_dwordx2 v[98:99], v36, s[48:51], s86 offen sc1
    v_mfma_f32_16x16x32_bf16 v[72:75], v[220:223], v[168:171], v[72:75]
    s_add_u32 s86, s86, 4857856
    v_lshlrev_b32 v43, 16, v79
    v_and_b32 v79, 0xffff0000, v79
    v_mfma_f32_16x16x32_bf16 v[72:75], v[224:227], v[184:187], v[72:75]
    s_waitcnt lgkmcnt(4)
    v_add_f32 v238, v238, v43
    v_add_f32 v239, v239, v79
    v_mfma_f32_16x16x32_bf16 v[44:47], v[204:207], v[20:23], v[44:47]
    ds_read_b64_tr_b16 v[220:221], v9 offset:384
    s_waitcnt vmcnt(11)
    v_lshlrev_b32 v40, 16, v80
    v_mfma_f32_16x16x32_bf16 v[44:47], v[208:211], v[188:191], v[44:47]
    ds_read_b64_tr_b16 v[222:223], v9 offset:2944
    v_and_b32 v80, 0xffff0000, v80
    v_mfma_f32_16x16x32_bf16 v[52:55], v[204:207], v[24:27], v[52:55]
    buffer_load_dwordx2 v[100:101], v36, s[48:51], s86 offen sc1
    v_mfma_f32_16x16x32_bf16 v[52:55], v[208:211], v[192:195], v[52:55]
    s_add_u32 s86, s86, 4857856
    v_add_f32 v236, v236, v40
    v_add_f32 v237, v237, v80
    v_mfma_f32_16x16x32_bf16 v[60:63], v[204:207], v[28:31], v[60:63]
    ds_read_b64_tr_b16 v[224:225], v9 offset:416
    v_lshlrev_b32 v41, 16, v81
    v_mfma_f32_16x16x32_bf16 v[60:63], v[208:211], v[196:199], v[60:63]
    ds_read_b64_tr_b16 v[226:227], v9 offset:2976
    v_and_b32 v81, 0xffff0000, v81
    v_mfma_f32_16x16x32_bf16 v[68:71], v[204:207], v[32:35], v[68:71]
    buffer_load_dwordx2 v[102:103], v36, s[48:51], s86 offen sc1
    v_mfma_f32_16x16x32_bf16 v[68:71], v[208:211], v[200:203], v[68:71]
    s_waitcnt lgkmcnt(4)
    v_add_f32 v238, v238, v41
    v_add_f32 v239, v239, v81
    v_mfma_f32_16x16x32_bf16 v[48:51], v[212:215], v[20:23], v[48:51]
    s_add_u32 s86, s86, 4857856
    s_waitcnt vmcnt(11)
    v_lshlrev_b32 v42, 16, v82
    v_and_b32 v82, 0xffff0000, v82
    v_mfma_f32_16x16x32_bf16 v[48:51], v[216:219], v[188:191], v[48:51]
    buffer_load_dwordx2 v[104:105], v36, s[48:51], s86 offen sc1
    v_mfma_f32_16x16x32_bf16 v[56:59], v[212:215], v[24:27], v[56:59]
    s_add_u32 s86, s86, 4857856
    v_add_f32 v236, v236, v42
    v_add_f32 v237, v237, v82
    v_mfma_f32_16x16x32_bf16 v[56:59], v[216:219], v[192:195], v[56:59]
    buffer_load_dword v254, v14, s[48:51], s68 offen sc1
    v_mfma_f32_16x16x32_bf16 v[64:67], v[212:215], v[28:31], v[64:67]
    buffer_load_dwordx2 v[106:107], v36, s[48:51], s86 offen sc1
    v_mfma_f32_16x16x32_bf16 v[64:67], v[216:219], v[196:199], v[64:67]
    v_lshlrev_b32 v43, 16, v83
    v_and_b32 v83, 0xffff0000, v83
    v_mfma_f32_16x16x32_bf16 v[72:75], v[212:215], v[32:35], v[72:75]
    v_add_f32 v238, v238, v43
    v_add_f32 v239, v239, v83
    v_mfma_f32_16x16x32_bf16 v[72:75], v[216:219], v[200:203], v[72:75]
    s_waitcnt lgkmcnt(2)
    s_waitcnt vmcnt(13)
    v_lshlrev_b32 v40, 16, v84
    v_and_b32 v84, 0xffff0000, v84
    v_mfma_f32_16x16x32_bf16 v[44:47], v[220:223], a[40:43], v[44:47]
    v_add_f32 v236, v236, v40
    v_add_f32 v237, v237, v84
    v_mfma_f32_16x16x32_bf16 v[52:55], v[220:223], a[104:107], v[52:55]
    v_lshlrev_b32 v41, 16, v85
    v_and_b32 v85, 0xffff0000, v85
    v_mfma_f32_16x16x32_bf16 v[60:63], v[220:223], a[168:171], v[60:63]
    v_add_f32 v238, v238, v41
    v_add_f32 v239, v239, v85
    v_mfma_f32_16x16x32_bf16 v[68:71], v[220:223], a[232:235], v[68:71]
    s_waitcnt lgkmcnt(0)
    v_mfma_f32_16x16x32_bf16 v[48:51], v[224:227], a[40:43], v[48:51]
    v_mfma_f32_16x16x32_bf16 v[56:59], v[224:227], a[104:107], v[56:59]
    v_mfma_f32_16x16x32_bf16 v[64:67], v[224:227], a[168:171], v[64:67]
    v_mfma_f32_16x16x32_bf16 v[72:75], v[224:227], a[232:235], v[72:75]
    s_waitcnt vmcnt(12)
    v_lshlrev_b32 v42, 16, v86
    v_and_b32 v86, 0xffff0000, v86
    s_sub_u32 s82, s12, 65536
    s_sub_u32 s83, s82, s65
    s_add_u32 s82, s82, s65
    s_add_u32 s83, s83, 1024
    v_cvt_pk_bf16_f32 v44, v44, v45
    v_cvt_pk_bf16_f32 v45, v46, v47
    v_cvt_pk_bf16_f32 v46, v48, v49
    v_cvt_pk_bf16_f32 v47, v50, v51
    v_or_b32 v44, 1, v44
    v_or_b32 v45, 1, v45
    v_or_b32 v46, 1, v46
    v_or_b32 v47, 1, v47
    v_cvt_pk_bf16_f32 v52, v52, v53
    buffer_store_dwordx4 v[44:47], v18, s[48:51], s82 offen sc1
    v_cvt_pk_bf16_f32 v53, v54, v55
    v_cvt_pk_bf16_f32 v54, v56, v57
    v_cvt_pk_bf16_f32 v55, v58, v59
    v_or_b32 v52, 1, v52
    v_or_b32 v53, 1, v53
    v_or_b32 v54, 1, v54
    v_or_b32 v55, 1, v55
    v_cvt_pk_bf16_f32 v60, v60, v61
    buffer_store_dwordx4 v[52:55], v18, s[48:51], s83 offen sc1
    v_cvt_pk_bf16_f32 v61, v62, v63
    v_cvt_pk_bf16_f32 v62, v64, v65
    v_cvt_pk_bf16_f32 v63, v66, v67
    v_or_b32 v60, 1, v60
    v_or_b32 v61, 1, v61
    v_or_b32 v62, 1, v62
    v_or_b32 v63, 1, v63
    v_cvt_pk_bf16_f32 v68, v68, v69
    buffer_store_dwordx4 v[60:63], v19, s[48:51], s82 offen sc1
    v_cvt_pk_bf16_f32 v69, v70, v71
    v_cvt_pk_bf16_f32 v70, v72, v73
    v_cvt_pk_bf16_f32 v71, v74, v75
    v_or_b32 v68, 1, v68
    v_or_b32 v69, 1, v69
    v_or_b32 v70, 1, v70
    v_or_b32 v71, 1, v71
    buffer_store_dwordx4 v[68:71], v19, s[48:51], s83 offen sc1
    v_add_f32 v236, v236, v42
    v_add_f32 v237, v237, v86
    v_lshlrev_b32 v43, 16, v87
    v_and_b32 v87, 0xffff0000, v87
    v_add_f32 v238, v238, v43
    v_add_f32 v239, v239, v87
    s_waitcnt vmcnt(15)
    v_lshlrev_b32 v40, 16, v88
    v_and_b32 v88, 0xffff0000, v88
    v_add_f32 v236, v236, v40
    v_add_f32 v237, v237, v88
    v_lshlrev_b32 v41, 16, v89
    v_and_b32 v89, 0xffff0000, v89
    v_add_f32 v238, v238, v41
    v_add_f32 v239, v239, v89
    s_waitcnt vmcnt(14)
    v_lshlrev_b32 v42, 16, v90
    v_and_b32 v90, 0xffff0000, v90
    v_add_f32 v236, v236, v42
    v_add_f32 v237, v237, v90
    v_lshlrev_b32 v43, 16, v91
    v_and_b32 v91, 0xffff0000, v91
    v_add_f32 v238, v238, v43
    v_add_f32 v239, v239, v91
    v_lshlrev_b32 v40, 16, v240
    v_and_b32 v240, 0xffff0000, v240
    v_fmamk_f32 v236, v236, 0x4091afa4, v40
    v_fmamk_f32 v237, v237, 0x4091afa4, v240
    v_lshlrev_b32 v41, 16, v241
    v_cvt_pk_bf16_f32 v240, v236, v237
    v_and_b32 v241, 0xffff0000, v241
    v_fmamk_f32 v238, v238, 0x4091afa4, v41
    v_fmamk_f32 v239, v239, 0x4091afa4, v241
    s_waitcnt vmcnt(13)
    v_lshlrev_b32 v244, 16, v92
    v_cvt_pk_bf16_f32 v241, v238, v239
    v_and_b32 v245, 0xffff0000, v92
    v_lshlrev_b32 v246, 16, v93
    v_and_b32 v247, 0xffff0000, v93
    s_waitcnt vmcnt(12)
    v_lshlrev_b32 v42, 16, v94
    v_and_b32 v94, 0xffff0000, v94
    v_add_f32 v244, v244, v42
    v_add_f32 v245, v245, v94
    v_lshlrev_b32 v43, 16, v95
    v_and_b32 v95, 0xffff0000, v95
    v_add_f32 v246, v246, v43
    v_add_f32 v247, v247, v95
    s_waitcnt vmcnt(11)
    v_lshlrev_b32 v40, 16, v96
    v_and_b32 v96, 0xffff0000, v96
    v_add_f32 v244, v244, v40
    v_add_f32 v245, v245, v96
    v_lshlrev_b32 v41, 16, v97
    v_and_b32 v97, 0xffff0000, v97
    v_add_f32 v246, v246, v41
    v_add_f32 v247, v247, v97
    s_waitcnt vmcnt(9)
    v_lshlrev_b32 v42, 16, v98
    v_and_b32 v98, 0xffff0000, v98
    v_add_f32 v244, v244, v42
    v_add_f32 v245, v245, v98
    v_lshlrev_b32 v43, 16, v99
    v_and_b32 v99, 0xffff0000, v99
    v_add_f32 v246, v246, v43
    v_add_f32 v247, v247, v99
    s_waitcnt vmcnt(8)
    v_lshlrev_b32 v40, 16, v100
    v_and_b32 v100, 0xffff0000, v100
    v_add_f32 v244, v244, v40
    v_add_f32 v245, v245, v100
    v_lshlrev_b32 v41, 16, v101
    v_and_b32 v101, 0xffff0000, v101
    v_add_f32 v246, v246, v41
    v_add_f32 v247, v247, v101
    s_waitcnt vmcnt(7)
    v_lshlrev_b32 v42, 16, v102
    v_and_b32 v102, 0xffff0000, v102
    v_add_f32 v244, v244, v42
    v_add_f32 v245, v245, v102
    v_lshlrev_b32 v43, 16, v103
    v_and_b32 v103, 0xffff0000, v103
    v_add_f32 v246, v246, v43
    v_add_f32 v247, v247, v103
    s_waitcnt vmcnt(6)
    v_lshlrev_b32 v40, 16, v104
    v_and_b32 v104, 0xffff0000, v104
    v_add_f32 v244, v244, v40
    v_add_f32 v245, v245, v104
    v_lshlrev_b32 v41, 16, v105
    v_and_b32 v105, 0xffff0000, v105
    v_add_f32 v246, v246, v41
    v_add_f32 v247, v247, v105
    s_waitcnt vmcnt(4)
    v_lshlrev_b32 v42, 16, v106
    v_and_b32 v106, 0xffff0000, v106
    v_add_f32 v244, v244, v42
    v_add_f32 v245, v245, v106
    v_lshlrev_b32 v43, 16, v107
    v_and_b32 v107, 0xffff0000, v107
    v_add_f32 v246, v246, v43
    v_add_f32 v247, v247, v107
    v_lshlrev_b32 v40, 16, v248
    v_and_b32 v248, 0xffff0000, v248
    v_fmamk_f32 v244, v244, 0x4091afa4, v40
    v_fmamk_f32 v245, v245, 0x4091afa4, v248
    v_lshlrev_b32 v41, 16, v249
    v_cvt_pk_bf16_f32 v248, v244, v245
    v_and_b32 v249, 0xffff0000, v249
    v_fmamk_f32 v246, v246, 0x4091afa4, v41
    v_fmamk_f32 v247, v247, 0x4091afa4, v249
    v_cvt_pk_bf16_f32 v249, v246, v247
    v_cmp_gt_u32 vcc, 9, v254
    s_nop 0
    s_cbranch_vccnz L_sp_r3
L_bk_r3:
    buffer_load_dwordx2 v[108:109], v36, s[48:51], s36 offen sc1
    s_add_u32 s36, s36, 4857856
    buffer_load_dwordx2 v[110:111], v36, s[48:51], s36 offen sc1
    s_add_u32 s36, s36, 4857856
    buffer_load_dwordx2 v[112:113], v36, s[48:51], s36 offen sc1
    s_add_u32 s36, s36, 4857856
    buffer_load_dwordx2 v[114:115], v36, s[48:51], s36 offen sc1
    s_add_u32 s36, s36, 4857856
    buffer_load_dwordx2 v[116:117], v36, s[48:51], s36 offen sc1
    s_add_u32 s36, s36, 4857856
    buffer_load_dwordx2 v[118:119], v36, s[48:51], s36 offen sc1
    s_add_u32 s36, s36, 4857856
    buffer_load_dwordx2 v[120:121], v36, s[48:51], s36 offen sc1
    s_add_u32 s36, s36, 4857856
    buffer_load_dwordx2 v[122:123], v36, s[48:51], s36 offen sc1
    buffer_load_dword v138, v14, s[48:51], s68 offen sc1
    s_waitcnt vmcnt(8)
    v_lshlrev_b32 v124, 16, v108
    v_and_b32 v125, 0xffff0000, v108
    v_lshlrev_b32 v126, 16, v109
    v_and_b32 v127, 0xffff0000, v109
    s_waitcnt vmcnt(7)
    v_lshlrev_b32 v42, 16, v110
    v_and_b32 v110, 0xffff0000, v110
    v_add_f32 v124, v124, v42
    v_add_f32 v125, v125, v110
    v_lshlrev_b32 v43, 16, v111
    v_and_b32 v111, 0xffff0000, v111
    v_add_f32 v126, v126, v43
    v_add_f32 v127, v127, v111
    s_waitcnt vmcnt(6)
    v_lshlrev_b32 v40, 16, v112
    v_and_b32 v112, 0xffff0000, v112
    v_add_f32 v124, v124, v40
    v_add_f32 v125, v125, v112
    v_lshlrev_b32 v41, 16, v113
    v_and_b32 v113, 0xffff0000, v113
    v_add_f32 v126, v126, v41
    v_add_f32 v127, v127, v113
    s_waitcnt vmcnt(5)
    v_lshlrev_b32 v42, 16, v114
    v_and_b32 v114, 0xffff0000, v114
    v_add_f32 v124, v124, v42
    v_add_f32 v125, v125, v114
    v_lshlrev_b32 v43, 16, v115
    v_and_b32 v115, 0xffff0000, v115
    v_add_f32 v126, v126, v43
    v_add_f32 v127, v127, v115
    s_waitcnt vmcnt(4)
    v_lshlrev_b32 v40, 16, v116
    v_and_b32 v116, 0xffff0000, v116
    v_add_f32 v124, v124, v40
    v_add_f32 v125, v125, v116
    v_lshlrev_b32 v41, 16, v117
    v_and_b32 v117, 0xffff0000, v117
    v_add_f32 v126, v126, v41
    v_add_f32 v127, v127, v117
    s_waitcnt vmcnt(3)
    v_lshlrev_b32 v42, 16, v118
    v_and_b32 v118, 0xffff0000, v118
    v_add_f32 v124, v124, v42
    v_add_f32 v125, v125, v118
    v_lshlrev_b32 v43, 16, v119
    v_and_b32 v119, 0xffff0000, v119
    v_add_f32 v126, v126, v43
    v_add_f32 v127, v127, v119
    s_waitcnt vmcnt(2)
    v_lshlrev_b32 v40, 16, v120
    v_and_b32 v120, 0xffff0000, v120
    v_add_f32 v124, v124, v40
    v_add_f32 v125, v125, v120
    v_lshlrev_b32 v41, 16, v121
    v_and_b32 v121, 0xffff0000, v121
    v_add_f32 v126, v126, v41
    v_add_f32 v127, v127, v121
    v_lshlrev_b32 v40, 16, v250
    v_and_b32 v250, 0xffff0000, v250
    s_waitcnt vmcnt(1)
    v_lshlrev_b32 v42, 16, v122
    v_and_b32 v122, 0xffff0000, v122
    v_add_f32 v124, v124, v42
    v_add_f32 v125, v125, v122
    v_lshlrev_b32 v43, 16, v123
    v_and_b32 v123, 0xffff0000, v123
    v_add_f32 v126, v126, v43
    v_add_f32 v127, v127, v123
    v_fmamk_f32 v124, v124, 0x4091afa4, v40
    v_fmamk_f32 v125, v125, 0x4091afa4, v250
    v_lshlrev_b32 v41, 16, v251
    v_cvt_pk_bf16_f32 v250, v124, v125
    v_and_b32 v251, 0xffff0000, v251
    v_fmamk_f32 v126, v126, 0x4091afa4, v41
    v_fmamk_f32 v127, v127, 0x4091afa4, v251
    v_cvt_pk_bf16_f32 v251, v126, v127
    s_waitcnt vmcnt(0)
    v_cmp_gt_u32 vcc, 10, v138
    s_nop 0
    s_cbranch_vccnz L_sp_r4
L_bk_r4:
    buffer_load_dwordx2 v[204:205], v36, s[48:51], s38 offen sc1
    s_add_u32 s38, s38, 180736
    buffer_load_dwordx2 v[206:207], v36, s[48:51], s38 offen sc1
    s_add_u32 s38, s38, 180736
    buffer_load_dwordx2 v[208:209], v36, s[48:51], s38 offen sc1
    s_add_u32 s38, s38, 180736
    buffer_load_dwordx2 v[210:211], v36, s[48:51], s38 offen sc1
    s_add_u32 s38, s38, 180736
    buffer_load_dwordx2 v[212:213], v36, s[48:51], s38 offen sc1
    s_add_u32 s38, s38, 180736
    buffer_load_dwordx2 v[214:215], v36, s[48:51], s38 offen sc1
    s_add_u32 s38, s38, 180736
    buffer_load_dwordx2 v[216:217], v36, s[48:51], s38 offen sc1
    s_add_u32 s38, s38, 180736
    buffer_load_dwordx2 v[218:219], v36, s[48:51], s38 offen sc1
    buffer_store_dwordx2 v[240:241], v37, s[28:31], s67 offen
    buffer_store_dwordx2 v[248:249], v37, s[28:31], s87 offen
    buffer_store_dwordx2 v[250:251], v37, s[28:31], s37 offen
    s_waitcnt vmcnt(10)
    v_bitop3_b32 v140, v204, v205, 1 bitop3:0x80
    s_waitcnt vmcnt(9)
    v_bitop3_b32 v140, v206, v207, v140 bitop3:0x80
    s_waitcnt vmcnt(8)
    v_bitop3_b32 v140, v208, v209, v140 bitop3:0x80
    s_waitcnt vmcnt(7)
    v_bitop3_b32 v140, v210, v211, v140 bitop3:0x80
    s_waitcnt vmcnt(6)
    v_bitop3_b32 v140, v212, v213, v140 bitop3:0x80
    s_waitcnt vmcnt(5)
    v_bitop3_b32 v140, v214, v215, v140 bitop3:0x80
    s_waitcnt vmcnt(4)
    v_bitop3_b32 v140, v216, v217, v140 bitop3:0x80
    s_waitcnt vmcnt(3)
    v_bitop3_b32 v140, v218, v219, v140 bitop3:0x80
    v_cmp_eq_u32 vcc, 0, v140
    s_nop 0
    s_cbranch_vccnz L_rt
L_rtb:
    v_lshlrev_b32 v132, 16, v204
    v_and_b32 v133, 0xffff0000, v204
    v_lshlrev_b32 v134, 16, v205
    v_and_b32 v135, 0xffff0000, v205
    v_lshlrev_b32 v40, 16, v206
    v_and_b32 v41, 0xffff0000, v206
    v_pk_add_f32 v[132:133], v[132:133], v[40:41]
    v_lshlrev_b32 v42, 16, v207
    v_and_b32 v43, 0xffff0000, v207
    v_pk_add_f32 v[134:135], v[134:135], v[42:43]
    v_lshlrev_b32 v40, 16, v208
    v_and_b32 v41, 0xffff0000, v208
    v_pk_add_f32 v[132:133], v[132:133], v[40:41]
    v_lshlrev_b32 v42, 16, v209
    v_and_b32 v43, 0xffff0000, v209
    v_pk_add_f32 v[134:135], v[134:135], v[42:43]
    v_lshlrev_b32 v40, 16, v210
    v_and_b32 v41, 0xffff0000, v210
    v_pk_add_f32 v[132:133], v[132:133], v[40:41]
    v_lshlrev_b32 v42, 16, v211
    v_and_b32 v43, 0xffff0000, v211
    v_pk_add_f32 v[134:135], v[134:135], v[42:43]
    v_lshlrev_b32 v40, 16, v212
    v_and_b32 v41, 0xffff0000, v212
    v_pk_add_f32 v[132:133], v[132:133], v[40:41]
    v_lshlrev_b32 v42, 16, v213
    v_and_b32 v43, 0xffff0000, v213
    v_pk_add_f32 v[134:135], v[134:135], v[42:43]
    v_lshlrev_b32 v40, 16, v214
    v_and_b32 v41, 0xffff0000, v214
    v_pk_add_f32 v[132:133], v[132:133], v[40:41]
    v_lshlrev_b32 v42, 16, v215
    v_and_b32 v43, 0xffff0000, v215
    v_pk_add_f32 v[134:135], v[134:135], v[42:43]
    v_lshlrev_b32 v40, 16, v216
    v_and_b32 v41, 0xffff0000, v216
    v_pk_add_f32 v[132:133], v[132:133], v[40:41]
    v_lshlrev_b32 v42, 16, v217
    v_and_b32 v43, 0xffff0000, v217
    v_pk_add_f32 v[134:135], v[134:135], v[42:43]
    v_lshlrev_b32 v40, 16, v218
    v_and_b32 v41, 0xffff0000, v218
    v_pk_add_f32 v[132:133], v[132:133], v[40:41]
    v_lshlrev_b32 v42, 16, v219
    v_and_b32 v43, 0xffff0000, v219
    v_pk_add_f32 v[134:135], v[134:135], v[42:43]
    v_lshlrev_b32 v40, 16, v6
    v_and_b32 v6, 0xffff0000, v6
    v_fmamk_f32 v132, v132, 0x4091afa4, v40
    v_fmamk_f32 v133, v133, 0x4091afa4, v6
    v_cvt_pk_bf16_f32 v6, v132, v133
    v_lshlrev_b32 v41, 16, v7
    v_and_b32 v7, 0xffff0000, v7
    v_fmamk_f32 v134, v134, 0x4091afa4, v41
    v_fmamk_f32 v135, v135, 0x4091afa4, v7
    v_cvt_pk_bf16_f32 v7, v134, v135
    buffer_store_dwordx2 v[6:7], v37, s[28:31], s39 offen
L_endA:
    s_endpgm
L_pad13:
    s_branch L_padretB
L_sig0:
    s_mov_b64 exec, 1
    global_atomic_inc v0, v18, s[20:21] sc1
    s_mov_b64 exec, -1
    s_branch L_sigb0
L_sig1:
    s_mov_b64 exec, 1
    global_atomic_inc v0, v18, s[20:21] sc1
    s_mov_b64 exec, -1
    s_branch L_sigb1
L_sig2:
    s_mov_b64 exec, 1
    global_atomic_inc v0, v18, s[20:21] sc1
    s_mov_b64 exec, -1
    s_branch L_sigb2
L_sig3:
    s_mov_b64 exec, 1
    global_atomic_inc v0, v18, s[20:21] sc1
    s_mov_b64 exec, -1
    s_branch L_sigb3
L_sig4:
    s_mov_b64 exec, 1
    global_atomic_inc v0, v18, s[20:21] sc1
    s_mov_b64 exec, -1
    s_branch L_sigb4
L_sig5:
    s_mov_b64 exec, 1
    global_atomic_inc v0, v18, s[20:21] sc1
    s_mov_b64 exec, -1
    s_branch L_sigb5
L_sig6:
    s_mov_b64 exec, 1
    global_atomic_inc v0, v18, s[20:21] sc1
    s_mov_b64 exec, -1
    s_branch L_sigb6
L_sig7:
    s_mov_b64 exec, 1
    global_atomic_inc v0, v18, s[20:21] sc1
    s_mov_b64 exec, -1
    s_branch L_sigb7
L_sp_init:
    s_mov_b32 s16, 0
L_lp_init:
    s_sleep 64
    global_load_dword v249, v248, s[20:21] sc1
    s_waitcnt vmcnt(0)
    s_add_u32 s16, s16, 1
    s_cmp_gt_u32 s16, 0x40000
    s_cbranch_scc1 L_bk_init
    v_cmp_gt_u32 vcc, 256, v249
    s_nop 4
    s_cbranch_vccnz L_lp_init
    s_branch L_bk_init
L_sp_kv:
    s_mov_b32 s16, 0
L_lp_kv:
    s_sleep 3
    buffer_load_dword v249, v248, s[48:51], s83 offen sc1
    s_waitcnt vmcnt(0)
    s_add_u32 s16, s16, 1
    s_cmp_gt_u32 s16, 0x40000
    s_cbranch_scc1 L_bk_kv
    v_cmp_gt_u32 vcc, 1, v249
    s_nop 4
    s_cbranch_vccnz L_lp_kv
    s_branch L_bk_kv
L_sp_ha:
    s_mov_b32 s16, 0
L_lp_ha:
    s_sleep 3
    buffer_load_dword v254, v253, s[48:51], s15 offen sc1
    s_waitcnt vmcnt(0)
    s_add_u32 s16, s16, 1
    s_cmp_gt_u32 s16, 0x40000
    s_cbranch_scc1 L_bk_ha
    v_cmp_gt_u32 vcc, 2, v254
    s_nop 4
    s_cbranch_vccnz L_lp_ha
    s_branch L_bk_ha
L_sp_ha2:
    s_mov_b32 s16, 0
L_lp_ha2:
    s_sleep 3
    buffer_load_dword v254, v253, s[48:51], s15 offen sc1
    s_waitcnt vmcnt(0)
    s_add_u32 s16, s16, 1
    s_cmp_gt_u32 s16, 0x40000
    s_cbranch_scc1 L_bk_ha2
    v_cmp_gt_u32 vcc, 3, v254
    s_nop 4
    s_cbranch_vccnz L_lp_ha2
    s_branch L_bk_ha2
L_sp_hb:
    s_mov_b32 s16, 0
L_lp_hb:
    s_sleep 3
    buffer_load_dword v254, v253, s[48:51], s15 offen sc1
    s_waitcnt vmcnt(0)
    s_add_u32 s16, s16, 1
    s_cmp_gt_u32 s16, 0x40000
    s_cbranch_scc1 L_bk_hb
    v_cmp_gt_u32 vcc, 4, v254
    s_nop 4
    s_cbranch_vccnz L_lp_hb
    s_branch L_bk_hb
L_sp_hc:
    s_mov_b32 s16, 0
L_lp_hc:
    s_sleep 3
    buffer_load_dword v254, v253, s[48:51], s15 offen sc1
    s_waitcnt vmcnt(0)
    s_add_u32 s16, s16, 1
    s_cmp_gt_u32 s16, 0x40000
    s_cbranch_scc1 L_bk_hc
    v_cmp_gt_u32 vcc, 5, v254
    s_nop 4
    s_cbranch_vccnz L_lp_hc
    s_branch L_bk_hc
L_sp_r0:
    s_mov_b32 s16, 0
L_lp_r0:
    s_sleep 3
    buffer_load_dword v254, v14, s[48:51], s68 offen sc1
    s_waitcnt vmcnt(0)
    s_add_u32 s16, s16, 1
    s_cmp_gt_u32 s16, 0x40000
    s_cbranch_scc1 L_bk_r0
    v_cmp_gt_u32 vcc, 6, v254
    s_nop 4
    s_cbranch_vccnz L_lp_r0
    s_branch L_bk_r0
L_sp_r1:
    s_mov_b32 s16, 0
L_lp_r1:
    s_sleep 3
    buffer_load_dword v254, v14, s[48:51], s68 offen sc1
    s_waitcnt vmcnt(0)
    s_add_u32 s16, s16, 1
    s_cmp_gt_u32 s16, 0x40000
    s_cbranch_scc1 L_bk_r1
    v_cmp_gt_u32 vcc, 8, v254
    s_nop 4
    s_cbranch_vccnz L_lp_r1
    s_branch L_bk_r1
L_sp_r3:
    s_mov_b32 s16, 0
L_lp_r3:
    s_sleep 3
    buffer_load_dword v254, v14, s[48:51], s68 offen sc1
    s_waitcnt vmcnt(0)
    s_add_u32 s16, s16, 1
    s_cmp_gt_u32 s16, 0x40000
    s_cbranch_scc1 L_bk_r3
    v_cmp_gt_u32 vcc, 9, v254
    s_nop 4
    s_cbranch_vccnz L_lp_r3
    s_branch L_bk_r3
L_sp_r4:
    s_mov_b32 s16, 0
L_lp_r4:
    s_sleep 3
    buffer_load_dword v138, v14, s[48:51], s68 offen sc1
    s_waitcnt vmcnt(0)
    s_add_u32 s16, s16, 1
    s_cmp_gt_u32 s16, 0x40000
    s_cbranch_scc1 L_bk_r4
    v_cmp_gt_u32 vcc, 10, v138
    s_nop 4
    s_cbranch_vccnz L_lp_r4
    s_branch L_bk_r4
L_rt:
    s_mov_b32 s16, 0
L_rt2:
    s_sub_u32 s38, s38, 1265152
    buffer_load_dwordx2 v[204:205], v36, s[48:51], s38 offen sc1
    s_add_u32 s38, s38, 180736
    buffer_load_dwordx2 v[206:207], v36, s[48:51], s38 offen sc1
    s_add_u32 s38, s38, 180736
    buffer_load_dwordx2 v[208:209], v36, s[48:51], s38 offen sc1
    s_add_u32 s38, s38, 180736
    buffer_load_dwordx2 v[210:211], v36, s[48:51], s38 offen sc1
    s_add_u32 s38, s38, 180736
    buffer_load_dwordx2 v[212:213], v36, s[48:51], s38 offen sc1
    s_add_u32 s38, s38, 180736
    buffer_load_dwordx2 v[214:215], v36, s[48:51], s38 offen sc1
    s_add_u32 s38, s38, 180736
    buffer_load_dwordx2 v[216:217], v36, s[48:51], s38 offen sc1
    s_add_u32 s38, s38, 180736
    buffer_load_dwordx2 v[218:219], v36, s[48:51], s38 offen sc1
    s_waitcnt vmcnt(0)
    s_add_u32 s16, s16, 1
    s_cmp_gt_u32 s16, 0x20000
    s_cbranch_scc1 L_rtb
    v_bitop3_b32 v140, v204, v205, 1 bitop3:0x80
    v_bitop3_b32 v140, v206, v207, v140 bitop3:0x80
    v_bitop3_b32 v140, v208, v209, v140 bitop3:0x80
    v_bitop3_b32 v140, v210, v211, v140 bitop3:0x80
    v_bitop3_b32 v140, v212, v213, v140 bitop3:0x80
    v_bitop3_b32 v140, v214, v215, v140 bitop3:0x80
    v_bitop3_b32 v140, v216, v217, v140 bitop3:0x80
    v_bitop3_b32 v140, v218, v219, v140 bitop3:0x80
    v_cmp_eq_u32 vcc, 0, v140
    s_nop 1
    s_cbranch_vccnz L_rt2
    s_branch L_rtb
.p2align 7
.type L_tbl,@object
L_tbl:
.long 0x22000, 0x22500, 0x22c00, 0x22040
.long 0x22050, 0x22550, 0x22c10, 0x22090
.long 0x220a0, 0x22c20, 0x22c20, 0x220e0
.long 0x220f0, 0x22c30, 0x22c30, 0x22130
.long 0x22140, 0x22c40, 0x22c40, 0x22180
.long 0x22190, 0x22c50, 0x22c50, 0x221d0
.long 0x221e0, 0x22c60, 0x22c60, 0x22220
.long 0x22230, 0x22c70, 0x22c70, 0x22270
.long 0x22280, 0x22c80, 0x22b40, 0x222c0
.long 0x222d0, 0x22c90, 0x22c90, 0x22310
.long 0x22320, 0x22ca0, 0x22ca0, 0x22360
.long 0x22370, 0x22cb0, 0x22cb0, 0x223b0
.long 0x223c0, 0x22cc0, 0x22cc0, 0x22400
.long 0x22410, 0x22cd0, 0x22cd0, 0x22450
.long 0x22460, 0x22ce0, 0x22ce0, 0x224a0
.long 0x224b0, 0x22cf0, 0x22cf0, 0x224f0
.long 0x22010, 0x22510, 0x22d00, 0x22d00
.long 0x22060, 0x22560, 0x22d10, 0x22d10
.long 0x220b0, 0x22d20, 0x22d20, 0x22d20
.long 0x22100, 0x22d30, 0x22d30, 0x22d30
.long 0x22150, 0x22d40, 0x22d40, 0x22d40
.long 0x221a0, 0x22d50, 0x22d50, 0x22d50
.long 0x221f0, 0x22d60, 0x22d60, 0x22d60
.long 0x22240, 0x22d70, 0x22d70, 0x22d70
.long 0x22290, 0x22d80, 0x22b50, 0x22d80
.long 0x222e0, 0x22d90, 0x22d90, 0x22d90
.long 0x22330, 0x22da0, 0x22da0, 0x22da0
.long 0x22380, 0x22db0, 0x22db0, 0x22db0
.long 0x223d0, 0x22dc0, 0x22dc0, 0x22dc0
.long 0x22420, 0x22dd0, 0x22dd0, 0x22dd0
.long 0x22470, 0x22de0, 0x22de0, 0x22de0
.long 0x224c0, 0x22df0, 0x22df0, 0x22df0
.long 0x22020, 0x22520, 0x22e00, 0x22e00
.long 0x22070, 0x22570, 0x22e10, 0x22e10
.long 0x220c0, 0x22e20, 0x22e20, 0x22e20
.long 0x22110, 0x22e30, 0x22e30, 0x22e30
.long 0x22160, 0x22e40, 0x22e40, 0x22e40
.long 0x221b0, 0x22e50, 0x22e50, 0x22e50
.long 0x22200, 0x22e60, 0x22e60, 0x22e60
.long 0x22250, 0x22e70, 0x22e70, 0x22e70
.long 0x222a0, 0x22e80, 0x22b60, 0x22e80
.long 0x222f0, 0x22e90, 0x22e90, 0x22e90
.long 0x22340, 0x22ea0, 0x22ea0, 0x22ea0
.long 0x22390, 0x22eb0, 0x22eb0, 0x22eb0
.long 0x223e0, 0x22ec0, 0x22ec0, 0x22ec0
.long 0x22430, 0x22ed0, 0x22ed0, 0x22ed0
.long 0x22480, 0x22ee0, 0x22ee0, 0x22ee0
.long 0x224d0, 0x22ef0, 0x22ef0, 0x22ef0
.long 0x22030, 0x22530, 0x22f00, 0x22f00
.long 0x22080, 0x22580, 0x22f10, 0x22f10
.long 0x220d0, 0x22f20, 0x22f20, 0x22f20
.long 0x22120, 0x22f30, 0x22f30, 0x22f30
.long 0x22170, 0x22f40, 0x22f40, 0x22f40
.long 0x221c0, 0x22f50, 0x22f50, 0x22f50
.long 0x22210, 0x22f60, 0x22f60, 0x22f60
.long 0x22260, 0x22f70, 0x22f70, 0x22f70
.long 0x222b0, 0x22f80, 0x22b70, 0x22f80
.long 0x22300, 0x22f90, 0x22f90, 0x22f90
.long 0x22350, 0x22fa0, 0x22fa0, 0x22fa0
.long 0x223a0, 0x22fb0, 0x22fb0, 0x22fb0
.long 0x223f0, 0x22fc0, 0x22fc0, 0x22fc0
.long 0x22440, 0x22fd0, 0x22fd0, 0x22fd0
.long 0x22490, 0x22fe0, 0x22fe0, 0x22fe0
.long 0x224e0, 0x22ff0, 0x22ff0, 0x22ff0
.long 0x22540, 0x22c00, 0x22c00, 0x22c00
.long 0x22590, 0x22c10, 0x22c10, 0x22c10
.long 0x225a0, 0x22c20, 0x225e0, 0x22c20
.long 0x225f0, 0x22c30, 0x22630, 0x22c30
.long 0x22640, 0x22a00, 0x22680, 0x22a40
.long 0x22690, 0x22a50, 0x226d0, 0x22a90
.long 0x226e0, 0x22aa0, 0x22720, 0x22ae0
.long 0x22730, 0x22af0, 0x22770, 0x22b30
.long 0x22780, 0x22b80, 0x227c0, 0x22c80
.long 0x227d0, 0x22b90, 0x22810, 0x22bd0
.long 0x22820, 0x22ca0, 0x22860, 0x22ca0
.long 0x22870, 0x22cb0, 0x228b0, 0x22cb0
.long 0x228c0, 0x22cc0, 0x22900, 0x22cc0
.long 0x22910, 0x22cd0, 0x22950, 0x22cd0
.long 0x22960, 0x22ce0, 0x229a0, 0x22ce0
.long 0x229b0, 0x22cf0, 0x229f0, 0x22cf0
.long 0x22d00, 0x22d00, 0x22d00, 0x22d00
.long 0x22d10, 0x22d10, 0x22d10, 0x22d10
.long 0x225b0, 0x22d20, 0x22d20, 0x22d20
.long 0x22600, 0x22d30, 0x22d30, 0x22d30
.long 0x22650, 0x22a10, 0x22d40, 0x22d40
.long 0x226a0, 0x22a60, 0x22d50, 0x22d50
.long 0x226f0, 0x22ab0, 0x22d60, 0x22d60
.long 0x22740, 0x22b00, 0x22d70, 0x22d70
.long 0x22790, 0x22d80, 0x22d80, 0x22d80
.long 0x227e0, 0x22ba0, 0x22d90, 0x22d90
.long 0x22830, 0x22da0, 0x22da0, 0x22da0
.long 0x22880, 0x22db0, 0x22db0, 0x22db0
.long 0x228d0, 0x22dc0, 0x22dc0, 0x22dc0
.long 0x22920, 0x22dd0, 0x22dd0, 0x22dd0
.long 0x22970, 0x22de0, 0x22de0, 0x22de0
.long 0x229c0, 0x22df0, 0x22df0, 0x22df0
.long 0x22e00, 0x22e00, 0x22e00, 0x22e00
.long 0x22e10, 0x22e10, 0x22e10, 0x22e10
.long 0x225c0, 0x22e20, 0x22e20, 0x22e20
.long 0x22610, 0x22e30, 0x22e30, 0x22e30
.long 0x22660, 0x22a20, 0x22e40, 0x22e40
.long 0x226b0, 0x22a70, 0x22e50, 0x22e50
.long 0x22700, 0x22ac0, 0x22e60, 0x22e60
.long 0x22750, 0x22b10, 0x22e70, 0x22e70
.long 0x227a0, 0x22e80, 0x22e80, 0x22e80
.long 0x227f0, 0x22bb0, 0x22e90, 0x22e90
.long 0x22840, 0x22ea0, 0x22ea0, 0x22ea0
.long 0x22890, 0x22eb0, 0x22eb0, 0x22eb0
.long 0x228e0, 0x22ec0, 0x22ec0, 0x22ec0
.long 0x22930, 0x22ed0, 0x22ed0, 0x22ed0
.long 0x22980, 0x22ee0, 0x22ee0, 0x22ee0
.long 0x229d0, 0x22ef0, 0x22ef0, 0x22ef0
.long 0x22f00, 0x22f00, 0x22f00, 0x22f00
.long 0x22f10, 0x22f10, 0x22f10, 0x22f10
.long 0x225d0, 0x22f20, 0x22f20, 0x22f20
.long 0x22620, 0x22f30, 0x22f30, 0x22f30
.long 0x22670, 0x22a30, 0x22f40, 0x22f40
.long 0x226c0, 0x22a80, 0x22f50, 0x22f50
.long 0x22710, 0x22ad0, 0x22f60, 0x22f60
.long 0x22760, 0x22b20, 0x22f70, 0x22f70
.long 0x227b0, 0x22f80, 0x22f80, 0x22f80
.long 0x22800, 0x22bc0, 0x22f90, 0x22f90
.long 0x22850, 0x22fa0, 0x22fa0, 0x22fa0
.long 0x228a0, 0x22fb0, 0x22fb0, 0x22fb0
.long 0x228f0, 0x22fc0, 0x22fc0, 0x22fc0
.long 0x22940, 0x22fd0, 0x22fd0, 0x22fd0
.long 0x22990, 0x22fe0, 0x22fe0, 0x22fe0
.long 0x229e0, 0x22ff0, 0x22ff0, 0x22ff0
.long 0x26b40, 0x26b80, 0x26bf0, 0x26000
.long 0x26bf0, 0x26b90, 0x26bf0, 0x26050
.long 0x26b40, 0x26b80, 0x26bf0, 0x260a0
.long 0x26bf0, 0x26b90, 0x26bf0, 0x260f0
.long 0x26b40, 0x26b80, 0x26bf0, 0x26140
.long 0x26bf0, 0x26b90, 0x26bf0, 0x26190
.long 0x26b40, 0x26b80, 0x26bf0, 0x261e0
.long 0x26bf0, 0x26b90, 0x26bf0, 0x26230
.long 0x26b40, 0x26b80, 0x26bf0, 0x26280
.long 0x26bf0, 0x26b90, 0x26bf0, 0x262d0
.long 0x26b40, 0x26b80, 0x26bf0, 0x26320
.long 0x26bf0, 0x26b90, 0x26bf0, 0x26370
.long 0x26b40, 0x26b80, 0x26bf0, 0x263c0
.long 0x26bf0, 0x26b90, 0x26bf0, 0x26410
.long 0x26b40, 0x26b80, 0x26bf0, 0x26460
.long 0x26bf0, 0x26b90, 0x26bf0, 0x264b0
.long 0x26b50, 0x26bf0, 0x26bf0, 0x26010
.long 0x26bf0, 0x26ba0, 0x26bf0, 0x26060
.long 0x26b50, 0x26bf0, 0x26bf0, 0x260b0
.long 0x26bf0, 0x26ba0, 0x26bf0, 0x26100
.long 0x26b50, 0x26bf0, 0x26bf0, 0x26150
.long 0x26bf0, 0x26ba0, 0x26bf0, 0x261a0
.long 0x26b50, 0x26bf0, 0x26bf0, 0x261f0
.long 0x26bf0, 0x26ba0, 0x26bf0, 0x26240
.long 0x26b50, 0x26bf0, 0x26bf0, 0x26290
.long 0x26bf0, 0x26ba0, 0x26bf0, 0x262e0
.long 0x26b50, 0x26bf0, 0x26bf0, 0x26330
.long 0x26bf0, 0x26ba0, 0x26bf0, 0x26380
.long 0x26b50, 0x26bf0, 0x26bf0, 0x263d0
.long 0x26bf0, 0x26ba0, 0x26bf0, 0x26420
.long 0x26b50, 0x26bf0, 0x26bf0, 0x26470
.long 0x26bf0, 0x26ba0, 0x26bf0, 0x264c0
.long 0x26b60, 0x26bf0, 0x26bf0, 0x26020
.long 0x26bf0, 0x26bb0, 0x26bf0, 0x26070
.long 0x26b60, 0x26bf0, 0x26bf0, 0x260c0
.long 0x26bf0, 0x26bb0, 0x26bf0, 0x26110
.long 0x26b60, 0x26bf0, 0x26bf0, 0x26160
.long 0x26bf0, 0x26bb0, 0x26bf0, 0x261b0
.long 0x26b60, 0x26bf0, 0x26bf0, 0x26200
.long 0x26bf0, 0x26bb0, 0x26bf0, 0x26250
.long 0x26b60, 0x26bf0, 0x26bf0, 0x262a0
.long 0x26bf0, 0x26bb0, 0x26bf0, 0x262f0
.long 0x26b60, 0x26bf0, 0x26bf0, 0x26340
.long 0x26bf0, 0x26bb0, 0x26bf0, 0x26390
.long 0x26b60, 0x26bf0, 0x26bf0, 0x263e0
.long 0x26bf0, 0x26bb0, 0x26bf0, 0x26430
.long 0x26b60, 0x26bf0, 0x26bf0, 0x26480
.long 0x26bf0, 0x26bb0, 0x26bf0, 0x264d0
.long 0x26b70, 0x26bf0, 0x26bf0, 0x26030
.long 0x26bf0, 0x26bc0, 0x26bd0, 0x26080
.long 0x26b70, 0x26bf0, 0x26bf0, 0x260d0
.long 0x26bf0, 0x26bc0, 0x26bd0, 0x26120
.long 0x26b70, 0x26bf0, 0x26bf0, 0x26170
.long 0x26bf0, 0x26bc0, 0x26bd0, 0x261c0
.long 0x26b70, 0x26bf0, 0x26bf0, 0x26210
.long 0x26bf0, 0x26bc0, 0x26bd0, 0x26260
.long 0x26b70, 0x26bf0, 0x26bf0, 0x262b0
.long 0x26bf0, 0x26bc0, 0x26bd0, 0x26300
.long 0x26b70, 0x26bf0, 0x26bf0, 0x26350
.long 0x26bf0, 0x26bc0, 0x26bd0, 0x263a0
.long 0x26b70, 0x26bf0, 0x26bf0, 0x263f0
.long 0x26bf0, 0x26bc0, 0x26bd0, 0x26440
.long 0x26b70, 0x26bf0, 0x26bf0, 0x26490
.long 0x26bf0, 0x26bc0, 0x26bd0, 0x264e0
.long 0x26040, 0x26500, 0x26540, 0x26bf0
.long 0x26090, 0x26550, 0x26590, 0x26bf0
.long 0x260e0, 0x26bf0, 0x265a0, 0x26bf0
.long 0x26130, 0x26bf0, 0x265f0, 0x26bf0
.long 0x26180, 0x26bf0, 0x26640, 0x26bf0
.long 0x261d0, 0x26bf0, 0x26690, 0x26bf0
.long 0x26220, 0x26bf0, 0x266e0, 0x26bf0
.long 0x26270, 0x26bf0, 0x26730, 0x26bf0
.long 0x262c0, 0x26bf0, 0x26780, 0x26bf0
.long 0x26310, 0x26bf0, 0x267d0, 0x26bf0
.long 0x26360, 0x26bf0, 0x26820, 0x26bf0
.long 0x263b0, 0x26bf0, 0x26870, 0x26bf0
.long 0x26400, 0x26bf0, 0x268c0, 0x26bf0
.long 0x26450, 0x26bf0, 0x26910, 0x26bf0
.long 0x264a0, 0x26bf0, 0x26960, 0x26bf0
.long 0x264f0, 0x26bf0, 0x269b0, 0x26bf0
.long 0x26bf0, 0x26510, 0x26bf0, 0x26bf0
.long 0x26bf0, 0x26560, 0x26bf0, 0x26bf0
.long 0x26bf0, 0x26bf0, 0x265b0, 0x26bf0
.long 0x26bf0, 0x26bf0, 0x26600, 0x26bf0
.long 0x26bf0, 0x26bf0, 0x26650, 0x26bf0
.long 0x26bf0, 0x26bf0, 0x266a0, 0x26bf0
.long 0x26bf0, 0x26bf0, 0x266f0, 0x26bf0
.long 0x26bf0, 0x26bf0, 0x26740, 0x26bf0
.long 0x26bf0, 0x26bf0, 0x26790, 0x26bf0
.long 0x26bf0, 0x26bf0, 0x267e0, 0x26bf0
.long 0x26bf0, 0x26bf0, 0x26830, 0x26bf0
.long 0x26bf0, 0x26bf0, 0x26880, 0x26bf0
.long 0x26bf0, 0x26bf0, 0x268d0, 0x26bf0
.long 0x26bf0, 0x26bf0, 0x26920, 0x26bf0
.long 0x26bf0, 0x26bf0, 0x26970, 0x26bf0
.long 0x26bf0, 0x26bf0, 0x269c0, 0x26bf0
.long 0x26bf0, 0x26520, 0x26bf0, 0x26bf0
.long 0x26bf0, 0x26570, 0x26bf0, 0x26bf0
.long 0x26bf0, 0x26bf0, 0x265c0, 0x26bf0
.long 0x26bf0, 0x26bf0, 0x26610, 0x26bf0
.long 0x26bf0, 0x26bf0, 0x26660, 0x26bf0
.long 0x26bf0, 0x26bf0, 0x266b0, 0x26bf0
.long 0x26bf0, 0x26bf0, 0x26700, 0x26bf0
.long 0x26bf0, 0x26bf0, 0x26750, 0x26bf0
.long 0x26bf0, 0x26bf0, 0x267a0, 0x26bf0
.long 0x26bf0, 0x26bf0, 0x267f0, 0x26bf0
.long 0x26bf0, 0x26bf0, 0x26840, 0x26bf0
.long 0x26bf0, 0x26bf0, 0x26890, 0x26bf0
.long 0x26bf0, 0x26bf0, 0x268e0, 0x26bf0
.long 0x26bf0, 0x26bf0, 0x26930, 0x26bf0
.long 0x26bf0, 0x26bf0, 0x26980, 0x26bf0
.long 0x26bf0, 0x26bf0, 0x269d0, 0x26bf0
.long 0x26bf0, 0x26530, 0x26bf0, 0x26bf0
.long 0x26bf0, 0x26580, 0x26bf0, 0x26bf0
.long 0x26bf0, 0x26bf0, 0x265d0, 0x265e0
.long 0x26bf0, 0x26bf0, 0x26620, 0x26630
.long 0x26bf0, 0x26bf0, 0x26670, 0x26680
.long 0x26bf0, 0x26bf0, 0x266c0, 0x266d0
.long 0x26bf0, 0x26bf0, 0x26710, 0x26720
.long 0x26bf0, 0x26bf0, 0x26760, 0x26770
.long 0x26bf0, 0x26bf0, 0x267b0, 0x267c0
.long 0x26bf0, 0x26bf0, 0x26800, 0x26810
.long 0x26bf0, 0x26bf0, 0x26850, 0x26860
.long 0x26bf0, 0x26bf0, 0x268a0, 0x268b0
.long 0x26bf0, 0x26bf0, 0x268f0, 0x26900
.long 0x26bf0, 0x26bf0, 0x26940, 0x26950
.long 0x26bf0, 0x26bf0, 0x26990, 0x269a0
.long 0x26bf0, 0x26bf0, 0x269e0, 0x269f0
.long 0x26a00, 0x26bf0, 0xffffffff, 0xffffffff
.long 0x26a50, 0x26bf0, 0xffffffff, 0xffffffff
.long 0x26aa0, 0x26bf0, 0xffffffff, 0xffffffff
.long 0x26af0, 0x26bf0, 0xffffffff, 0xffffffff
.long 0x26bf0, 0x26bf0, 0xffffffff, 0x0
.long 0x26bf0, 0x26bf0, 0xffffffff, 0xffffffff
.long 0x26bf0, 0x26bf0, 0xffffffff, 0xffffffff
.long 0x26bf0, 0x26bf0, 0xffffffff, 0xffffffff
.long 0x26bf0, 0x26bf0, 0xffffffff, 0xffffffff
.long 0x26bf0, 0x26bf0, 0xffffffff, 0x0
.long 0x26bf0, 0x26bf0, 0xffffffff, 0xffffffff
.long 0x26bf0, 0x26bf0, 0xffffffff, 0xffffffff
.long 0x26bf0, 0x26bf0, 0xffffffff, 0xffffffff
.long 0x26bf0, 0x26bf0, 0xffffffff, 0xffffffff
.long 0x26bf0, 0x26bf0, 0xffffffff, 0x0
.long 0x26bf0, 0x26bf0, 0xffffffff, 0xffffffff
.long 0x26a10, 0x26bf0, 0xffffffff, 0xffffffff
.long 0x26a60, 0x26bf0, 0xffffffff, 0xffffffff
.long 0x26ab0, 0x26bf0, 0xffffffff, 0xffffffff
.long 0x26b00, 0x26bf0, 0xffffffff, 0x0
.long 0x26bf0, 0x26bf0, 0xffffffff, 0xffffffff
.long 0x26bf0, 0x26bf0, 0xffffffff, 0xffffffff
.long 0x26bf0, 0x26bf0, 0xffffffff, 0xffffffff
.long 0x26bf0, 0x26bf0, 0xffffffff, 0xffffffff
.long 0x26bf0, 0x26bf0, 0xffffffff, 0x0
.long 0x26bf0, 0x26bf0, 0xffffffff, 0xffffffff
.long 0x26bf0, 0x26bf0, 0xffffffff, 0xffffffff
.long 0x26bf0, 0x26bf0, 0xffffffff, 0xffffffff
.long 0x26bf0, 0x26bf0, 0xffffffff, 0xffffffff
.long 0x26bf0, 0x26bf0, 0xffffffff, 0x0
.long 0x26bf0, 0x26bf0, 0xffffffff, 0xffffffff
.long 0x26bf0, 0x26bf0, 0xffffffff, 0xffffffff
.long 0x26a20, 0x26bf0, 0xffffffff, 0xffffffff
.long 0x26a70, 0x26bf0, 0xffffffff, 0xffffffff
.long 0x26ac0, 0x26bf0, 0xffffffff, 0x0
.long 0x26b10, 0x26bf0, 0xffffffff, 0xffffffff
.long 0x26bf0, 0x26bf0, 0xffffffff, 0xffffffff
.long 0x26bf0, 0x26bf0, 0xffffffff, 0xffffffff
.long 0x26bf0, 0x26bf0, 0xffffffff, 0xffffffff
.long 0x26bf0, 0x26bf0, 0xffffffff, 0x0
.long 0x26bf0, 0x26bf0, 0xffffffff, 0xffffffff
.long 0x26bf0, 0x26bf0, 0xffffffff, 0xffffffff
.long 0x26bf0, 0x26bf0, 0xffffffff, 0xffffffff
.long 0x26bf0, 0x26bf0, 0xffffffff, 0xffffffff
.long 0x26bf0, 0x26bf0, 0xffffffff, 0x0
.long 0x26bf0, 0x26bf0, 0xffffffff, 0xffffffff
.long 0x26bf0, 0x26bf0, 0xffffffff, 0xffffffff
.long 0x26bf0, 0x26bf0, 0xffffffff, 0xffffffff
.long 0x26a30, 0x26a40, 0xffffffff, 0xffffffff
.long 0x26a80, 0x26a90, 0xffffffff, 0x0
.long 0x26ad0, 0x26ae0, 0xffffffff, 0xffffffff
.long 0x26b20, 0x26b30, 0xffffffff, 0xffffffff
.long 0x26bf0, 0x26bf0, 0xffffffff, 0xffffffff
.long 0x26bf0, 0x26bf0, 0xffffffff, 0xffffffff
.long 0x26bf0, 0x26bf0, 0xffffffff, 0x0
.long 0x26bf0, 0x26bf0, 0xffffffff, 0xffffffff
.long 0x26bf0, 0x26bf0, 0xffffffff, 0xffffffff
.long 0x26bf0, 0x26bf0, 0xffffffff, 0xffffffff
.long 0x26bf0, 0x26bf0, 0xffffffff, 0xffffffff
.long 0x26bf0, 0x26bf0, 0xffffffff, 0x0
.long 0x26bf0, 0x26bf0, 0xffffffff, 0xffffffff
.long 0x26bf0, 0x26bf0, 0xffffffff, 0xffffffff
.long 0x26bf0, 0x26bf0, 0xffffffff, 0xffffffff
.long 0x26bf0, 0x26bf0, 0xffffffff, 0xffffffff
.long 0x26a00, 0x26bf0, 0xffffffff, 0xffffffff
.long 0x26a50, 0x26bf0, 0xffffffff, 0x0
.long 0x26aa0, 0x26bf0, 0xffffffff, 0xffffffff
.long 0x26af0, 0x26bf0, 0xffffffff, 0xffffffff
.long 0x26bf0, 0x26bf0, 0xffffffff, 0xffffffff
.long 0x26bf0, 0x26bf0, 0xffffffff, 0xffffffff
.long 0x26bf0, 0x26bf0, 0xffffffff, 0x0
.long 0x26bf0, 0x26bf0, 0xffffffff, 0xffffffff
.long 0x26bf0, 0x26bf0, 0xffffffff, 0xffffffff
.long 0x26bf0, 0x26bf0, 0xffffffff, 0xffffffff
.long 0x26bf0, 0x26bf0, 0xffffffff, 0xffffffff
.long 0x26bf0, 0x26bf0, 0xffffffff, 0x0
.long 0x26bf0, 0x26bf0, 0xffffffff, 0xffffffff
.long 0x26bf0, 0x26bf0, 0xffffffff, 0xffffffff
.long 0x26bf0, 0x26bf0, 0xffffffff, 0xffffffff
.long 0x26bf0, 0x26bf0, 0xffffffff, 0xffffffff
.long 0x26a10, 0x26bf0, 0xffffffff, 0x0
.long 0x26a60, 0x26bf0, 0xffffffff, 0xffffffff
.long 0x26ab0, 0x26bf0, 0xffffffff, 0xffffffff
.long 0x26b00, 0x26bf0, 0xffffffff, 0xffffffff
.long 0x26bf0, 0x26bf0, 0xffffffff, 0xffffffff
.long 0x26bf0, 0x26bf0, 0xffffffff, 0x0
.long 0x26bf0, 0x26bf0, 0xffffffff, 0xffffffff
.long 0x26bf0, 0x26bf0, 0xffffffff, 0xffffffff
.long 0x26bf0, 0x26bf0, 0xffffffff, 0xffffffff
.long 0x26bf0, 0x26bf0, 0xffffffff, 0xffffffff
.long 0x26bf0, 0x26bf0, 0xffffffff, 0x0
.long 0x26bf0, 0x26bf0, 0xffffffff, 0xffffffff
.long 0x26bf0, 0x26bf0, 0xffffffff, 0xffffffff
.long 0x26bf0, 0x26bf0, 0xffffffff, 0xffffffff
.long 0x26bf0, 0x26bf0, 0xffffffff, 0xffffffff
.long 0x26bf0, 0x26bf0, 0xffffffff, 0x0
.long 0x26a20, 0x26bf0, 0xffffffff, 0xffffffff
.long 0x26a70, 0x26bf0, 0xffffffff, 0xffffffff
.long 0x26ac0, 0x26bf0, 0xffffffff, 0xffffffff
.long 0x26b10, 0x26bf0, 0xffffffff, 0xffffffff
.long 0x26bf0, 0x26bf0, 0xffffffff, 0x0
.long 0x26bf0, 0x26bf0, 0xffffffff, 0xffffffff
.long 0x26bf0, 0x26bf0, 0xffffffff, 0xffffffff
.long 0x26bf0, 0x26bf0, 0xffffffff, 0xffffffff
.long 0x26bf0, 0x26bf0, 0xffffffff, 0xffffffff
.long 0x26bf0, 0x26bf0, 0xffffffff, 0x0
.long 0x26bf0, 0x26bf0, 0x0, 0xffffffff
.long 0x26bf0, 0x26bf0, 0xffffffff, 0xffffffff
.long 0x26bf0, 0x26bf0, 0xffffffff, 0xffffffff
.long 0x26bf0, 0x26bf0, 0xffffffff, 0xffffffff
.long 0x26bf0, 0x26bf0, 0xffffffff, 0xffffffff
.long 0x26bf0, 0x26bf0, 0x0, 0xffffffff
.long 0x26a30, 0x26a40, 0xffffffff, 0xffffffff
.long 0x26a80, 0x26a90, 0xffffffff, 0xffffffff
.long 0x26ad0, 0x26ae0, 0xffffffff, 0xffffffff
.long 0x26b20, 0x26b30, 0xffffffff, 0xffffffff
.long 0x26bf0, 0x26bf0, 0x0, 0xffffffff
.long 0x26bf0, 0x26bf0, 0xffffffff, 0xffffffff
.long 0x26bf0, 0x26bf0, 0xffffffff, 0xffffffff
.long 0x26bf0, 0x26bf0, 0xffffffff, 0xffffffff
.long 0x26bf0, 0x26bf0, 0xffffffff, 0xffffffff
.long 0x26bf0, 0x26bf0, 0x0, 0xffffffff
.long 0x26bf0, 0x26bf0, 0xffffffff, 0xffffffff
.long 0x26bf0, 0x26bf0, 0xffffffff, 0xffffffff
.long 0x26bf0, 0x26bf0, 0xffffffff, 0xffffffff
.long 0x26bf0, 0x26bf0, 0xffffffff, 0xffffffff
.long 0x26bf0, 0x26bf0, 0x0, 0xffffffff
.long 0x26bf0, 0x26bf0, 0xffffffff, 0xffffffff
.long 0x26a00, 0x26bf0, 0xffffffff, 0xffffffff
.long 0x26a50, 0x26bf0, 0xffffffff, 0xffffffff
.long 0x26aa0, 0x26bf0, 0xffffffff, 0xffffffff
.long 0x26af0, 0x26bf0, 0xffffffff, 0xffffffff
.long 0x26bf0, 0x26bf0, 0x0, 0xffffffff
.long 0x26bf0, 0x26bf0, 0xffffffff, 0xffffffff
.long 0x26bf0, 0x26bf0, 0xffffffff, 0xffffffff
.long 0x26bf0, 0x26bf0, 0xffffffff, 0xffffffff
.long 0x26bf0, 0x26bf0, 0xffffffff, 0xffffffff
.long 0x26bf0, 0x26bf0, 0x0, 0xffffffff
.long 0x26bf0, 0x26bf0, 0xffffffff, 0xffffffff
.long 0x26bf0, 0x26bf0, 0xffffffff, 0xffffffff
.long 0x26bf0, 0x26bf0, 0xffffffff, 0xffffffff
.long 0x26bf0, 0x26bf0, 0xffffffff, 0xffffffff
.long 0x26bf0, 0x26bf0, 0x0, 0xffffffff
.long 0x26bf0, 0x26bf0, 0xffffffff, 0xffffffff
.long 0x26a10, 0x26bf0, 0xffffffff, 0xffffffff
.long 0x26a60, 0x26bf0, 0xffffffff, 0xffffffff
.long 0x26ab0, 0x26bf0, 0xffffffff, 0xffffffff
.long 0x26b00, 0x26bf0, 0x0, 0xffffffff
.long 0x26bf0, 0x26bf0, 0xffffffff, 0xffffffff
.long 0x26bf0, 0x26bf0, 0xffffffff, 0xffffffff
.long 0x26bf0, 0x26bf0, 0xffffffff, 0xffffffff
.long 0x26bf0, 0x26bf0, 0xffffffff, 0xffffffff
.long 0x26bf0, 0x26bf0, 0x0, 0xffffffff
.long 0x26bf0, 0x26bf0, 0xffffffff, 0xffffffff
.long 0x26bf0, 0x26bf0, 0xffffffff, 0xffffffff
.long 0x26bf0, 0x26bf0, 0xffffffff, 0xffffffff
.long 0x26bf0, 0x26bf0, 0xffffffff, 0xffffffff
.long 0x26bf0, 0x26bf0, 0x0, 0xffffffff
.long 0x26bf0, 0x26bf0, 0xffffffff, 0xffffffff
.long 0x26bf0, 0x26bf0, 0xffffffff, 0xffffffff
.long 0x26a20, 0x26bf0, 0xffffffff, 0xffffffff
.long 0x26a70, 0x26bf0, 0xffffffff, 0xffffffff
.long 0x26ac0, 0x26bf0, 0x0, 0xffffffff
.long 0x26b10, 0x26bf0, 0xffffffff, 0xffffffff
.long 0x26bf0, 0x26bf0, 0xffffffff, 0xffffffff
.long 0x26bf0, 0x26bf0, 0xffffffff, 0xffffffff
.long 0x26bf0, 0x26bf0, 0xffffffff, 0xffffffff
.long 0x26bf0, 0x26bf0, 0x0, 0xffffffff
.long 0x26bf0, 0x26bf0, 0xffffffff, 0xffffffff
.long 0x26bf0, 0x26bf0, 0xffffffff, 0xffffffff
.long 0x26bf0, 0x26bf0, 0xffffffff, 0xffffffff
.long 0x26bf0, 0x26bf0, 0xffffffff, 0xffffffff
.long 0x26bf0, 0x26bf0, 0x0, 0xffffffff
.long 0x26bf0, 0x26bf0, 0xffffffff, 0xffffffff
.long 0x26bf0, 0x26bf0, 0xffffffff, 0xffffffff
.long 0x26bf0, 0x26bf0, 0xffffffff, 0xffffffff
.long 0x26a30, 0x26a40, 0xffffffff, 0xffffffff
.long 0x26a80, 0x26a90, 0x0, 0xffffffff
.long 0x26ad0, 0x26ae0, 0xffffffff, 0xffffffff
.long 0x26b20, 0x26b30, 0xffffffff, 0xffffffff
.long 0x26bf0, 0x26bf0, 0xffffffff, 0xffffffff
.long 0x26bf0, 0x26bf0, 0xffffffff, 0xffffffff
.long 0x26bf0, 0x26bf0, 0x0, 0xffffffff
.long 0x26bf0, 0x26bf0, 0xffffffff, 0xffffffff
.long 0x26bf0, 0x26bf0, 0xffffffff, 0xffffffff
.long 0x26bf0, 0x26bf0, 0xffffffff, 0xffffffff
.long 0x26bf0, 0x26bf0, 0xffffffff, 0xffffffff
.long 0x26bf0, 0x26bf0, 0x0, 0xffffffff
.long 0x26bf0, 0x26bf0, 0xffffffff, 0xffffffff
.long 0x26bf0, 0x26bf0, 0xffffffff, 0xffffffff
.long 0x26bf0, 0x26bf0, 0xffffffff, 0xffffffff
.long 0x26bf0, 0x26bf0, 0xffffffff, 0xffffffff
.long 0x26a00, 0x26bf0, 0xffffffff, 0xffffffff
.long 0x26a50, 0x26bf0, 0x0, 0xffffffff
.long 0x26aa0, 0x26bf0, 0xffffffff, 0xffffffff
.long 0x26af0, 0x26bf0, 0xffffffff, 0xffffffff
.long 0x26bf0, 0x26bf0, 0xffffffff, 0xffffffff
.long 0x26bf0, 0x26bf0, 0xffffffff, 0xffffffff
.long 0x26bf0, 0x26bf0, 0x0, 0xffffffff
.long 0x26bf0, 0x26bf0, 0xffffffff, 0xffffffff
.long 0x26bf0, 0x26bf0, 0xffffffff, 0xffffffff
.long 0x26bf0, 0x26bf0, 0xffffffff, 0xffffffff
.long 0x26bf0, 0x26bf0, 0xffffffff, 0xffffffff
.long 0x26bf0, 0x26bf0, 0x0, 0xffffffff
.long 0x26bf0, 0x26bf0, 0xffffffff, 0xffffffff
.long 0x26bf0, 0x26bf0, 0xffffffff, 0xffffffff
.long 0x26bf0, 0x26bf0, 0xffffffff, 0xffffffff
.long 0x26bf0, 0x26bf0, 0xffffffff, 0xffffffff
.long 0x26a10, 0x26bf0, 0x0, 0xffffffff
.long 0x26a60, 0x26bf0, 0xffffffff, 0xffffffff
.long 0x26ab0, 0x26bf0, 0xffffffff, 0xffffffff
.long 0x26b00, 0x26bf0, 0xffffffff, 0xffffffff
.long 0x26bf0, 0x26bf0, 0xffffffff, 0xffffffff
.long 0x26bf0, 0x26bf0, 0x0, 0xffffffff
.long 0x26bf0, 0x26bf0, 0xffffffff, 0xffffffff
.long 0x26bf0, 0x26bf0, 0xffffffff, 0xffffffff
.long 0x26bf0, 0x26bf0, 0xffffffff, 0xffffffff
.long 0x26bf0, 0x26bf0, 0xffffffff, 0xffffffff
.long 0x26bf0, 0x26bf0, 0x0, 0xffffffff
.long 0x26bf0, 0x26bf0, 0xffffffff, 0xffffffff
.long 0x26bf0, 0x26bf0, 0xffffffff, 0xffffffff
.long 0x26bf0, 0x26bf0, 0xffffffff, 0xffffffff
.long 0x26bf0, 0x26bf0, 0xffffffff, 0xffffffff
.long 0x26bf0, 0x26bf0, 0x0, 0xffffffff
.long 0x26a20, 0x26bf0, 0xffffffff, 0xffffffff
.long 0x26a70, 0x26bf0, 0xffffffff, 0xffffffff
.long 0x26ac0, 0x26bf0, 0xffffffff, 0xffffffff
.long 0x26b10, 0x26bf0, 0xffffffff, 0xffffffff
.long 0x26bf0, 0x26bf0, 0xffffffff, 0xffffffff
.long 0x26bf0, 0x26bf0, 0xffffffff, 0xffffffff
.long 0x26bf0, 0x26bf0, 0xffffffff, 0xffffffff
.long 0x26bf0, 0x26bf0, 0xffffffff, 0xffffffff
.long 0x26bf0, 0x26bf0, 0xffffffff, 0x0
.long 0x26bf0, 0x26bf0, 0x0, 0xffffffff
.long 0x26bf0, 0x26bf0, 0xffffffff, 0xffffffff
.long 0x26bf0, 0x26bf0, 0xffffffff, 0xffffffff
.long 0x26bf0, 0x26bf0, 0xffffffff, 0xffffffff
.long 0x26bf0, 0x26bf0, 0xffffffff, 0xffffffff
.long 0x26bf0, 0x26bf0, 0xffffffff, 0xffffffff
.long 0x26bf0, 0x26bf0, 0xffffffff, 0xffffffff
.long 0x26a30, 0x26a40, 0xffffffff, 0xffffffff
.long 0x26a80, 0x26a90, 0xffffffff, 0xffffffff
.long 0x26ad0, 0x26ae0, 0xffffffff, 0xffffffff
.long 0x26b20, 0x26b30, 0xffffffff, 0xffffffff
.long 0x26bf0, 0x26bf0, 0xffffffff, 0xffffffff
.long 0x26bf0, 0x26bf0, 0xffffffff, 0xffffffff
.long 0x26bf0, 0x26bf0, 0xffffffff, 0xffffffff
.long 0x26bf0, 0x26bf0, 0xffffffff, 0xffffffff
.long 0x26bf0, 0x26bf0, 0xffffffff, 0xffffffff
.long 0x26bf0, 0x26bf0, 0xffffffff, 0xffffffff
.long 0x26bf0, 0x26bf0, 0xffffffff, 0xffffffff
.long 0x26bf0, 0x26bf0, 0xffffffff, 0xffffffff
.long 0x26bf0, 0x26bf0, 0xffffffff, 0xffffffff
.long 0x26bf0, 0x26bf0, 0xffffffff, 0xffffffff
.long 0x26bf0, 0x26bf0, 0xffffffff, 0xffffffff
.long 0x26bf0, 0x26bf0, 0xffffffff, 0xffffffff
.size L_tbl, 8192
L_codeend:
.section .rodata,"a"
.p2align 6
.amdhsa_kernel parallel_sum__linear_attn_block__geglu_ffn__prompt_kernel
  .amdhsa_next_free_vgpr 512
  .amdhsa_next_free_sgpr 102
  .amdhsa_accum_offset 256
  .amdhsa_group_segment_fixed_size 0
  .amdhsa_kernarg_size 80
  .amdhsa_user_sgpr_count 2
  .amdhsa_user_sgpr_kernarg_segment_ptr 1
  .amdhsa_system_sgpr_workgroup_id_x 1
.end_amdhsa_kernel
```
